```python
import torch

def _softmax(x, axis=-1):
    return torch.softmax(x, dim=axis)
def _gelu(x):
    return torch.nn.functional.gelu(x, approximate="tanh")
def _silu(x):
    return torch.nn.functional.silu(x)
def _sigmoid(x):
    return torch.sigmoid(x)
def _layernorm(x, axis=-1, eps=1e-5):
    m = x.mean(dim=axis, keepdim=True)
    v = x.var(dim=axis, keepdim=True, unbiased=False)
    return (x - m) / torch.sqrt(v + eps)
def _scatter_add(tgt, idx, src, axis=0):
    return tgt.clone().index_add_(axis, idx, src)
def _segment_sum(src, seg, n):
    out = torch.zeros((n,) + src.shape[1:], dtype=src.dtype)
    return out.index_add_(0, seg, src)
def _pad(x, pw):
    flat = tuple(v for pair in reversed(pw) for v in pair)
    return torch.nn.functional.pad(x, flat)

kernel_name = 'concat_heads__grouped_kv_mqa__grouped_kv_mqa__prompt'

def setup_inputs():

    _w = (lambda a: (lambda t: t.to(torch.bfloat16) if t.is_floating_point() else t)(torch.as_tensor(a)))
    def _A_setup():
        B, S, D, H = 1, 2048, 576, 32
        Dh = D // H
        return {
            "x": _w((lambda *s: torch.randn(*s, dtype=torch.bfloat16) * 0.05)(B, S, D)),
            "wq": _w((lambda *s: torch.randn(*s, dtype=torch.bfloat16) * 0.8)(D, H * Dh)),
            "wk": _w((lambda *s: torch.randn(*s, dtype=torch.bfloat16) * 0.8)(D, Dh)),
            "wv": _w((lambda *s: torch.randn(*s, dtype=torch.bfloat16) * 0.05)(D, Dh)),
            "wo": _w((lambda *s: torch.randn(*s, dtype=torch.bfloat16) * 0.05)(H * Dh, D)),
        }
    _A_in = _A_setup()

    def _B_setup():
        B, S, D, H = 1, 2048, 576, 32
        Dh = D // H
        return {
            "x": _w((lambda *s: torch.randn(*s, dtype=torch.bfloat16) * 0.05)(B, S, D)),
            "wq": _w((lambda *s: torch.randn(*s, dtype=torch.bfloat16) * 0.8)(D, H * Dh)),
            "wk": _w((lambda *s: torch.randn(*s, dtype=torch.bfloat16) * 0.8)(D, Dh)),
            "wv": _w((lambda *s: torch.randn(*s, dtype=torch.bfloat16) * 0.05)(D, Dh)),
            "wo": _w((lambda *s: torch.randn(*s, dtype=torch.bfloat16) * 0.05)(H * Dh, D)),
        }
    _B_in = _B_setup()

    return {
        "A_x": _A_in["x"],
        "A_wq": _A_in["wq"],
        "A_wk": _A_in["wk"],
        "A_wv": _A_in["wv"],
        "A_wo": _A_in["wo"],
        "B_x": _B_in["x"],
        "B_wq": _B_in["wq"],
        "B_wk": _B_in["wk"],
        "B_wv": _B_in["wv"],
        "B_wo": _B_in["wo"],
    }

def reference(A_x, A_wq, A_wk, A_wv, A_wo, B_x, B_wq, B_wk, B_wv, B_wo):
    def _A_ref(x, wq, wk, wv, wo):
        B, S, D = x.shape
        H = 32
        Dh = D // H
        q = (lambda x, *d: x.permute(*d))((x @ wq).reshape(B, S, H, Dh), 0, 2, 1, 3)
        k = x @ wk
        v = x @ wv
        scores = torch.einsum("bhqd,bkd->bhqk", q, k) * (Dh ** -0.5)
        p = _softmax(scores, axis=-1)
        o = torch.einsum("bhqk,bkd->bhqd", p, v)
        return (lambda x, *d: x.permute(*d))(o, 0, 2, 1, 3).reshape(B, S, H * Dh) @ wo

    def _B_ref(x, wq, wk, wv, wo):
        B, S, D = x.shape
        H = 32
        Dh = D // H
        q = (lambda x, *d: x.permute(*d))((x @ wq).reshape(B, S, H, Dh), 0, 2, 1, 3)
        k = x @ wk
        v = x @ wv
        scores = torch.einsum("bhqd,bkd->bhqk", q, k) * (Dh ** -0.5)
        p = _softmax(scores, axis=-1)
        o = torch.einsum("bhqk,bkd->bhqd", p, v)
        return (lambda x, *d: x.permute(*d))(o, 0, 2, 1, 3).reshape(B, S, H * Dh) @ wo

    a = _A_ref(A_x, A_wq, A_wk, A_wv, A_wo)
    b = _B_ref(B_x, B_wq, B_wk, B_wv, B_wo)
    return torch.concatenate([a, b], axis=-1)
```

```asm
; @launch grid=(256,1,1) block=(512,1,1) lds=163840
.amdgcn_target "amdgcn-amd-amdhsa--gfx950"
.text
.globl concat_heads__grouped_kv_mqa__grouped_kv_mqa__prompt_kernel
.p2align 8
.type concat_heads__grouped_kv_mqa__grouped_kv_mqa__prompt_kernel,@function
concat_heads__grouped_kv_mqa__grouped_kv_mqa__prompt_kernel:
    s_cmp_ge_u32 s2, 256
    s_cbranch_scc1 L_con_end_concat_heads__grouped_kv_mqa__grouped_kv_mqa__prompt_kernel
    s_and_b32 s32, s2, 1
    s_mul_i32 s3, s32, 40
    s_add_u32 s56, s0, s3
    s_addc_u32 s57, s1, 0
    s_load_dwordx4 s[60:63], s[56:57], 0
    s_load_dwordx2 s[70:71], s[0:1], 96
    s_load_dwordx4 s[64:67], s[56:57], 16
    s_load_dwordx2 s[54:55], s[56:57], 32
    s_load_dwordx2 s[72:73], s[0:1], 80
    v_lshrrev_b32 v2, 6, v0
    v_and_b32 v1, 63, v0
L_con_pc0:
    s_bfe_u32 s3, s2, 0x20001
    s_lshl_b32 s3, s3, 3
    s_lshr_b32 s33, s2, 5
    v_readfirstlane_b32 s35, v2
    s_add_u32 s33, s33, s3
    s_bfe_u32 s34, s2, 0x20003
    s_cmp_ge_u32 s35, 4
    s_cbranch_scc1 L_con_role1
    s_setprio 1
    s_and_b32 s75, s33, 7
    s_and_b32 s3, s34, 1
    s_lshl_b32 s3, s3, 2
    s_add_u32 s75, s75, s3
    s_cmp_ge_u32 s75, 9
    s_cselect_b32 s3, 9, 0
    s_sub_u32 s75, s75, s3
    s_movk_i32 s43, 1152
    v_lshrrev_b32 v3, 3, v1
    v_lshrrev_b32 v4, 4, v1
    v_xor_b32 v4, 0, v4
    v_xor_b32 v4, v4, v1
    v_and_b32 v4, 7, v4
    v_lshlrev_b32 v4, 4, v4
    v_mad_u32_u24 v14, v3, s43, v4
    v_xor_b32 v15, 64, v14
    s_lshr_b32 s3, s34, 1
    s_lshl_b32 s37, s33, 1
    s_add_u32 s37, s37, s3
    s_mul_i32 s37, s37, 36864
    s_lshl_b32 s42, s35, 12
    s_add_u32 s38, s75, s35
    s_cmp_ge_u32 s38, 9
    s_cselect_b32 s3, 9, 0
    s_sub_u32 s38, s38, s3
    s_add_u32 s39, s38, 4
    s_cmp_ge_u32 s39, 9
    s_cselect_b32 s3, 9, 0
    s_sub_u32 s39, s39, s3
    s_waitcnt lgkmcnt(0)
    s_mov_b32 s4, s60
    s_mov_b32 s5, s61
    s_mov_b32 s6, 2359296
    s_mov_b32 s7, 0x20000
    s_lshl_b32 s40, s38, 7
    s_add_u32 s40, s40, s37
    s_add_u32 m0, s42, 12288
    s_nop 0
    buffer_load_dwordx4 v14, s[4:7], s40 offen lds
    s_add_u32 m0, s42, 13312
    s_add_u32 s3, s40, 9216
    buffer_load_dwordx4 v15, s[4:7], s3 offen lds
    s_add_u32 m0, s42, 14336
    s_add_u32 s3, s40, 18432
    buffer_load_dwordx4 v14, s[4:7], s3 offen lds
    s_add_u32 m0, s42, 15360
    s_add_u32 s3, s40, 27648
    buffer_load_dwordx4 v15, s[4:7], s3 offen lds
    s_cmp_eq_u32 s35, 0
    s_cbranch_scc0 L_con_nox8
    s_add_u32 s75, s75, 8
    s_cmp_ge_u32 s75, 9
    s_cselect_b32 s3, 9, 0
    s_sub_u32 s75, s75, s3
    s_lshl_b32 s40, s75, 7
    s_add_u32 s40, s40, s37
    s_add_u32 m0, s42, 45056
    s_nop 0
    buffer_load_dwordx4 v14, s[4:7], s40 offen lds
    s_add_u32 m0, s42, 46080
    s_add_u32 s3, s40, 9216
    buffer_load_dwordx4 v15, s[4:7], s3 offen lds
    s_add_u32 m0, s42, 47104
    s_add_u32 s3, s40, 18432
    buffer_load_dwordx4 v14, s[4:7], s3 offen lds
    s_add_u32 m0, s42, 48128
    s_add_u32 s3, s40, 27648
    buffer_load_dwordx4 v15, s[4:7], s3 offen lds
L_con_nox8:
    v_mov_b32 v3, v1
    v_mul_u32_u24 v4, 0x5556, v3
    v_lshrrev_b32 v4, 16, v4
    v_lshlrev_b32 v3, 4, v3
    v_mad_i32_i24 v11, v4, -12, v3
    v_add_u32 v3, 64, v1
    v_mul_u32_u24 v4, 0x5556, v3
    v_lshrrev_b32 v4, 16, v4
    v_lshlrev_b32 v3, 4, v3
    v_mad_i32_i24 v12, v4, -12, v3
    v_add_u32 v3, 128, v1
    v_mul_u32_u24 v4, 0x5556, v3
    v_lshrrev_b32 v4, 16, v4
    v_lshlrev_b32 v3, 4, v3
    v_mad_i32_i24 v13, v4, -12, v3
    s_add_u32 s3, s35, 3
    s_and_b32 s41, s3, 1
    s_mul_i32 s41, s41, 6144
    s_bitcmp1_b32 s3, 1
    s_cselect_b32 s3, 75776, 0
    s_add_u32 s41, s41, s3
    s_add_u32 s28, s70, 524288
    s_addc_u32 s29, s71, 0
    s_mov_b32 s30, 0x10100
    s_mov_b32 s31, 0x20000
    s_mov_b32 s8, s62
    s_mov_b32 s9, s63
    s_mov_b32 s10, 663552
    s_mov_b32 s11, 0x20000
    s_bitcmp1_b32 s34, 0
    s_cselect_b64 s[12:13], s[66:67], s[64:65]
    s_mov_b32 s14, 20736
    s_mov_b32 s15, 0x20000
    s_mul_i32 s40, s38, 2304
    s_add_u32 m0, s41, 0
    s_nop 0
    buffer_load_dwordx4 v11, s[12:15], s40 offen lds
    s_add_u32 m0, s41, 1024
    s_nop 0
    buffer_load_dwordx4 v12, s[12:15], s40 offen lds
    s_add_u32 m0, s41, 2048
    s_nop 0
    buffer_load_dwordx4 v13, s[12:15], s40 offen lds
    s_cmp_eq_u32 s35, 0
    s_cbranch_scc0 L_con_now8
    s_mul_i32 s40, s75, 2304
    s_add_u32 m0, s41, 6144
    s_nop 0
    buffer_load_dwordx4 v11, s[12:15], s40 offen lds
    s_add_u32 m0, s41, 7168
    s_nop 0
    buffer_load_dwordx4 v12, s[12:15], s40 offen lds
    s_add_u32 m0, s41, 8192
    s_nop 0
    buffer_load_dwordx4 v13, s[12:15], s40 offen lds
L_con_now8:
    s_lshl_b32 s40, s39, 7
    s_add_u32 s40, s40, s37
    s_add_u32 m0, s42, 28672
    s_nop 0
    buffer_load_dwordx4 v14, s[4:7], s40 offen lds
    s_add_u32 m0, s42, 29696
    s_add_u32 s3, s40, 9216
    buffer_load_dwordx4 v15, s[4:7], s3 offen lds
    s_add_u32 m0, s42, 30720
    s_add_u32 s3, s40, 18432
    buffer_load_dwordx4 v14, s[4:7], s3 offen lds
    s_add_u32 m0, s42, 31744
    s_add_u32 s3, s40, 27648
    buffer_load_dwordx4 v15, s[4:7], s3 offen lds
    s_mul_i32 s40, s39, 2304
    s_add_u32 m0, s41, 3072
    s_nop 0
    buffer_load_dwordx4 v11, s[12:15], s40 offen lds
    s_add_u32 m0, s41, 4096
    s_nop 0
    buffer_load_dwordx4 v12, s[12:15], s40 offen lds
    s_add_u32 m0, s41, 5120
    s_nop 0
    buffer_load_dwordx4 v13, s[12:15], s40 offen lds
    s_lshl_b32 s36, s32, 7
    s_add_u32 s36, s36, 65536
    v_mov_b32 v180, 0
    buffer_load_dword v180, v180, s[28:31], s36 offen sc1
    s_setprio 0
    s_barrier
    s_branch L_con_rest0
L_con_role1:
    s_getpc_b64 s[24:25]
L_con_pc:
    s_mov_b32 s26, L_con_code_end-L_con_pc
    s_mov_b32 s27, 0x20000
    s_lshr_b32 s3, s2, 3
    s_mul_i32 s3, s3, 1664
    v_lshlrev_b32 v3, 7, v1
    s_cmp_eq_u32 s35, 4
    s_cbranch_scc0 L_con_nocode
    s_mov_b32 exec_lo, 8191
    s_mov_b32 exec_hi, 0
    buffer_load_dword v205, v3, s[24:27], s3 offen
    s_mov_b64 exec, -1
L_con_nocode:
    s_and_b32 s75, s33, 7
    s_and_b32 s3, s34, 1
    s_lshl_b32 s3, s3, 2
    s_add_u32 s75, s75, s3
    s_cmp_ge_u32 s75, 9
    s_cselect_b32 s3, 9, 0
    s_sub_u32 s75, s75, s3
    s_movk_i32 s43, 1152
    s_lshl_b32 s36, s32, 7
    s_add_u32 s36, s36, 65536
    v_mov_b32 v180, 0
    s_and_b32 s42, s35, 3
    s_and_b32 s41, s35, 1
    s_lshl_b32 s40, s41, 2
    v_lshrrev_b32 v3, 3, v1
    v_lshrrev_b32 v4, 4, v1
    v_xor_b32 v4, s40, v4
    v_xor_b32 v4, v4, v1
    v_and_b32 v4, 7, v4
    v_lshlrev_b32 v4, 4, v4
    v_mad_u32_u24 v179, v3, s43, v4
    s_lshr_b32 s3, s34, 1
    s_xor_b32 s3, s3, 1
    s_lshl_b32 s37, s33, 1
    s_add_u32 s37, s37, s3
    s_lshl_b32 s37, s37, 2
    s_add_u32 s37, s37, s42
    s_lshl_b32 s38, s42, 6
    v_add_u32 v3, s38, v1
    v_mul_u32_u24 v4, 3641, v3
    v_lshrrev_b32 v4, 16, v4
    v_mad_i32_i24 v3, v4, -16, v3
    v_mad_i32_i24 v3, v4, -2, v3
    v_bfe_u32 v5, v4, 1, 2
    v_and_or_b32 v5, v4, 56, v5
    v_and_b32 v4, 1, v4
    v_lshl_or_b32 v5, v4, 2, v5
    v_lshlrev_b32 v3, 4, v3
    v_mad_u32_u24 v176, v5, s43, v3
    s_add_u32 s38, s38, 256
    v_add_u32 v3, s38, v1
    v_mul_u32_u24 v4, 3641, v3
    v_lshrrev_b32 v4, 16, v4
    v_mad_i32_i24 v3, v4, -16, v3
    v_mad_i32_i24 v3, v4, -2, v3
    v_bfe_u32 v5, v4, 1, 2
    v_and_or_b32 v5, v4, 56, v5
    v_and_b32 v4, 1, v4
    v_lshl_or_b32 v5, v4, 2, v5
    v_lshlrev_b32 v3, 4, v3
    v_mad_u32_u24 v177, v5, s43, v3
    s_mul_i32 s38, s41, 576
    s_add_u32 s38, s38, 512
    v_add_u32 v3, s38, v1
    v_mul_u32_u24 v4, 3641, v3
    v_lshrrev_b32 v4, 16, v4
    v_mad_i32_i24 v3, v4, -16, v3
    v_mad_i32_i24 v3, v4, -2, v3
    v_bfe_u32 v5, v4, 1, 2
    v_and_or_b32 v5, v4, 56, v5
    v_and_b32 v4, 1, v4
    v_lshl_or_b32 v5, v4, 2, v5
    v_lshlrev_b32 v3, 4, v3
    v_mad_u32_u24 v178, v5, s43, v3
    s_waitcnt lgkmcnt(0)
    s_mov_b32 s4, s60
    s_mov_b32 s5, s61
    s_mov_b32 s6, 2359296
    s_mov_b32 s7, 0x20000
    s_add_u32 s28, s70, 524288
    s_addc_u32 s29, s71, 0
    s_mov_b32 s30, 0x10100
    s_mov_b32 s31, 0x20000
    s_mov_b32 s8, s62
    s_mov_b32 s9, s63
    s_mov_b32 s10, 663552
    s_mov_b32 s11, 0x20000
    s_bitcmp1_b32 s34, 0
    s_cselect_b64 s[12:13], s[66:67], s[64:65]
    s_mov_b32 s14, 20736
    s_mov_b32 s15, 0x20000
    s_mul_i32 s57, s37, 9216
    s_mul_i32 s56, s34, 288
    s_lshl_b32 s58, s42, 10
    s_lshl_b32 s59, s38, 4
    s_cmp_ge_u32 s35, 6
    s_cselect_b64 s[46:47], 1, -1
    buffer_load_dword v180, v180, s[28:31], s36 offen sc1
    v_lshrrev_b32 v6, 5, v1
    v_bfe_u32 v7, v1, 4, 1
    v_bfe_u32 v8, v1, 2, 2
    v_and_b32 v9, 3, v1
    v_and_b32 v10, 31, v1
    s_and_b32 s3, s33, 1
    s_lshl_b32 s3, s3, 2
    s_add_u32 s52, s3, s34
    s_lshr_b32 s3, s33, 1
    s_lshl_b32 s53, s32, 4
    s_add_u32 s53, s53, s3
    s_lshl_b32 s3, s32, 18
    s_add_u32 s16, s70, s3
    s_addc_u32 s17, s71, 0
    s_mov_b32 s18, 151552
    s_mov_b32 s19, 0x20000
    s_add_u32 s20, s70, 1048576
    s_addc_u32 s21, s71, 0
    s_mov_b32 s22, 4718592
    s_mov_b32 s23, 0x20000
    s_mov_b32 s24, s72
    s_mov_b32 s25, s73
    s_mov_b32 s26, 4718592
    s_mov_b32 s27, 0x20000
    v_and_b32 v11, 15, v1
    s_and_b32 s36, s35, 1
    s_lshl_b32 s36, s36, 4
    v_add_u32 v11, s36, v11
    v_lshrrev_b32 v13, 4, v1
    v_add_u32 v14, 0, v13
    v_bfe_u32 v12, v11, 1, 3
    v_xor_b32 v12, v12, v14
    v_lshlrev_b32 v12, 4, v12
    v_lshl_add_u32 v169, v11, 7, v12
    v_add_u32 v14, 4, v13
    v_bfe_u32 v12, v11, 1, 3
    v_xor_b32 v12, v12, v14
    v_lshlrev_b32 v12, 4, v12
    v_lshl_add_u32 v170, v11, 7, v12
    v_lshl_add_u32 v12, v13, 2, v8
    v_lshlrev_b32 v14, 3, v9
    v_add_u32 v14, 49408, v14
    s_movk_i32 s3, 576
    v_mad_u32_u24 v173, v12, s3, v14
    v_add_u32 v189, 64512, v173
    v_lshrrev_b32 v221, 3, v1
    v_and_b32 v222, 7, v1
    v_bfe_u32 v223, v1, 4, 1
    v_lshlrev_b32 v223, 1, v223
    v_xor_b32 v222, v222, v223
    v_lshlrev_b32 v222, 4, v222
    v_mul_u32_u24 v221, 0x480, v221
    v_add_u32 v217, v221, v222
    v_mad_u32_u24 v218, v221, 18, v222
    v_lshrrev_b32 v221, 2, v1
    v_and_b32 v222, 3, v1
    v_lshlrev_b32 v222, 4, v222
    v_and_b32 v223, 7, v221
    v_mul_u32_u24 v223, 18, v223
    v_lshrrev_b32 v224, 5, v1
    v_add_u32 v223, v223, v224
    v_mul_u32_u24 v223, 0x480, v223
    v_add_u32 v220, v223, v222
    v_mul_u32_u24 v221, 0x480, v221
    v_add_u32 v219, v221, v222
    s_barrier
    s_mul_i32 s44, s75, 73728
    s_add_u32 m0, s58, 49152
    s_add_u32 s44, s44, s56
    buffer_load_dwordx4 v176, s[8:11], s44 offen lds
    s_add_u32 m0, s58, 53248
    s_add_u32 s45, s44, 36864
    buffer_load_dwordx4 v177, s[8:11], s44 offen lds
    s_add_u32 m0, s59, 49152
    s_mov_b64 exec, s[46:47]
    buffer_load_dwordx4 v178, s[8:11], s44 offen lds
    s_mov_b64 exec, -1
    s_add_u32 m0, s58, 58368
    s_lshl_b32 s44, s75, 7
    buffer_load_dwordx4 v176, s[8:11], s45 offen lds
    s_add_u32 m0, s58, 62464
    s_add_u32 s44, s44, s57
    buffer_load_dwordx4 v177, s[8:11], s45 offen lds
    s_add_u32 m0, s58, 67584
    s_add_u32 s75, s75, 1
    buffer_load_dwordx4 v179, s[4:7], s44 offen lds
    s_cmp_ge_u32 s75, 9
    s_cselect_b32 s75, 0, s75
    s_mul_i32 s44, s75, 73728
    s_add_u32 m0, s58, 91136
    s_add_u32 s44, s44, s56
    buffer_load_dwordx4 v176, s[8:11], s44 offen lds
    s_add_u32 m0, s58, 95232
    s_add_u32 s45, s44, 36864
    buffer_load_dwordx4 v177, s[8:11], s44 offen lds
    s_add_u32 m0, s59, 91136
    s_mov_b64 exec, s[46:47]
    buffer_load_dwordx4 v178, s[8:11], s44 offen lds
    s_mov_b64 exec, -1
    s_add_u32 m0, s58, 100352
    s_lshl_b32 s44, s75, 7
    buffer_load_dwordx4 v176, s[8:11], s45 offen lds
    s_add_u32 m0, s58, 104448
    s_add_u32 s44, s44, s57
    buffer_load_dwordx4 v177, s[8:11], s45 offen lds
    s_add_u32 m0, s58, 109568
    s_add_u32 s75, s75, 1
    buffer_load_dwordx4 v179, s[4:7], s44 offen lds
    s_cmp_ge_u32 s75, 9
    s_cselect_b32 s75, 0, s75
    s_branch L_con_rest1
L_con_rest0:
    v_lshrrev_b32 v6, 5, v1
    v_bfe_u32 v7, v1, 4, 1
    v_bfe_u32 v8, v1, 2, 2
    v_and_b32 v9, 3, v1
    v_and_b32 v10, 31, v1
    s_lshl_b32 s36, s35, 12
    v_add_u32 v11, 0, v6
    v_bfe_u32 v12, v10, 1, 3
    v_xor_b32 v12, v12, v11
    v_lshlrev_b32 v12, 4, v12
    v_lshl_add_u32 v160, v10, 7, v12
    v_add_u32 v192, s36, v160
    v_add_u32 v11, 2, v6
    v_bfe_u32 v12, v10, 1, 3
    v_xor_b32 v12, v12, v11
    v_lshlrev_b32 v12, 4, v12
    v_lshl_add_u32 v161, v10, 7, v12
    v_add_u32 v193, s36, v161
    v_add_u32 v11, 4, v6
    v_bfe_u32 v12, v10, 1, 3
    v_xor_b32 v12, v12, v11
    v_lshlrev_b32 v12, 4, v12
    v_lshl_add_u32 v162, v10, 7, v12
    v_add_u32 v194, s36, v162
    v_add_u32 v11, 6, v6
    v_bfe_u32 v12, v10, 1, 3
    v_xor_b32 v12, v12, v11
    v_lshlrev_b32 v12, 4, v12
    v_lshl_add_u32 v163, v10, 7, v12
    v_add_u32 v195, s36, v163
    v_lshlrev_b32 v11, 3, v9
    v_and_b32 v12, 1, v9
    v_lshlrev_b32 v12, 4, v12
    v_lshrrev_b32 v13, 1, v9
    v_lshl_add_u32 v12, v13, 3, v12
    s_bitcmp1_b32 s34, 0
    s_cselect_b64 vcc, -1, 0
    v_cndmask_b32 v11, v12, v11, vcc
    v_cmp_eq_u32 vcc, 1, v7
    v_lshl_add_u32 v12, v6, 3, v8
    v_lshl_add_u32 v175, v1, 4, s41
    v_cndmask_b32 v11, v11, 32, vcc
    v_mad_u32_u24 v11, v12, 48, v11
    v_add_u32 v174, s41, v11
    v_mov_b32 v16, 0
    v_mov_b32 v17, 0
    v_mov_b32 v18, 0
    v_mov_b32 v19, 0
    v_mov_b32 v20, 0
    v_mov_b32 v21, 0
    v_mov_b32 v22, 0
    v_mov_b32 v23, 0
    v_mov_b32 v24, 0
    v_mov_b32 v25, 0
    v_mov_b32 v26, 0
    v_mov_b32 v27, 0
    v_mov_b32 v28, 0
    v_mov_b32 v29, 0
    v_mov_b32 v30, 0
    v_mov_b32 v31, 0
    v_add_u32 v164, 67584, v160
    v_add_u32 v184, 154624, v160
    v_add_u32 v165, 67584, v161
    v_add_u32 v185, 154624, v161
    v_add_u32 v166, 67584, v162
    v_add_u32 v186, 154624, v162
    v_add_u32 v167, 67584, v163
    v_add_u32 v187, 154624, v163
    s_lshl_b32 s3, s35, 6
    s_add_u32 s3, s3, 49152
    v_lshl_add_u32 v11, v7, 5, s3
    v_lshl_add_u32 v11, v9, 3, v11
    v_lshl_add_u32 v12, v6, 2, v8
    s_movk_i32 s3, 576
    v_mad_u32_u24 v168, v12, s3, v11
    v_add_u32 v188, 64512, v168
    s_and_b32 s3, s33, 1
    s_lshl_b32 s3, s3, 2
    s_add_u32 s52, s3, s34
    s_lshr_b32 s3, s33, 1
    s_lshl_b32 s53, s32, 4
    s_add_u32 s53, s53, s3
    s_lshl_b32 s3, s32, 18
    s_add_u32 s16, s70, s3
    s_addc_u32 s17, s71, 0
    s_mov_b32 s18, 151552
    s_mov_b32 s19, 0x20000
    s_add_u32 s20, s70, 1048576
    s_addc_u32 s21, s71, 0
    s_mov_b32 s22, 4718592
    s_mov_b32 s23, 0x20000
    s_mov_b32 s24, s72
    s_mov_b32 s25, s73
    s_mov_b32 s26, 4718592
    s_mov_b32 s27, 0x20000
    s_bitcmp1_b32 s34, 0
    s_cbranch_scc1 L_con_kvV
    s_cmp_eq_u32 s35, 0
    s_cbranch_scc0 L_con_kv2K
    s_waitcnt vmcnt(8)
    ds_read_b128 v[128:131], v192 offset:45056
    ds_read_b64_tr_b16 v[144:145], v174 offset:6144
    ds_read_b64_tr_b16 v[146:147], v174 offset:6336
    ds_read_b128 v[132:135], v193 offset:45056
    ds_read_b64_tr_b16 v[148:149], v174 offset:6912
    ds_read_b64_tr_b16 v[150:151], v174 offset:7104
    ds_read_b128 v[136:139], v194 offset:45056
    ds_read_b64_tr_b16 v[152:153], v174 offset:7680
    ds_read_b64_tr_b16 v[154:155], v174 offset:7872
    ds_read_b128 v[140:143], v195 offset:45056
    ds_read_b64_tr_b16 v[156:157], v174 offset:8448
    ds_read_b64_tr_b16 v[158:159], v174 offset:8640
    s_waitcnt lgkmcnt(9)
    v_mfma_f32_32x32x16_bf16 v[16:31], v[144:147], v[128:131], v[16:31]
    s_waitcnt lgkmcnt(6)
    v_mfma_f32_32x32x16_bf16 v[16:31], v[148:151], v[132:135], v[16:31]
    s_waitcnt lgkmcnt(3)
    v_mfma_f32_32x32x16_bf16 v[16:31], v[152:155], v[136:139], v[16:31]
    s_waitcnt lgkmcnt(0)
    v_mfma_f32_32x32x16_bf16 v[16:31], v[156:159], v[140:143], v[16:31]
L_con_kv2K:
    s_waitcnt vmcnt(8)
    ds_read_b128 v[64:67], v192 offset:12288
    ds_read_b64_tr_b16 v[80:81], v174 offset:0
    ds_read_b64_tr_b16 v[82:83], v174 offset:192
    ds_read_b128 v[68:71], v193 offset:12288
    ds_read_b64_tr_b16 v[84:85], v174 offset:768
    ds_read_b64_tr_b16 v[86:87], v174 offset:960
    ds_read_b128 v[72:75], v194 offset:12288
    ds_read_b64_tr_b16 v[88:89], v174 offset:1536
    ds_read_b64_tr_b16 v[90:91], v174 offset:1728
    ds_read_b128 v[76:79], v195 offset:12288
    ds_read_b64_tr_b16 v[92:93], v174 offset:2304
    ds_read_b64_tr_b16 v[94:95], v174 offset:2496
    s_waitcnt lgkmcnt(9)
    v_mfma_f32_32x32x16_bf16 v[16:31], v[80:83], v[64:67], v[16:31]
    s_waitcnt lgkmcnt(6)
    v_mfma_f32_32x32x16_bf16 v[16:31], v[84:87], v[68:71], v[16:31]
    s_waitcnt lgkmcnt(3)
    v_mfma_f32_32x32x16_bf16 v[16:31], v[88:91], v[72:75], v[16:31]
    s_waitcnt lgkmcnt(0)
    v_mfma_f32_32x32x16_bf16 v[16:31], v[92:95], v[76:79], v[16:31]
    s_waitcnt vmcnt(0)
    ds_read_b128 v[96:99], v192 offset:28672
    ds_read_b64_tr_b16 v[112:113], v174 offset:3072
    ds_read_b64_tr_b16 v[114:115], v174 offset:3264
    ds_read_b128 v[100:103], v193 offset:28672
    ds_read_b64_tr_b16 v[116:117], v174 offset:3840
    ds_read_b64_tr_b16 v[118:119], v174 offset:4032
    ds_read_b128 v[104:107], v194 offset:28672
    ds_read_b64_tr_b16 v[120:121], v174 offset:4608
    ds_read_b64_tr_b16 v[122:123], v174 offset:4800
    ds_read_b128 v[108:111], v195 offset:28672
    ds_read_b64_tr_b16 v[124:125], v174 offset:5376
    ds_read_b64_tr_b16 v[126:127], v174 offset:5568
    s_waitcnt lgkmcnt(9)
    v_mfma_f32_32x32x16_bf16 v[16:31], v[112:115], v[96:99], v[16:31]
    s_waitcnt lgkmcnt(6)
    v_mfma_f32_32x32x16_bf16 v[16:31], v[116:119], v[100:103], v[16:31]
    s_waitcnt lgkmcnt(3)
    v_mfma_f32_32x32x16_bf16 v[16:31], v[120:123], v[104:107], v[16:31]
    s_waitcnt lgkmcnt(0)
    v_mfma_f32_32x32x16_bf16 v[16:31], v[124:127], v[108:111], v[16:31]
    s_branch L_con_kvD
L_con_kvV:
    s_cmp_eq_u32 s35, 0
    s_cbranch_scc0 L_con_kv2V
    s_waitcnt vmcnt(8)
    ds_read_b128 v[128:131], v192 offset:45056
    ds_read_b64_tr_b16 v[144:145], v174 offset:6144
    ds_read_b64_tr_b16 v[146:147], v174 offset:6336
    ds_read_b128 v[132:135], v193 offset:45056
    ds_read_b64_tr_b16 v[148:149], v174 offset:6912
    ds_read_b64_tr_b16 v[150:151], v174 offset:7104
    ds_read_b128 v[136:139], v194 offset:45056
    ds_read_b64_tr_b16 v[152:153], v174 offset:7680
    ds_read_b64_tr_b16 v[154:155], v174 offset:7872
    ds_read_b128 v[140:143], v195 offset:45056
    ds_read_b64_tr_b16 v[156:157], v174 offset:8448
    ds_read_b64_tr_b16 v[158:159], v174 offset:8640
    s_waitcnt lgkmcnt(9)
    v_mfma_f32_32x32x16_bf16 v[16:31], v[128:131], v[144:147], v[16:31]
    s_waitcnt lgkmcnt(6)
    v_mfma_f32_32x32x16_bf16 v[16:31], v[132:135], v[148:151], v[16:31]
    s_waitcnt lgkmcnt(3)
    v_mfma_f32_32x32x16_bf16 v[16:31], v[136:139], v[152:155], v[16:31]
    s_waitcnt lgkmcnt(0)
    v_mfma_f32_32x32x16_bf16 v[16:31], v[140:143], v[156:159], v[16:31]
L_con_kv2V:
    s_waitcnt vmcnt(8)
    ds_read_b128 v[64:67], v192 offset:12288
    ds_read_b64_tr_b16 v[80:81], v174 offset:0
    ds_read_b64_tr_b16 v[82:83], v174 offset:192
    ds_read_b128 v[68:71], v193 offset:12288
    ds_read_b64_tr_b16 v[84:85], v174 offset:768
    ds_read_b64_tr_b16 v[86:87], v174 offset:960
    ds_read_b128 v[72:75], v194 offset:12288
    ds_read_b64_tr_b16 v[88:89], v174 offset:1536
    ds_read_b64_tr_b16 v[90:91], v174 offset:1728
    ds_read_b128 v[76:79], v195 offset:12288
    ds_read_b64_tr_b16 v[92:93], v174 offset:2304
    ds_read_b64_tr_b16 v[94:95], v174 offset:2496
    s_waitcnt lgkmcnt(9)
    v_mfma_f32_32x32x16_bf16 v[16:31], v[64:67], v[80:83], v[16:31]
    s_waitcnt lgkmcnt(6)
    v_mfma_f32_32x32x16_bf16 v[16:31], v[68:71], v[84:87], v[16:31]
    s_waitcnt lgkmcnt(3)
    v_mfma_f32_32x32x16_bf16 v[16:31], v[72:75], v[88:91], v[16:31]
    s_waitcnt lgkmcnt(0)
    v_mfma_f32_32x32x16_bf16 v[16:31], v[76:79], v[92:95], v[16:31]
    s_waitcnt vmcnt(0)
    ds_read_b128 v[96:99], v192 offset:28672
    ds_read_b64_tr_b16 v[112:113], v174 offset:3072
    ds_read_b64_tr_b16 v[114:115], v174 offset:3264
    ds_read_b128 v[100:103], v193 offset:28672
    ds_read_b64_tr_b16 v[116:117], v174 offset:3840
    ds_read_b64_tr_b16 v[118:119], v174 offset:4032
    ds_read_b128 v[104:107], v194 offset:28672
    ds_read_b64_tr_b16 v[120:121], v174 offset:4608
    ds_read_b64_tr_b16 v[122:123], v174 offset:4800
    ds_read_b128 v[108:111], v195 offset:28672
    ds_read_b64_tr_b16 v[124:125], v174 offset:5376
    ds_read_b64_tr_b16 v[126:127], v174 offset:5568
    s_waitcnt lgkmcnt(9)
    v_mfma_f32_32x32x16_bf16 v[16:31], v[96:99], v[112:115], v[16:31]
    s_waitcnt lgkmcnt(6)
    v_mfma_f32_32x32x16_bf16 v[16:31], v[100:103], v[116:119], v[16:31]
    s_waitcnt lgkmcnt(3)
    v_mfma_f32_32x32x16_bf16 v[16:31], v[104:107], v[120:123], v[16:31]
    s_waitcnt lgkmcnt(0)
    v_mfma_f32_32x32x16_bf16 v[16:31], v[108:111], v[124:127], v[16:31]
L_con_kvD:
    s_nop 7
    s_nop 3
    ds_write_b128 v175, v[16:19] offset:0
    ds_write_b128 v175, v[20:23] offset:1024
    ds_write_b128 v175, v[24:27] offset:2048
    ds_write_b128 v175, v[28:31] offset:3072
    v_readfirstlane_b32 s74, v180
    s_waitcnt lgkmcnt(0)
    s_barrier
    s_add_u32 s74, s74, 2654435761
    s_cmp_ge_u32 s35, 2
    s_cbranch_scc1 L_con_kvF
    s_lshl_b32 s36, s35, 11
    v_lshl_add_u32 v11, v1, 4, s36
    v_add_u32 v12, 75776, v11
    ds_read_b128 v[112:115], v12 offset:6144
    ds_read_b128 v[116:119], v11 offset:0
    ds_read_b128 v[120:123], v11 offset:6144
    ds_read_b128 v[124:127], v12 offset:0
    ds_read_b128 v[128:131], v12 offset:7168
    ds_read_b128 v[132:135], v11 offset:1024
    ds_read_b128 v[136:139], v11 offset:7168
    ds_read_b128 v[140:143], v12 offset:1024
    s_lshr_b32 s36, s34, 1
    s_lshl_b32 s37, s33, 1
    s_add_u32 s36, s36, s37
    s_lshr_b32 s37, s36, 2
    s_mul_i32 s37, s37, 9472
    s_and_b32 s36, s36, 3
    s_mul_i32 s39, s36, 2240
    s_add_u32 s39, s39, s37
    s_add_u32 s39, s39, 512
    s_bitcmp1_b32 s34, 0
    s_cbranch_scc1 L_con_kvFV
    v_and_b32 v11, 0x13, v10
    v_bfe_u32 v12, v10, 2, 1
    v_lshl_or_b32 v11, v12, 3, v11
    v_bfe_u32 v12, v10, 3, 1
    v_lshl_or_b32 v11, v12, 2, v11
    s_mov_b32 s40, 1051597459
    s_waitcnt lgkmcnt(6)
    v_pk_add_f32 v[112:113], v[112:113], v[116:117]
    v_pk_add_f32 v[114:115], v[114:115], v[118:119]
    s_waitcnt lgkmcnt(4)
    v_pk_add_f32 v[120:121], v[120:121], v[124:125]
    v_pk_add_f32 v[122:123], v[122:123], v[126:127]
    v_pk_add_f32 v[112:113], v[112:113], v[120:121]
    v_pk_add_f32 v[114:115], v[114:115], v[122:123]
    v_mul_f32 v112, s40, v112
    v_mul_f32 v113, s40, v113
    v_mul_f32 v114, s40, v114
    v_mul_f32 v115, s40, v115
    v_cvt_pk_bf16_f32 v144, v112, v113
    v_cvt_pk_bf16_f32 v145, v114, v115
    s_waitcnt lgkmcnt(2)
    v_pk_add_f32 v[128:129], v[128:129], v[132:133]
    v_pk_add_f32 v[130:131], v[130:131], v[134:135]
    s_waitcnt lgkmcnt(0)
    v_pk_add_f32 v[136:137], v[136:137], v[140:141]
    v_pk_add_f32 v[138:139], v[138:139], v[142:143]
    v_pk_add_f32 v[128:129], v[128:129], v[136:137]
    v_pk_add_f32 v[130:131], v[130:131], v[138:139]
    v_mul_f32 v128, s40, v128
    v_mul_f32 v129, s40, v129
    v_mul_f32 v130, s40, v130
    v_mul_f32 v131, s40, v131
    v_cvt_pk_bf16_f32 v146, v128, v129
    v_cvt_pk_bf16_f32 v147, v130, v131
    s_cmp_eq_u32 s35, 1
    s_cbranch_scc1 L_con_kvK2
    v_lshl_add_u32 v11, v6, 5, v11
    v_lshlrev_b32 v11, 4, v11
    buffer_store_dwordx4 v[144:147], v11, s[16:19], s39 offen sc1
    s_branch L_con_kvF
L_con_kvK2:
    v_lshlrev_b32 v11, 2, v11
    s_lshr_b32 s3, s36, 1
    s_lshl_b32 s3, s3, 7
    s_and_b32 s36, s36, 1
    s_lshl_b32 s36, s36, 8
    s_add_u32 s37, s37, s3
    s_add_u32 s37, s37, s36
    s_mov_b32 exec_hi, 0
    buffer_store_dword v144, v11, s[16:19], s37 offen sc1
    s_mov_b64 exec, -1
    s_branch L_con_kvF
L_con_kvFV:
    v_cmp_eq_u32 vcc, 18, v10
    v_mov_b32 v12, 0x3f803f80
    s_movk_i32 s36, 304
    v_lshlrev_b32 v11, 4, v10
    v_mad_u32_u24 v11, v6, s36, v11
    s_mul_i32 s38, s35, 608
    s_add_u32 s39, s39, s38
    s_waitcnt lgkmcnt(6)
    v_pk_add_f32 v[112:113], v[112:113], v[116:117]
    v_pk_add_f32 v[114:115], v[114:115], v[118:119]
    s_waitcnt lgkmcnt(4)
    v_pk_add_f32 v[120:121], v[120:121], v[124:125]
    v_pk_add_f32 v[122:123], v[122:123], v[126:127]
    v_pk_add_f32 v[112:113], v[112:113], v[120:121]
    v_pk_add_f32 v[114:115], v[114:115], v[122:123]
    v_cvt_pk_bf16_f32 v144, v112, v113
    v_cvt_pk_bf16_f32 v145, v114, v115
    s_waitcnt lgkmcnt(2)
    v_pk_add_f32 v[128:129], v[128:129], v[132:133]
    v_pk_add_f32 v[130:131], v[130:131], v[134:135]
    s_waitcnt lgkmcnt(0)
    v_pk_add_f32 v[136:137], v[136:137], v[140:141]
    v_pk_add_f32 v[138:139], v[138:139], v[142:143]
    v_pk_add_f32 v[128:129], v[128:129], v[136:137]
    v_pk_add_f32 v[130:131], v[130:131], v[138:139]
    v_cvt_pk_bf16_f32 v146, v128, v129
    v_cvt_pk_bf16_f32 v147, v130, v131
    v_cndmask_b32 v144, v144, v12, vcc
    v_cndmask_b32 v145, v145, v12, vcc
    v_cndmask_b32 v146, v146, v12, vcc
    v_cndmask_b32 v147, v147, v12, vcc
    s_mov_b32 exec_lo, 0x7ffff
    s_mov_b32 exec_hi, 0x7ffff
    buffer_store_dwordx4 v[144:147], v11, s[16:19], s39 offen offset:1024 sc1
    s_mov_b64 exec, -1
L_con_kvF:
    s_barrier
    ds_read_b64_tr_b16 v[72:73], v168 offset:0
    ds_read_b64_tr_b16 v[74:75], v168 offset:288
    ds_read_b128 v[64:67], v160 offset:12288
    ds_read_b128 v[68:71], v164 offset:0
    ds_read_b64_tr_b16 v[84:85], v168 offset:4608
    ds_read_b64_tr_b16 v[86:87], v168 offset:4896
    ds_read_b128 v[76:79], v161 offset:12288
    ds_read_b128 v[80:83], v165 offset:0
    ds_read_b64_tr_b16 v[96:97], v168 offset:9216
    ds_read_b64_tr_b16 v[98:99], v168 offset:9504
    ds_read_b128 v[88:91], v162 offset:12288
    ds_read_b128 v[92:95], v166 offset:0
    s_waitcnt lgkmcnt(8)
    ds_read_b64_tr_b16 v[108:109], v168 offset:13824
    ds_read_b64_tr_b16 v[110:111], v168 offset:14112
    ds_read_b128 v[100:103], v163 offset:12288
    ds_read_b128 v[104:107], v167 offset:0
    s_waitcnt lgkmcnt(0)
    s_barrier
    v_mfma_f32_32x32x16_bf16 v[16:31], v[72:75], v[64:67], 0
    ds_read_b64_tr_b16 v[120:121], v168 offset:41984
    ds_read_b64_tr_b16 v[122:123], v168 offset:42272
    ds_read_b128 v[112:115], v160 offset:16384
    v_mfma_f32_32x32x16_bf16 v[32:47], v[72:75], v[68:71], 0
    ds_read_b128 v[116:119], v164 offset:41984
    ds_read_b64_tr_b16 v[132:133], v168 offset:46592
    ds_read_b64_tr_b16 v[134:135], v168 offset:46880
    v_mfma_f32_32x32x16_bf16 v[16:31], v[84:87], v[76:79], v[16:31]
    ds_read_b128 v[124:127], v161 offset:16384
    ds_read_b128 v[128:131], v165 offset:41984
    ds_read_b64_tr_b16 v[144:145], v168 offset:51200
    v_mfma_f32_32x32x16_bf16 v[32:47], v[84:87], v[80:83], v[32:47]
    ds_read_b64_tr_b16 v[146:147], v168 offset:51488
    ds_read_b128 v[136:139], v162 offset:16384
    ds_read_b128 v[140:143], v166 offset:41984
    v_mfma_f32_32x32x16_bf16 v[16:31], v[96:99], v[88:91], v[16:31]
    s_waitcnt lgkmcnt(8)
    ds_read_b64_tr_b16 v[156:157], v168 offset:55808
    ds_read_b64_tr_b16 v[158:159], v168 offset:56096
    ds_read_b128 v[148:151], v163 offset:16384
    ds_read_b128 v[152:155], v167 offset:41984
    v_mfma_f32_32x32x16_bf16 v[32:47], v[96:99], v[92:95], v[32:47]
    v_mfma_f32_32x32x16_bf16 v[16:31], v[108:111], v[100:103], v[16:31]
    v_mfma_f32_32x32x16_bf16 v[32:47], v[108:111], v[104:107], v[32:47]
    s_waitcnt vmcnt(0) lgkmcnt(0)
    s_barrier
    s_cmp_eq_u32 s35, 0
    s_cbranch_scc0 L_con_nokvf
    s_lshl_b32 s36, s33, 2
    s_add_u32 s36, s36, s34
    s_lshl_b32 s3, s32, 7
    s_add_u32 s36, s36, s3
    s_lshl_b32 s36, s36, 7
    v_mov_b32 v11, s74
    v_mov_b32 v12, 0
    s_mov_b32 exec_lo, 1
    s_mov_b32 exec_hi, 0
    buffer_store_dword v11, v12, s[28:31], s36 offen sc1
    s_mov_b64 exec, -1
L_con_nokvf:
    v_mfma_f32_32x32x16_bf16 v[16:31], v[120:123], v[112:115], v[16:31]
    ds_read_b64_tr_b16 v[72:73], v188 offset:0
    ds_read_b64_tr_b16 v[74:75], v188 offset:288
    ds_read_b128 v[64:67], v160 offset:20480
    v_mfma_f32_32x32x16_bf16 v[32:47], v[120:123], v[116:119], v[32:47]
    ds_read_b128 v[68:71], v164 offset:64512
    ds_read_b64_tr_b16 v[84:85], v188 offset:4608
    ds_read_b64_tr_b16 v[86:87], v188 offset:4896
    v_mfma_f32_32x32x16_bf16 v[16:31], v[132:135], v[124:127], v[16:31]
    ds_read_b128 v[76:79], v161 offset:20480
    ds_read_b128 v[80:83], v165 offset:64512
    ds_read_b64_tr_b16 v[96:97], v188 offset:9216
    v_mfma_f32_32x32x16_bf16 v[32:47], v[132:135], v[128:131], v[32:47]
    ds_read_b64_tr_b16 v[98:99], v188 offset:9504
    ds_read_b128 v[88:91], v162 offset:20480
    ds_read_b128 v[92:95], v166 offset:64512
    v_mfma_f32_32x32x16_bf16 v[16:31], v[144:147], v[136:139], v[16:31]
    s_waitcnt lgkmcnt(8)
    ds_read_b64_tr_b16 v[108:109], v188 offset:13824
    ds_read_b64_tr_b16 v[110:111], v188 offset:14112
    ds_read_b128 v[100:103], v163 offset:20480
    ds_read_b128 v[104:107], v167 offset:64512
    v_mfma_f32_32x32x16_bf16 v[32:47], v[144:147], v[140:143], v[32:47]
    v_mfma_f32_32x32x16_bf16 v[16:31], v[156:159], v[148:151], v[16:31]
    v_mfma_f32_32x32x16_bf16 v[32:47], v[156:159], v[152:155], v[32:47]
    s_waitcnt lgkmcnt(0)
    s_barrier
    v_mfma_f32_32x32x16_bf16 v[16:31], v[72:75], v[64:67], v[16:31]
    ds_read_b64_tr_b16 v[120:121], v188 offset:22528
    ds_read_b64_tr_b16 v[122:123], v188 offset:22816
    ds_read_b128 v[112:115], v160 offset:24576
    v_mfma_f32_32x32x16_bf16 v[32:47], v[72:75], v[68:71], v[32:47]
    ds_read_b128 v[116:119], v184
    ds_read_b64_tr_b16 v[132:133], v188 offset:27136
    ds_read_b64_tr_b16 v[134:135], v188 offset:27424
    v_mfma_f32_32x32x16_bf16 v[16:31], v[84:87], v[76:79], v[16:31]
    ds_read_b128 v[124:127], v161 offset:24576
    ds_read_b128 v[128:131], v185
    ds_read_b64_tr_b16 v[144:145], v188 offset:31744
    v_mfma_f32_32x32x16_bf16 v[32:47], v[84:87], v[80:83], v[32:47]
    ds_read_b64_tr_b16 v[146:147], v188 offset:32032
    ds_read_b128 v[136:139], v162 offset:24576
    ds_read_b128 v[140:143], v186
    v_mfma_f32_32x32x16_bf16 v[16:31], v[96:99], v[88:91], v[16:31]
    s_waitcnt lgkmcnt(8)
    ds_read_b64_tr_b16 v[156:157], v188 offset:36352
    ds_read_b64_tr_b16 v[158:159], v188 offset:36640
    ds_read_b128 v[148:151], v163 offset:24576
    ds_read_b128 v[152:155], v187
    v_mfma_f32_32x32x16_bf16 v[32:47], v[96:99], v[92:95], v[32:47]
    v_mfma_f32_32x32x16_bf16 v[16:31], v[108:111], v[100:103], v[16:31]
    v_mfma_f32_32x32x16_bf16 v[32:47], v[108:111], v[104:107], v[32:47]
    s_lshr_b32 s38, s35, 2
    s_mul_i32 s38, s38, 75776
    v_lshl_add_u32 v3, v1, 4, s38
    v_lshl_add_u32 v4, v10, 2, s38
    v_and_b32 v206, 0x13, v10
    v_bfe_u32 v207, v10, 2, 1
    v_lshl_or_b32 v206, v207, 3, v206
    v_bfe_u32 v207, v10, 3, 1
    v_lshl_or_b32 v206, v207, 2, v206
    v_mov_b32 v207, 0x4000
    v_cmp_lt_u32 vcc, 16, v10
    s_nop 1
    v_cndmask_b32 v206, v206, v207, vcc
    v_cmp_eq_u32 vcc, 20, v10
    s_nop 1
    v_cndmask_b32 v206, v206, 17, vcc
    v_and_b32 v207, 0x1b, v10
    v_cmp_eq_u32 vcc, 17, v207
    s_nop 1
    v_cndmask_b32 v206, v206, 18, vcc
    s_movk_i32 s39, 304
    v_lshl_add_u32 v206, v206, 4, s38
    v_mad_u32_u24 v5, v6, s39, v206
    v_mov_b32 v2, 0xdddddddd
    v_lshlrev_b32 v15, 4, v1
    v_add_u32 v212, 37888, v3
    v_add_u32 v213, 37888, v5
    v_add_u32 v214, 128, v4
    v_add_u32 v215, 37888, v4
    v_add_u32 v216, 38016, v4
    s_waitcnt lgkmcnt(0)
    s_barrier
    v_mfma_f32_32x32x16_bf16 v[16:31], v[120:123], v[112:115], v[16:31]
    ds_read_b64_tr_b16 v[72:73], v168 offset:0
    ds_read_b64_tr_b16 v[74:75], v168 offset:288
    ds_read_b128 v[64:67], v160 offset:28672
    v_mfma_f32_32x32x16_bf16 v[32:47], v[120:123], v[116:119], v[32:47]
    ds_read_b128 v[68:71], v164 offset:0
    ds_read_b64_tr_b16 v[84:85], v168 offset:4608
    ds_read_b64_tr_b16 v[86:87], v168 offset:4896
    v_mfma_f32_32x32x16_bf16 v[16:31], v[132:135], v[124:127], v[16:31]
    ds_read_b128 v[76:79], v161 offset:28672
    ds_read_b128 v[80:83], v165 offset:0
    ds_read_b64_tr_b16 v[96:97], v168 offset:9216
    v_mfma_f32_32x32x16_bf16 v[32:47], v[132:135], v[128:131], v[32:47]
    ds_read_b64_tr_b16 v[98:99], v168 offset:9504
    ds_read_b128 v[88:91], v162 offset:28672
    ds_read_b128 v[92:95], v166 offset:0
    v_mfma_f32_32x32x16_bf16 v[16:31], v[144:147], v[136:139], v[16:31]
    s_waitcnt lgkmcnt(8)
    ds_read_b64_tr_b16 v[108:109], v168 offset:13824
    ds_read_b64_tr_b16 v[110:111], v168 offset:14112
    ds_read_b128 v[100:103], v163 offset:28672
    ds_read_b128 v[104:107], v167 offset:0
    v_mfma_f32_32x32x16_bf16 v[32:47], v[144:147], v[140:143], v[32:47]
    v_mfma_f32_32x32x16_bf16 v[16:31], v[156:159], v[148:151], v[16:31]
    v_mfma_f32_32x32x16_bf16 v[32:47], v[156:159], v[152:155], v[32:47]
    s_and_b32 s39, s35, 3
    s_mul_i32 s39, s39, 72
    s_add_u32 s39, s39, 144896
    s_movk_i32 s40, 296
    s_cmp_ge_u32 s35, 4
    s_cselect_b32 s38, 0, 9472
    s_sub_u32 s3, 9472, s38
    v_mov_b32 v206, s39
    v_mad_u32_u24 v206, v10, s40, v206
    v_lshl_add_u32 v207, v6, 4, v206
    v_add_u32 v197, s38, v207
    v_add_u32 v198, s3, v207
    v_mad_u32_u24 v206, v6, 36, v206
    v_add_u32 v196, s38, v206
    v_add_u32 v207, s3, v206
    v_lshlrev_b32 v206, 20, v6
    v_add_u32 v199, v206, v196
    v_xor_b32 v206, 0x100000, v206
    v_add_u32 v205, v206, v196
    v_mov_b32 v201, 0
    v_mov_b32 v203, 0
    s_waitcnt lgkmcnt(0)
    s_barrier
    v_mfma_f32_32x32x16_bf16 v[16:31], v[72:75], v[64:67], v[16:31]
    ds_read_b64_tr_b16 v[120:121], v168 offset:41984
    ds_read_b64_tr_b16 v[122:123], v168 offset:42272
    ds_read_b128 v[112:115], v160 offset:32768
    v_mfma_f32_32x32x16_bf16 v[32:47], v[72:75], v[68:71], v[32:47]
    ds_read_b128 v[116:119], v164 offset:41984
    ds_read_b64_tr_b16 v[132:133], v168 offset:46592
    ds_read_b64_tr_b16 v[134:135], v168 offset:46880
    v_mfma_f32_32x32x16_bf16 v[16:31], v[84:87], v[76:79], v[16:31]
    ds_read_b128 v[124:127], v161 offset:32768
    ds_read_b128 v[128:131], v165 offset:41984
    ds_read_b64_tr_b16 v[144:145], v168 offset:51200
    v_mfma_f32_32x32x16_bf16 v[32:47], v[84:87], v[80:83], v[32:47]
    ds_read_b64_tr_b16 v[146:147], v168 offset:51488
    ds_read_b128 v[136:139], v162 offset:32768
    ds_read_b128 v[140:143], v166 offset:41984
    v_mfma_f32_32x32x16_bf16 v[16:31], v[96:99], v[88:91], v[16:31]
    s_waitcnt lgkmcnt(8)
    ds_read_b64_tr_b16 v[156:157], v168 offset:55808
    ds_read_b64_tr_b16 v[158:159], v168 offset:56096
    ds_read_b128 v[148:151], v163 offset:32768
    ds_read_b128 v[152:155], v167 offset:41984
    v_mfma_f32_32x32x16_bf16 v[32:47], v[96:99], v[92:95], v[32:47]
    v_mfma_f32_32x32x16_bf16 v[16:31], v[108:111], v[100:103], v[16:31]
    v_mfma_f32_32x32x16_bf16 v[32:47], v[108:111], v[104:107], v[32:47]
    v_lshrrev_b32 v221, 3, v1
    v_and_b32 v222, 7, v1
    v_bfe_u32 v223, v1, 4, 1
    v_lshlrev_b32 v223, 1, v223
    v_xor_b32 v222, v222, v223
    v_lshlrev_b32 v222, 4, v222
    v_mul_u32_u24 v221, 0x480, v221
    v_add_u32 v217, v221, v222
    v_mad_u32_u24 v218, v221, 18, v222
    v_lshrrev_b32 v221, 2, v1
    v_and_b32 v222, 3, v1
    v_lshlrev_b32 v222, 4, v222
    v_and_b32 v223, 7, v221
    v_mul_u32_u24 v223, 18, v223
    v_lshrrev_b32 v224, 5, v1
    v_add_u32 v223, v223, v224
    v_mul_u32_u24 v223, 0x480, v223
    v_add_u32 v220, v223, v222
    v_mul_u32_u24 v221, 0x480, v221
    v_add_u32 v219, v221, v222
    s_waitcnt lgkmcnt(0)
    s_barrier
    v_mfma_f32_32x32x16_bf16 v[16:31], v[120:123], v[112:115], v[16:31]
    ds_read_b64_tr_b16 v[72:73], v188 offset:0
    ds_read_b64_tr_b16 v[74:75], v188 offset:288
    ds_read_b128 v[64:67], v160 offset:36864
    v_mfma_f32_32x32x16_bf16 v[32:47], v[120:123], v[116:119], v[32:47]
    ds_read_b128 v[68:71], v164 offset:64512
    ds_read_b64_tr_b16 v[84:85], v188 offset:4608
    ds_read_b64_tr_b16 v[86:87], v188 offset:4896
    v_mfma_f32_32x32x16_bf16 v[16:31], v[132:135], v[124:127], v[16:31]
    ds_read_b128 v[76:79], v161 offset:36864
    ds_read_b128 v[80:83], v165 offset:64512
    ds_read_b64_tr_b16 v[96:97], v188 offset:9216
    v_mfma_f32_32x32x16_bf16 v[32:47], v[132:135], v[128:131], v[32:47]
    ds_read_b64_tr_b16 v[98:99], v188 offset:9504
    ds_read_b128 v[88:91], v162 offset:36864
    ds_read_b128 v[92:95], v166 offset:64512
    v_mfma_f32_32x32x16_bf16 v[16:31], v[144:147], v[136:139], v[16:31]
    s_waitcnt lgkmcnt(8)
    ds_read_b64_tr_b16 v[108:109], v188 offset:13824
    ds_read_b64_tr_b16 v[110:111], v188 offset:14112
    ds_read_b128 v[100:103], v163 offset:36864
    ds_read_b128 v[104:107], v167 offset:64512
    v_mfma_f32_32x32x16_bf16 v[32:47], v[144:147], v[140:143], v[32:47]
    v_mfma_f32_32x32x16_bf16 v[16:31], v[156:159], v[148:151], v[16:31]
    v_mfma_f32_32x32x16_bf16 v[32:47], v[156:159], v[152:155], v[32:47]
    s_waitcnt lgkmcnt(0)
    s_barrier
    v_mfma_f32_32x32x16_bf16 v[16:31], v[72:75], v[64:67], v[16:31]
    ds_read_b64_tr_b16 v[120:121], v188 offset:22528
    ds_read_b64_tr_b16 v[122:123], v188 offset:22816
    ds_read_b128 v[112:115], v160 offset:40960
    v_mfma_f32_32x32x16_bf16 v[32:47], v[72:75], v[68:71], v[32:47]
    ds_read_b128 v[116:119], v184
    ds_read_b64_tr_b16 v[132:133], v188 offset:27136
    ds_read_b64_tr_b16 v[134:135], v188 offset:27424
    v_mfma_f32_32x32x16_bf16 v[16:31], v[84:87], v[76:79], v[16:31]
    ds_read_b128 v[124:127], v161 offset:40960
    ds_read_b128 v[128:131], v185
    ds_read_b64_tr_b16 v[144:145], v188 offset:31744
    v_mfma_f32_32x32x16_bf16 v[32:47], v[84:87], v[80:83], v[32:47]
    ds_read_b64_tr_b16 v[146:147], v188 offset:32032
    ds_read_b128 v[136:139], v162 offset:40960
    ds_read_b128 v[140:143], v186
    v_mfma_f32_32x32x16_bf16 v[16:31], v[96:99], v[88:91], v[16:31]
    s_waitcnt lgkmcnt(8)
    ds_read_b64_tr_b16 v[156:157], v188 offset:36352
    ds_read_b64_tr_b16 v[158:159], v188 offset:36640
    ds_read_b128 v[148:151], v163 offset:40960
    ds_read_b128 v[152:155], v187
    v_mfma_f32_32x32x16_bf16 v[32:47], v[96:99], v[92:95], v[32:47]
    v_mfma_f32_32x32x16_bf16 v[16:31], v[108:111], v[100:103], v[16:31]
    v_mfma_f32_32x32x16_bf16 v[32:47], v[108:111], v[104:107], v[32:47]
    s_waitcnt lgkmcnt(0)
    s_barrier
    v_mov_b32 v13, 71680
    ds_read_b128 v[208:211], v13
    v_mfma_f32_32x32x16_bf16 v[16:31], v[120:123], v[112:115], v[16:31]
    ds_read_b64_tr_b16 v[72:73], v168 offset:0
    ds_read_b64_tr_b16 v[74:75], v168 offset:288
    ds_read_b128 v[64:67], v160 offset:45056
    v_mfma_f32_32x32x16_bf16 v[32:47], v[120:123], v[116:119], v[32:47]
    ds_read_b128 v[68:71], v164 offset:0
    ds_read_b64_tr_b16 v[84:85], v168 offset:4608
    ds_read_b64_tr_b16 v[86:87], v168 offset:4896
    v_mfma_f32_32x32x16_bf16 v[16:31], v[132:135], v[124:127], v[16:31]
    ds_read_b128 v[76:79], v161 offset:45056
    ds_read_b128 v[80:83], v165 offset:0
    ds_read_b64_tr_b16 v[96:97], v168 offset:9216
    v_mfma_f32_32x32x16_bf16 v[32:47], v[132:135], v[128:131], v[32:47]
    ds_read_b64_tr_b16 v[98:99], v168 offset:9504
    ds_read_b128 v[88:91], v162 offset:45056
    ds_read_b128 v[92:95], v166 offset:0
    v_mfma_f32_32x32x16_bf16 v[16:31], v[144:147], v[136:139], v[16:31]
    s_waitcnt lgkmcnt(8)
    ds_read_b64_tr_b16 v[108:109], v168 offset:13824
    ds_read_b64_tr_b16 v[110:111], v168 offset:14112
    ds_read_b128 v[100:103], v163 offset:45056
    ds_read_b128 v[104:107], v167 offset:0
    v_mfma_f32_32x32x16_bf16 v[32:47], v[144:147], v[140:143], v[32:47]
    v_mfma_f32_32x32x16_bf16 v[16:31], v[156:159], v[148:151], v[16:31]
    v_mfma_f32_32x32x16_bf16 v[32:47], v[156:159], v[152:155], v[32:47]
    v_and_b32 v208, v208, v209
    v_and_b32 v210, v210, v211
    v_and_b32 v208, v208, v210
    s_nop 0
    v_readfirstlane_b32 s51, v208
    s_nop 0
    s_movk_i32 s38, 296
    s_lshr_b32 s36, s34, 1
    s_waitcnt lgkmcnt(8)
    v_mfma_f32_32x32x16_bf16 v[16:31], v[72:75], v[64:67], v[16:31]
    v_mfma_f32_32x32x16_bf16 v[32:47], v[72:75], v[68:71], v[32:47]
    s_waitcnt lgkmcnt(8)
    v_mfma_f32_32x32x16_bf16 v[16:31], v[84:87], v[76:79], v[16:31]
    v_mfma_f32_32x32x16_bf16 v[32:47], v[84:87], v[80:83], v[32:47]
    s_waitcnt lgkmcnt(4)
    v_mfma_f32_32x32x16_bf16 v[16:31], v[96:99], v[88:91], v[16:31]
    v_mfma_f32_32x32x16_bf16 v[32:47], v[96:99], v[92:95], v[32:47]
    s_waitcnt lgkmcnt(0)
    v_mfma_f32_32x32x16_bf16 v[16:31], v[108:111], v[100:103], v[16:31]
    v_mfma_f32_32x32x16_bf16 v[32:47], v[108:111], v[104:107], v[32:47]
    s_mul_i32 s36, s36, 9472
    s_lshl_b32 s37, s35, 6
    s_add_u32 s37, s37, 144896
    v_lshl_add_u32 v11, v6, 3, s37
    v_mad_u32_u24 v11, v10, s38, v11
    s_sub_u32 s37, 9472, s36
    v_add_u32 v12, s37, v11
    v_add_u32 v11, s36, v11
    s_nop 2
    v_cvt_pk_bf16_f32 v112, v16, v17
    v_cvt_pk_bf16_f32 v113, v18, v19
    ds_write_b64 v11, v[112:113] offset:0
    v_cvt_pk_bf16_f32 v114, v20, v21
    v_cvt_pk_bf16_f32 v115, v22, v23
    ds_write_b64 v11, v[114:115] offset:16
    v_cvt_pk_bf16_f32 v116, v24, v25
    v_cvt_pk_bf16_f32 v117, v26, v27
    ds_write_b64 v11, v[116:117] offset:32
    v_cvt_pk_bf16_f32 v118, v28, v29
    v_cvt_pk_bf16_f32 v119, v30, v31
    ds_write_b64 v11, v[118:119] offset:48
    v_cvt_pk_bf16_f32 v120, v32, v33
    v_cvt_pk_bf16_f32 v121, v34, v35
    ds_write_b64 v12, v[120:121] offset:0
    v_cvt_pk_bf16_f32 v122, v36, v37
    v_cvt_pk_bf16_f32 v123, v38, v39
    ds_write_b64 v12, v[122:123] offset:16
    v_cvt_pk_bf16_f32 v124, v40, v41
    v_cvt_pk_bf16_f32 v125, v42, v43
    ds_write_b64 v12, v[124:125] offset:32
    v_cvt_pk_bf16_f32 v126, v44, v45
    v_cvt_pk_bf16_f32 v127, v46, v47
    ds_write_b64 v12, v[126:127] offset:48
    s_branch L_con_pro_done
L_con_rest1:
    s_barrier
    s_mul_i32 s44, s75, 73728
    s_add_u32 m0, s58, 113664
    s_add_u32 s44, s44, s56
    buffer_load_dwordx4 v176, s[8:11], s44 offen lds
    s_add_u32 m0, s58, 117760
    s_add_u32 s45, s44, 36864
    buffer_load_dwordx4 v177, s[8:11], s44 offen lds
    s_add_u32 m0, s59, 113664
    s_mov_b64 exec, s[46:47]
    buffer_load_dwordx4 v178, s[8:11], s44 offen lds
    s_mov_b64 exec, -1
    s_add_u32 m0, s58, 122880
    s_lshl_b32 s44, s75, 7
    buffer_load_dwordx4 v176, s[8:11], s45 offen lds
    s_add_u32 m0, s58, 126976
    s_add_u32 s44, s44, s57
    buffer_load_dwordx4 v177, s[8:11], s45 offen lds
    s_add_u32 m0, s58, 132096
    s_add_u32 s75, s75, 1
    buffer_load_dwordx4 v179, s[4:7], s44 offen lds
    s_cmp_ge_u32 s75, 9
    s_cselect_b32 s75, 0, s75
    s_waitcnt vmcnt(12)
    v_readfirstlane_b32 s74, v180
    s_barrier
    s_add_u32 s74, s74, 2654435761
    s_mul_i32 s44, s75, 73728
    s_add_u32 m0, s58, 136192
    s_add_u32 s44, s44, s56
    buffer_load_dwordx4 v176, s[8:11], s44 offen lds
    s_add_u32 m0, s58, 140288
    s_add_u32 s45, s44, 36864
    buffer_load_dwordx4 v177, s[8:11], s44 offen lds
    s_add_u32 m0, s59, 136192
    s_mov_b64 exec, s[46:47]
    buffer_load_dwordx4 v178, s[8:11], s44 offen lds
    s_mov_b64 exec, -1
    s_add_u32 m0, s58, 145408
    s_lshl_b32 s44, s75, 7
    buffer_load_dwordx4 v176, s[8:11], s45 offen lds
    s_add_u32 m0, s58, 149504
    s_add_u32 s44, s44, s57
    buffer_load_dwordx4 v177, s[8:11], s45 offen lds
    s_add_u32 m0, s58, 154624
    s_add_u32 s75, s75, 1
    buffer_load_dwordx4 v179, s[4:7], s44 offen lds
    s_cmp_ge_u32 s75, 9
    s_cselect_b32 s75, 0, s75
    s_mov_b32 s3, 12288
    s_cmp_ge_u32 s35, 6
    s_cselect_b32 s3, 67584, s3
    v_add_u32 v171, s3, v169
    v_add_u32 v172, s3, v170
    ds_read_b128 v[96:99], v171
    ds_read_b64_tr_b16 v[104:105], v173 offset:0
    ds_read_b64_tr_b16 v[106:107], v173 offset:288
    ds_read_b128 v[100:103], v172
    ds_read_b64_tr_b16 v[108:109], v173 offset:9216
    ds_read_b64_tr_b16 v[110:111], v173 offset:9504
    s_waitcnt vmcnt(12) lgkmcnt(0)
    s_barrier
    s_mul_i32 s44, s75, 73728
    s_add_u32 m0, s58, 49152
    s_add_u32 s44, s44, s56
    buffer_load_dwordx4 v176, s[8:11], s44 offen lds
    s_add_u32 m0, s58, 53248
    s_add_u32 s45, s44, 36864
    buffer_load_dwordx4 v177, s[8:11], s44 offen lds
    s_add_u32 m0, s59, 49152
    s_mov_b64 exec, s[46:47]
    buffer_load_dwordx4 v178, s[8:11], s44 offen lds
    s_mov_b64 exec, -1
    s_add_u32 m0, s58, 58368
    s_lshl_b32 s44, s75, 7
    buffer_load_dwordx4 v176, s[8:11], s45 offen lds
    s_add_u32 m0, s58, 62464
    s_add_u32 s44, s44, s57
    buffer_load_dwordx4 v177, s[8:11], s45 offen lds
    s_add_u32 m0, s58, 67584
    s_add_u32 s75, s75, 1
    buffer_load_dwordx4 v179, s[4:7], s44 offen lds
    s_cmp_ge_u32 s75, 9
    s_cselect_b32 s75, 0, s75
    s_mov_b32 s3, 16384
    s_cmp_ge_u32 s35, 6
    s_cselect_b32 s3, 109568, s3
    v_add_u32 v171, s3, v169
    v_add_u32 v172, s3, v170
    ds_read_b128 v[112:115], v171
    ds_read_b64_tr_b16 v[120:121], v173 offset:41984
    ds_read_b64_tr_b16 v[122:123], v173 offset:42272
    ds_read_b128 v[116:119], v172
    ds_read_b64_tr_b16 v[124:125], v173 offset:51200
    ds_read_b64_tr_b16 v[126:127], v173 offset:51488
    v_mfma_f32_16x16x32_bf16 v[48:51], v[104:107], v[96:99], 0
    v_mfma_f32_16x16x32_bf16 v[48:51], v[108:111], v[100:103], v[48:51]
    s_waitcnt vmcnt(12) lgkmcnt(0)
    s_barrier
    s_mul_i32 s44, s75, 73728
    s_add_u32 m0, s58, 91136
    s_add_u32 s44, s44, s56
    buffer_load_dwordx4 v176, s[8:11], s44 offen lds
    s_add_u32 m0, s58, 95232
    s_add_u32 s45, s44, 36864
    buffer_load_dwordx4 v177, s[8:11], s44 offen lds
    s_add_u32 m0, s59, 91136
    s_mov_b64 exec, s[46:47]
    buffer_load_dwordx4 v178, s[8:11], s44 offen lds
    s_mov_b64 exec, -1
    s_add_u32 m0, s58, 100352
    s_lshl_b32 s44, s75, 7
    buffer_load_dwordx4 v176, s[8:11], s45 offen lds
    s_add_u32 m0, s58, 104448
    s_add_u32 s44, s44, s57
    buffer_load_dwordx4 v177, s[8:11], s45 offen lds
    s_add_u32 m0, s58, 109568
    s_add_u32 s75, s75, 1
    buffer_load_dwordx4 v179, s[4:7], s44 offen lds
    s_cmp_ge_u32 s75, 9
    s_cselect_b32 s75, 0, s75
    s_mov_b32 s3, 20480
    s_cmp_ge_u32 s35, 6
    s_cselect_b32 s3, 132096, s3
    v_add_u32 v171, s3, v169
    v_add_u32 v172, s3, v170
    ds_read_b128 v[96:99], v171
    ds_read_b64_tr_b16 v[104:105], v189 offset:0
    ds_read_b64_tr_b16 v[106:107], v189 offset:288
    ds_read_b128 v[100:103], v172
    ds_read_b64_tr_b16 v[108:109], v189 offset:9216
    ds_read_b64_tr_b16 v[110:111], v189 offset:9504
    v_mfma_f32_16x16x32_bf16 v[48:51], v[120:123], v[112:115], v[48:51]
    v_mfma_f32_16x16x32_bf16 v[48:51], v[124:127], v[116:119], v[48:51]
    s_waitcnt vmcnt(12) lgkmcnt(0)
    s_barrier
    s_mul_i32 s44, s75, 73728
    s_add_u32 m0, s58, 113664
    s_add_u32 s44, s44, s56
    buffer_load_dwordx4 v176, s[8:11], s44 offen lds
    s_add_u32 m0, s58, 117760
    s_add_u32 s45, s44, 36864
    buffer_load_dwordx4 v177, s[8:11], s44 offen lds
    s_add_u32 m0, s59, 113664
    s_mov_b64 exec, s[46:47]
    buffer_load_dwordx4 v178, s[8:11], s44 offen lds
    s_mov_b64 exec, -1
    s_add_u32 m0, s58, 122880
    s_lshl_b32 s44, s75, 7
    buffer_load_dwordx4 v176, s[8:11], s45 offen lds
    s_add_u32 m0, s58, 126976
    s_add_u32 s44, s44, s57
    buffer_load_dwordx4 v177, s[8:11], s45 offen lds
    s_add_u32 m0, s58, 132096
    s_add_u32 s75, s75, 1
    buffer_load_dwordx4 v179, s[4:7], s44 offen lds
    s_cmp_ge_u32 s75, 9
    s_cselect_b32 s75, 0, s75
    s_mov_b32 s3, 24576
    s_cmp_ge_u32 s35, 6
    s_cselect_b32 s3, 154624, s3
    v_add_u32 v171, s3, v169
    v_add_u32 v172, s3, v170
    ds_read_b128 v[112:115], v171
    ds_read_b64_tr_b16 v[120:121], v189 offset:22528
    ds_read_b64_tr_b16 v[122:123], v189 offset:22816
    ds_read_b128 v[116:119], v172
    ds_read_b64_tr_b16 v[124:125], v189 offset:31744
    ds_read_b64_tr_b16 v[126:127], v189 offset:32032
    v_mfma_f32_16x16x32_bf16 v[48:51], v[104:107], v[96:99], v[48:51]
    v_mfma_f32_16x16x32_bf16 v[48:51], v[108:111], v[100:103], v[48:51]
    s_waitcnt vmcnt(12) lgkmcnt(0)
    s_barrier
    s_mul_i32 s44, s75, 73728
    s_add_u32 m0, s58, 136192
    s_add_u32 s44, s44, s56
    buffer_load_dwordx4 v176, s[8:11], s44 offen lds
    s_add_u32 m0, s58, 140288
    s_add_u32 s45, s44, 36864
    buffer_load_dwordx4 v177, s[8:11], s44 offen lds
    s_add_u32 m0, s59, 136192
    s_mov_b64 exec, s[46:47]
    buffer_load_dwordx4 v178, s[8:11], s44 offen lds
    s_mov_b64 exec, -1
    s_add_u32 m0, s58, 145408
    s_lshl_b32 s44, s75, 7
    buffer_load_dwordx4 v176, s[8:11], s45 offen lds
    s_add_u32 m0, s58, 149504
    s_add_u32 s44, s44, s57
    buffer_load_dwordx4 v177, s[8:11], s45 offen lds
    s_add_u32 m0, s58, 154624
    s_add_u32 s75, s75, 1
    buffer_load_dwordx4 v179, s[4:7], s44 offen lds
    s_cmp_ge_u32 s75, 9
    s_cselect_b32 s75, 0, s75
    s_mov_b32 s3, 28672
    s_cmp_ge_u32 s35, 6
    s_cselect_b32 s3, 67584, s3
    v_add_u32 v171, s3, v169
    v_add_u32 v172, s3, v170
    ds_read_b128 v[96:99], v171
    ds_read_b64_tr_b16 v[104:105], v173 offset:0
    ds_read_b64_tr_b16 v[106:107], v173 offset:288
    ds_read_b128 v[100:103], v172
    ds_read_b64_tr_b16 v[108:109], v173 offset:9216
    ds_read_b64_tr_b16 v[110:111], v173 offset:9504
    v_mfma_f32_16x16x32_bf16 v[48:51], v[120:123], v[112:115], v[48:51]
    v_mfma_f32_16x16x32_bf16 v[48:51], v[124:127], v[116:119], v[48:51]
    s_waitcnt vmcnt(12) lgkmcnt(0)
    s_barrier
    s_lshl_b32 s41, s32, 2
    s_add_u32 s41, s41, s35
    s_sub_u32 s41, s41, 4
    s_lshl_b32 s41, s41, 12
    v_lshlrev_b32 v11, 7, v10
    v_mov_b32 v13, s74
    s_mul_i32 s44, s75, 73728
    s_add_u32 m0, s58, 49152
    s_add_u32 s44, s44, s56
    buffer_load_dwordx4 v176, s[8:11], s44 offen lds
    s_add_u32 m0, s58, 53248
    s_add_u32 s45, s44, 36864
    buffer_load_dwordx4 v177, s[8:11], s44 offen lds
    s_add_u32 m0, s59, 49152
    s_mov_b64 exec, s[46:47]
    buffer_load_dwordx4 v178, s[8:11], s44 offen lds
    s_mov_b64 exec, -1
    s_add_u32 m0, s58, 58368
    s_lshl_b32 s44, s75, 7
    buffer_load_dwordx4 v176, s[8:11], s45 offen lds
    s_add_u32 m0, s58, 62464
    s_add_u32 s44, s44, s57
    buffer_load_dwordx4 v177, s[8:11], s45 offen lds
    s_add_u32 m0, s58, 67584
    s_add_u32 s75, s75, 1
    buffer_load_dwordx4 v179, s[4:7], s44 offen lds
    s_cmp_ge_u32 s75, 9
    s_cselect_b32 s75, 0, s75
    s_mov_b32 s3, 32768
    s_cmp_ge_u32 s35, 6
    s_cselect_b32 s3, 109568, s3
    v_add_u32 v171, s3, v169
    v_add_u32 v172, s3, v170
    ds_read_b128 v[112:115], v171
    ds_read_b64_tr_b16 v[120:121], v173 offset:41984
    ds_read_b64_tr_b16 v[122:123], v173 offset:42272
    ds_read_b128 v[116:119], v172
    ds_read_b64_tr_b16 v[124:125], v173 offset:51200
    ds_read_b64_tr_b16 v[126:127], v173 offset:51488
    v_mfma_f32_16x16x32_bf16 v[48:51], v[104:107], v[96:99], v[48:51]
    v_mfma_f32_16x16x32_bf16 v[48:51], v[108:111], v[100:103], v[48:51]
    s_waitcnt vmcnt(12) lgkmcnt(0)
    s_barrier
    s_mov_b32 s3, 36864
    s_cmp_ge_u32 s35, 6
    s_cselect_b32 s3, 132096, s3
    v_add_u32 v171, s3, v169
    v_add_u32 v172, s3, v170
    ds_read_b128 v[96:99], v171
    ds_read_b64_tr_b16 v[104:105], v189 offset:0
    ds_read_b64_tr_b16 v[106:107], v189 offset:288
    ds_read_b128 v[100:103], v172
    ds_read_b64_tr_b16 v[108:109], v189 offset:9216
    ds_read_b64_tr_b16 v[110:111], v189 offset:9504
    v_mfma_f32_16x16x32_bf16 v[48:51], v[120:123], v[112:115], v[48:51]
    v_mfma_f32_16x16x32_bf16 v[48:51], v[124:127], v[116:119], v[48:51]
    s_waitcnt vmcnt(6) lgkmcnt(0)
    s_barrier
    s_mov_b32 exec_hi, 0
    buffer_load_dword v13, v11, s[28:31], s41 offen sc1
    s_mov_b32 exec_hi, -1
    s_mov_b32 s3, 40960
    s_cmp_ge_u32 s35, 6
    s_cselect_b32 s3, 154624, s3
    v_add_u32 v171, s3, v169
    v_add_u32 v172, s3, v170
    ds_read_b128 v[112:115], v171
    ds_read_b64_tr_b16 v[120:121], v189 offset:22528
    ds_read_b64_tr_b16 v[122:123], v189 offset:22816
    ds_read_b128 v[116:119], v172
    ds_read_b64_tr_b16 v[124:125], v189 offset:31744
    ds_read_b64_tr_b16 v[126:127], v189 offset:32032
    v_mfma_f32_16x16x32_bf16 v[48:51], v[104:107], v[96:99], v[48:51]
    v_mfma_f32_16x16x32_bf16 v[48:51], v[108:111], v[100:103], v[48:51]
    s_waitcnt vmcnt(0) lgkmcnt(0)
    v_cmp_ne_u32 vcc, s74, v13
    s_lshl_b32 s3, s35, 2
    s_add_u32 s3, s3, 71664
    v_mov_b32 v12, s3
    s_cmp_eq_u64 vcc, 0
    s_cselect_b32 s3, 1, 0
    v_mov_b32 v14, s3
    s_mov_b32 s56, s3
    ds_write_b32 v12, v14
    s_waitcnt lgkmcnt(0)
    s_barrier
    v_mov_b32 v12, 71680
    ds_read_b128 v[208:211], v12
    s_waitcnt lgkmcnt(0)
    v_and_b32 v208, v208, v209
    v_and_b32 v210, v210, v211
    v_and_b32 v208, v208, v210
    s_nop 0
    v_readfirstlane_b32 s51, v208
    s_nop 0
    s_cmp_eq_u32 s51, 0
    s_cbranch_scc1 L_con_nost1
    v_lshlrev_b32 v15, 4, v1
    s_add_u32 s3, s58, 0
    s_mov_b32 m0, s3
    s_nop 0
    buffer_load_dwordx4 v15, s[16:19], s3 offen sc1 lds
    s_add_u32 s3, s58, 4096
    s_mov_b32 m0, s3
    s_nop 0
    buffer_load_dwordx4 v15, s[16:19], s3 offen sc1 lds
    s_add_u32 s3, s58, 8192
    s_mov_b32 m0, s3
    s_nop 0
    buffer_load_dwordx4 v15, s[16:19], s3 offen sc1 lds
    s_add_u32 s3, s58, 75776
    s_mov_b32 m0, s3
    s_nop 0
    buffer_load_dwordx4 v15, s[16:19], s3 offen sc1 lds
    s_add_u32 s3, s58, 79872
    s_mov_b32 m0, s3
    s_nop 0
    buffer_load_dwordx4 v15, s[16:19], s3 offen sc1 lds
    s_add_u32 s3, s58, 83968
    s_mov_b32 m0, s3
    s_nop 0
    buffer_load_dwordx4 v15, s[16:19], s3 offen sc1 lds
L_con_nost1:
    s_mov_b32 s3, 45056
    s_cmp_ge_u32 s35, 6
    s_cselect_b32 s3, 67584, s3
    v_add_u32 v171, s3, v169
    v_add_u32 v172, s3, v170
    ds_read_b128 v[96:99], v171
    ds_read_b64_tr_b16 v[104:105], v173 offset:0
    ds_read_b64_tr_b16 v[106:107], v173 offset:288
    ds_read_b128 v[100:103], v172
    ds_read_b64_tr_b16 v[108:109], v173 offset:9216
    ds_read_b64_tr_b16 v[110:111], v173 offset:9504
    v_mfma_f32_16x16x32_bf16 v[48:51], v[120:123], v[112:115], v[48:51]
    v_mfma_f32_16x16x32_bf16 v[48:51], v[124:127], v[116:119], v[48:51]
    s_movk_i32 s38, 296
    s_lshr_b32 s36, s34, 1
    s_waitcnt lgkmcnt(0)
    v_mfma_f32_16x16x32_bf16 v[48:51], v[104:107], v[96:99], v[48:51]
    v_mfma_f32_16x16x32_bf16 v[48:51], v[108:111], v[100:103], v[48:51]
    s_bfe_u32 s37, s35, 0x10001
    s_xor_b32 s36, s36, s37
    s_lshl_b32 s36, s36, 1
    s_and_b32 s37, s35, 1
    s_add_u32 s36, s36, s37
    s_mul_i32 s36, s36, 4736
    s_add_u32 s36, s36, 145152
    v_lshrrev_b32 v12, 4, v1
    v_lshl_add_u32 v12, v12, 3, s36
    v_and_b32 v13, 15, v1
    v_mad_u32_u24 v12, v13, s38, v12
    v_cvt_pk_bf16_f32 v64, v48, v49
    v_cvt_pk_bf16_f32 v65, v50, v51
    ds_write_b64 v12, v[64:65]
    s_lshr_b32 s38, s35, 2
    s_mul_i32 s38, s38, 75776
    v_lshl_add_u32 v3, v1, 4, s38
    v_lshl_add_u32 v4, v10, 2, s38
    v_and_b32 v206, 0x13, v10
    v_bfe_u32 v207, v10, 2, 1
    v_lshl_or_b32 v206, v207, 3, v206
    v_bfe_u32 v207, v10, 3, 1
    v_lshl_or_b32 v206, v207, 2, v206
    v_mov_b32 v207, 0x4000
    v_cmp_lt_u32 vcc, 16, v10
    s_nop 1
    v_cndmask_b32 v206, v206, v207, vcc
    v_cmp_eq_u32 vcc, 20, v10
    s_nop 1
    v_cndmask_b32 v206, v206, 17, vcc
    v_and_b32 v207, 0x1b, v10
    v_cmp_eq_u32 vcc, 17, v207
    s_nop 1
    v_cndmask_b32 v206, v206, 18, vcc
    s_movk_i32 s39, 304
    v_lshl_add_u32 v206, v206, 4, s38
    v_mad_u32_u24 v5, v6, s39, v206
    v_mov_b32 v2, 0xdddddddd
    v_lshlrev_b32 v15, 4, v1
    v_add_u32 v212, 37888, v3
    v_add_u32 v213, 37888, v5
    v_add_u32 v214, 128, v4
    v_add_u32 v215, 37888, v4
    v_add_u32 v216, 38016, v4
    s_and_b32 s39, s35, 3
    s_mul_i32 s39, s39, 72
    s_add_u32 s39, s39, 144896
    s_movk_i32 s40, 296
    s_cmp_ge_u32 s35, 4
    s_cselect_b32 s38, 0, 9472
    s_sub_u32 s3, 9472, s38
    v_mov_b32 v206, s39
    v_mad_u32_u24 v206, v10, s40, v206
    v_lshl_add_u32 v207, v6, 4, v206
    v_add_u32 v197, s38, v207
    v_add_u32 v198, s3, v207
    v_mad_u32_u24 v206, v6, 36, v206
    v_add_u32 v196, s38, v206
    v_add_u32 v207, s3, v206
    v_lshlrev_b32 v206, 20, v6
    v_add_u32 v199, v206, v196
    v_xor_b32 v206, 0x100000, v206
    v_add_u32 v205, v206, v196
    v_mov_b32 v201, 0
    v_mov_b32 v203, 0
L_con_pro_done:
    v_mov_b32 v161, 0
    v_mov_b32 v162, 0
    v_mov_b32 v165, 0
    v_mov_b32 v166, 0
    v_mov_b32 v192, 0
    v_mov_b32 v193, 0
    s_nop 1
    v_mfma_f32_32x32x4bf16_1k v[80:111], v[192:193], v[192:193], 0
    v_mfma_f32_32x32x4bf16_1k v[112:143], v[192:193], v[192:193], 0
    s_cmp_eq_u32 s51, 0
    s_cbranch_scc0 L_con_kvfast
    s_cmp_ge_u32 s35, 4
    s_cbranch_scc0 L_con_kvw0
    v_lshlrev_b32 v11, 7, v1
    s_mov_b32 s50, 0
    s_mov_b32 exec_lo, 4294967295
    s_mov_b32 exec_hi, 0
L_con_pollkv:
    buffer_load_dword v13, v11, s[28:31], s41 offen sc1
    s_add_u32 s50, s50, 1
    s_cmp_gt_u32 s50, 1048576
    s_cbranch_scc1 L_con_polldkv
    s_waitcnt vmcnt(0)
    v_cmp_ne_u32 vcc, s74, v13
    s_nop 4
    s_cbranch_vccnz L_con_pollkv
L_con_polldkv:
    s_waitcnt vmcnt(0)
    s_mov_b64 exec, -1
    s_barrier
    v_lshlrev_b32 v15, 4, v1
    s_add_u32 s3, s58, 0
    s_mov_b32 m0, s3
    s_nop 0
    buffer_load_dwordx4 v15, s[16:19], s3 offen sc1 lds
    s_add_u32 s3, s58, 4096
    s_mov_b32 m0, s3
    s_nop 0
    buffer_load_dwordx4 v15, s[16:19], s3 offen sc1 lds
    s_add_u32 s3, s58, 8192
    s_mov_b32 m0, s3
    s_nop 0
    buffer_load_dwordx4 v15, s[16:19], s3 offen sc1 lds
    s_add_u32 s3, s58, 75776
    s_mov_b32 m0, s3
    s_nop 0
    buffer_load_dwordx4 v15, s[16:19], s3 offen sc1 lds
    s_add_u32 s3, s58, 79872
    s_mov_b32 m0, s3
    s_nop 0
    buffer_load_dwordx4 v15, s[16:19], s3 offen sc1 lds
    s_add_u32 s3, s58, 83968
    s_mov_b32 m0, s3
    s_nop 0
    buffer_load_dwordx4 v15, s[16:19], s3 offen sc1 lds
    s_branch L_con_kvfast
L_con_kvw0:
    s_barrier
L_con_kvfast:
    s_or_b32 s3, s33, s34
    s_xor_b32 s41, s35, 3
    s_or_b32 s3, s3, s41
    s_cmp_eq_u32 s3, 0
    s_cbranch_scc0 L_con_kvseen
    s_lshl_b32 s41, s32, 7
    s_add_u32 s41, s41, 65536
    v_mov_b32 v11, s74
    v_mov_b32 v12, 0
    s_mov_b32 exec_lo, 1
    s_mov_b32 exec_hi, 0
    buffer_store_dword v11, v12, s[28:31], s41 offen sc1
    s_mov_b64 exec, -1
L_con_kvseen:
    s_waitcnt vmcnt(0) lgkmcnt(0)
    s_barrier
    s_cmp_ge_u32 s35, 4
    s_cbranch_scc1 L_con_roleB
    s_mov_b32 s8, s54
    s_mov_b32 s9, s55
    s_mov_b32 s10, 663552
    s_mov_b32 s11, 0x20000
    ds_read_b128 v[168:171], v3 offset:512
    ds_read2_b32 v[144:145], v197 offset0:0 offset1:1
    ds_read2_b32 v[146:147], v197 offset0:2 offset1:3
    ds_read2st64_b32 v[176:177], v4 offset0:0 offset1:1
    ds_read_b32 v200, v199 offset:32
    ds_read2_b32 v[148:149], v197 offset0:9 offset1:10
    ds_read2_b32 v[150:151], v197 offset0:11 offset1:12
    ds_read_b32 v202, v205 offset:32
    ds_read2_b32 v[152:153], v198 offset0:0 offset1:1
    ds_read2_b32 v[154:155], v198 offset0:2 offset1:3
    ds_read_b128 v[180:183], v5 offset:1536
    ds_read_b128 v[184:187], v5 offset:2144
    s_waitcnt lgkmcnt(9)
    v_mfma_f32_32x32x16_bf16 v[16:31], v[168:171], v[144:147], 0
    s_waitcnt lgkmcnt(7)
    v_mfma_f32_32x32x8bf16_1k v[16:31], v[176:177], v[200:201], v[16:31]
    ds_read_b32 v164, v207 offset:32
    ds_read2_b32 v[156:157], v198 offset0:9 offset1:10
    ds_read2_b32 v[158:159], v198 offset0:11 offset1:12
    s_waitcnt lgkmcnt(8)
    v_mfma_f32_32x32x16_bf16 v[32:47], v[168:171], v[148:151], 0
    s_waitcnt lgkmcnt(7)
    v_mfma_f32_32x32x8bf16_1k v[32:47], v[176:177], v[202:203], v[32:47]
    ds_read_b32 v160, v196 offset:32
    ds_read_b32 v163, v196 offset:32
    ds_read_b32 v167, v207 offset:32
    s_nop 0
    s_waitcnt lgkmcnt(0)
    s_setprio 2
    v_exp_f32 v16, v16
    v_exp_f32 v17, v17
    v_exp_f32 v18, v18
    v_exp_f32 v19, v19
    ds_read_b128 v[172:175], v3 offset:2752
    v_exp_f32 v20, v20
    v_mfma_f32_32x32x4bf16_1k v[48:79], v[176:177], v[164:165], 0
    v_exp_f32 v21, v21
    v_exp_f32 v22, v22
    v_exp_f32 v23, v23
    v_exp_f32 v24, v24
    v_exp_f32 v25, v25
    v_exp_f32 v26, v26
    v_exp_f32 v27, v27
    v_exp_f32 v28, v28
    v_smfmac_f32_32x32x32_bf16 v[80:95], v[180:183], v[16:23], v2
    v_exp_f32 v29, v29
    v_exp_f32 v30, v30
    ds_read_b128 v[188:191], v5 offset:3776
    v_exp_f32 v31, v31
    v_exp_f32 v32, v32
    ds_read2st64_b32 v[178:179], v214 offset0:0 offset1:1
    v_exp_f32 v33, v33
    v_smfmac_f32_32x32x32_bf16 v[80:95], v[184:187], v[24:31], v2
    v_exp_f32 v34, v34
    v_exp_f32 v35, v35
    ds_read_b128 v[192:195], v5 offset:4384
    v_exp_f32 v36, v36
    v_exp_f32 v37, v37
    v_mfma_f32_32x32x16_bf16 v[48:63], v[168:171], v[152:155], v[48:63]
    v_exp_f32 v38, v38
    v_exp_f32 v39, v39
    v_exp_f32 v40, v40
    v_exp_f32 v41, v41
    v_mfma_f32_32x32x16_bf16 v[64:79], v[168:171], v[156:159], v[64:79]
    v_exp_f32 v42, v42
    v_exp_f32 v43, v43
    v_exp_f32 v44, v44
    v_exp_f32 v45, v45
    v_smfmac_f32_32x32x32_bf16 v[96:111], v[180:183], v[32:39], v2
    v_exp_f32 v46, v46
    v_exp_f32 v47, v47
    v_exp_f32 v48, v48
    v_exp_f32 v49, v49
    v_smfmac_f32_32x32x32_bf16 v[96:111], v[184:187], v[40:47], v2
    v_exp_f32 v50, v50
    v_exp_f32 v51, v51
    v_exp_f32 v52, v52
    s_waitcnt lgkmcnt(0)
    v_mfma_f32_32x32x4bf16_1k v[16:47], v[176:177], v[162:163], 0
    v_exp_f32 v53, v53
    v_exp_f32 v54, v54
    v_exp_f32 v55, v55
    v_exp_f32 v56, v56
    v_exp_f32 v57, v57
    v_exp_f32 v58, v58
    v_exp_f32 v59, v59
    v_exp_f32 v60, v60
    v_smfmac_f32_32x32x32_bf16 v[112:127], v[180:183], v[48:55], v2
    v_exp_f32 v61, v61
    v_exp_f32 v62, v62
    v_exp_f32 v63, v63
    v_exp_f32 v64, v64
    v_exp_f32 v65, v65
    v_smfmac_f32_32x32x32_bf16 v[112:127], v[184:187], v[56:63], v2
    v_exp_f32 v66, v66
    v_exp_f32 v67, v67
    v_exp_f32 v68, v68
    v_exp_f32 v69, v69
    v_mfma_f32_32x32x16_bf16 v[16:31], v[172:175], v[144:147], v[16:31]
    v_exp_f32 v70, v70
    v_exp_f32 v71, v71
    v_exp_f32 v72, v72
    v_exp_f32 v73, v73
    v_mfma_f32_32x32x16_bf16 v[32:47], v[172:175], v[148:151], v[32:47]
    v_exp_f32 v74, v74
    v_exp_f32 v75, v75
    v_exp_f32 v76, v76
    v_exp_f32 v77, v77
    v_smfmac_f32_32x32x32_bf16 v[128:143], v[180:183], v[64:71], v2
    v_exp_f32 v78, v78
    v_exp_f32 v79, v79
    v_exp_f32 v16, v16
    v_exp_f32 v17, v17
    v_smfmac_f32_32x32x32_bf16 v[128:143], v[184:187], v[72:79], v2
    v_exp_f32 v18, v18
    v_exp_f32 v19, v19
    ds_read_b128 v[168:171], v3 offset:4992
    v_exp_f32 v20, v20
    v_mfma_f32_32x32x4bf16_1k v[48:79], v[176:177], v[166:167], 0
    v_exp_f32 v21, v21
    v_exp_f32 v22, v22
    v_exp_f32 v23, v23
    v_exp_f32 v24, v24
    v_exp_f32 v25, v25
    v_exp_f32 v26, v26
    v_exp_f32 v27, v27
    v_exp_f32 v28, v28
    v_smfmac_f32_32x32x32_bf16 v[80:95], v[188:191], v[16:23], v2
    v_exp_f32 v29, v29
    v_exp_f32 v30, v30
    ds_read_b128 v[180:183], v5 offset:6016
    v_exp_f32 v31, v31
    v_exp_f32 v32, v32
    v_exp_f32 v33, v33
    v_smfmac_f32_32x32x32_bf16 v[80:95], v[192:195], v[24:31], v2
    v_exp_f32 v34, v34
    v_exp_f32 v35, v35
    ds_read_b128 v[184:187], v5 offset:6624
    v_exp_f32 v36, v36
    v_exp_f32 v37, v37
    v_mfma_f32_32x32x16_bf16 v[48:63], v[172:175], v[152:155], v[48:63]
    v_exp_f32 v38, v38
    v_exp_f32 v39, v39
    v_exp_f32 v40, v40
    v_exp_f32 v41, v41
    v_mfma_f32_32x32x16_bf16 v[64:79], v[172:175], v[156:159], v[64:79]
    v_exp_f32 v42, v42
    v_exp_f32 v43, v43
    v_exp_f32 v44, v44
    v_exp_f32 v45, v45
    v_smfmac_f32_32x32x32_bf16 v[96:111], v[188:191], v[32:39], v2
    v_exp_f32 v46, v46
    v_exp_f32 v47, v47
    v_exp_f32 v48, v48
    v_exp_f32 v49, v49
    v_smfmac_f32_32x32x32_bf16 v[96:111], v[192:195], v[40:47], v2
    v_exp_f32 v50, v50
    v_exp_f32 v51, v51
    v_exp_f32 v52, v52
    s_waitcnt lgkmcnt(0)
    v_mfma_f32_32x32x4bf16_1k v[16:47], v[178:179], v[160:161], 0
    v_exp_f32 v53, v53
    v_exp_f32 v54, v54
    v_exp_f32 v55, v55
    v_exp_f32 v56, v56
    v_exp_f32 v57, v57
    v_exp_f32 v58, v58
    v_exp_f32 v59, v59
    v_exp_f32 v60, v60
    v_smfmac_f32_32x32x32_bf16 v[112:127], v[188:191], v[48:55], v2
    v_exp_f32 v61, v61
    v_exp_f32 v62, v62
    v_exp_f32 v63, v63
    v_exp_f32 v64, v64
    v_exp_f32 v65, v65
    v_smfmac_f32_32x32x32_bf16 v[112:127], v[192:195], v[56:63], v2
    v_exp_f32 v66, v66
    v_exp_f32 v67, v67
    v_exp_f32 v68, v68
    v_exp_f32 v69, v69
    v_mfma_f32_32x32x16_bf16 v[16:31], v[168:171], v[144:147], v[16:31]
    v_exp_f32 v70, v70
    v_exp_f32 v71, v71
    v_exp_f32 v72, v72
    v_exp_f32 v73, v73
    v_mfma_f32_32x32x16_bf16 v[32:47], v[168:171], v[148:151], v[32:47]
    v_exp_f32 v74, v74
    v_exp_f32 v75, v75
    v_exp_f32 v76, v76
    v_exp_f32 v77, v77
    v_smfmac_f32_32x32x32_bf16 v[128:143], v[188:191], v[64:71], v2
    v_exp_f32 v78, v78
    v_exp_f32 v79, v79
    v_exp_f32 v16, v16
    v_exp_f32 v17, v17
    v_smfmac_f32_32x32x32_bf16 v[128:143], v[192:195], v[72:79], v2
    v_exp_f32 v18, v18
    v_exp_f32 v19, v19
    ds_read_b128 v[172:175], v3 offset:7232
    v_exp_f32 v20, v20
    v_mfma_f32_32x32x4bf16_1k v[48:79], v[178:179], v[164:165], 0
    v_exp_f32 v21, v21
    v_exp_f32 v22, v22
    v_exp_f32 v23, v23
    v_exp_f32 v24, v24
    v_exp_f32 v25, v25
    v_exp_f32 v26, v26
    v_exp_f32 v27, v27
    v_exp_f32 v28, v28
    v_smfmac_f32_32x32x32_bf16 v[80:95], v[180:183], v[16:23], v2
    v_exp_f32 v29, v29
    v_exp_f32 v30, v30
    ds_read_b128 v[188:191], v5 offset:8256
    v_exp_f32 v31, v31
    v_exp_f32 v32, v32
    ds_read2st64_b32 v[176:177], v4 offset0:37 offset1:38
    v_exp_f32 v33, v33
    v_smfmac_f32_32x32x32_bf16 v[80:95], v[184:187], v[24:31], v2
    v_exp_f32 v34, v34
    v_exp_f32 v35, v35
    ds_read_b128 v[192:195], v5 offset:8864
    v_exp_f32 v36, v36
    v_exp_f32 v37, v37
    v_mfma_f32_32x32x16_bf16 v[48:63], v[168:171], v[152:155], v[48:63]
    v_exp_f32 v38, v38
    v_exp_f32 v39, v39
    v_exp_f32 v40, v40
    v_exp_f32 v41, v41
    v_mfma_f32_32x32x16_bf16 v[64:79], v[168:171], v[156:159], v[64:79]
    v_exp_f32 v42, v42
    v_exp_f32 v43, v43
    v_exp_f32 v44, v44
    v_exp_f32 v45, v45
    v_smfmac_f32_32x32x32_bf16 v[96:111], v[180:183], v[32:39], v2
    v_exp_f32 v46, v46
    v_exp_f32 v47, v47
    v_exp_f32 v48, v48
    v_exp_f32 v49, v49
    v_smfmac_f32_32x32x32_bf16 v[96:111], v[184:187], v[40:47], v2
    v_exp_f32 v50, v50
    v_exp_f32 v51, v51
    v_exp_f32 v52, v52
    s_waitcnt lgkmcnt(0)
    v_mfma_f32_32x32x4bf16_1k v[16:47], v[178:179], v[162:163], 0
    v_exp_f32 v53, v53
    v_exp_f32 v54, v54
    v_exp_f32 v55, v55
    v_exp_f32 v56, v56
    v_exp_f32 v57, v57
    v_exp_f32 v58, v58
    v_exp_f32 v59, v59
    v_exp_f32 v60, v60
    v_smfmac_f32_32x32x32_bf16 v[112:127], v[180:183], v[48:55], v2
    v_exp_f32 v61, v61
    v_exp_f32 v62, v62
    v_exp_f32 v63, v63
    v_exp_f32 v64, v64
    v_exp_f32 v65, v65
    v_smfmac_f32_32x32x32_bf16 v[112:127], v[184:187], v[56:63], v2
    v_exp_f32 v66, v66
    v_exp_f32 v67, v67
    v_exp_f32 v68, v68
    v_exp_f32 v69, v69
    v_mfma_f32_32x32x16_bf16 v[16:31], v[172:175], v[144:147], v[16:31]
    v_exp_f32 v70, v70
    v_exp_f32 v71, v71
    v_exp_f32 v72, v72
    v_exp_f32 v73, v73
    v_mfma_f32_32x32x16_bf16 v[32:47], v[172:175], v[148:151], v[32:47]
    v_exp_f32 v74, v74
    v_exp_f32 v75, v75
    v_exp_f32 v76, v76
    v_exp_f32 v77, v77
    v_smfmac_f32_32x32x32_bf16 v[128:143], v[180:183], v[64:71], v2
    v_exp_f32 v78, v78
    v_exp_f32 v79, v79
    v_exp_f32 v16, v16
    v_exp_f32 v17, v17
    v_smfmac_f32_32x32x32_bf16 v[128:143], v[184:187], v[72:79], v2
    v_exp_f32 v18, v18
    v_exp_f32 v19, v19
    ds_read_b128 v[168:171], v3 offset:9984
    v_exp_f32 v20, v20
    v_mfma_f32_32x32x4bf16_1k v[48:79], v[178:179], v[166:167], 0
    v_exp_f32 v21, v21
    v_exp_f32 v22, v22
    v_exp_f32 v23, v23
    v_exp_f32 v24, v24
    v_exp_f32 v25, v25
    v_exp_f32 v26, v26
    v_exp_f32 v27, v27
    v_exp_f32 v28, v28
    v_smfmac_f32_32x32x32_bf16 v[80:95], v[188:191], v[16:23], v2
    v_exp_f32 v29, v29
    v_exp_f32 v30, v30
    ds_read_b128 v[180:183], v5 offset:11008
    v_exp_f32 v31, v31
    s_setprio 0
    v_exp_f32 v32, v32
    v_exp_f32 v33, v33
    v_smfmac_f32_32x32x32_bf16 v[80:95], v[192:195], v[24:31], v2
    v_exp_f32 v34, v34
    v_exp_f32 v35, v35
    ds_read_b128 v[184:187], v5 offset:11616
    v_exp_f32 v36, v36
    v_exp_f32 v37, v37
    v_mfma_f32_32x32x16_bf16 v[48:63], v[172:175], v[152:155], v[48:63]
    v_exp_f32 v38, v38
    v_exp_f32 v39, v39
    v_exp_f32 v40, v40
    v_exp_f32 v41, v41
    v_mfma_f32_32x32x16_bf16 v[64:79], v[172:175], v[156:159], v[64:79]
    v_exp_f32 v42, v42
    v_exp_f32 v43, v43
    v_exp_f32 v44, v44
    v_exp_f32 v45, v45
    v_smfmac_f32_32x32x32_bf16 v[96:111], v[188:191], v[32:39], v2
    v_exp_f32 v46, v46
    v_exp_f32 v47, v47
    v_exp_f32 v48, v48
    v_exp_f32 v49, v49
    v_smfmac_f32_32x32x32_bf16 v[96:111], v[192:195], v[40:47], v2
    v_exp_f32 v50, v50
    v_exp_f32 v51, v51
    v_exp_f32 v52, v52
    s_waitcnt lgkmcnt(0)
    v_mfma_f32_32x32x4bf16_1k v[16:47], v[176:177], v[160:161], 0
    v_exp_f32 v53, v53
    v_exp_f32 v54, v54
    v_exp_f32 v55, v55
    v_exp_f32 v56, v56
    v_exp_f32 v57, v57
    v_exp_f32 v58, v58
    v_exp_f32 v59, v59
    v_exp_f32 v60, v60
    v_smfmac_f32_32x32x32_bf16 v[112:127], v[188:191], v[48:55], v2
    v_exp_f32 v61, v61
    v_exp_f32 v62, v62
    v_exp_f32 v63, v63
    v_exp_f32 v64, v64
    v_exp_f32 v65, v65
    v_smfmac_f32_32x32x32_bf16 v[112:127], v[192:195], v[56:63], v2
    v_exp_f32 v66, v66
    v_exp_f32 v67, v67
    v_exp_f32 v68, v68
    v_exp_f32 v69, v69
    v_mfma_f32_32x32x16_bf16 v[16:31], v[168:171], v[144:147], v[16:31]
    v_exp_f32 v70, v70
    v_exp_f32 v71, v71
    v_exp_f32 v72, v72
    v_exp_f32 v73, v73
    v_mfma_f32_32x32x16_bf16 v[32:47], v[168:171], v[148:151], v[32:47]
    v_exp_f32 v74, v74
    v_exp_f32 v75, v75
    v_exp_f32 v76, v76
    v_exp_f32 v77, v77
    v_smfmac_f32_32x32x32_bf16 v[128:143], v[188:191], v[64:71], v2
    v_exp_f32 v78, v78
    v_exp_f32 v79, v79
    s_waitcnt vmcnt(0)
    s_barrier
    s_setprio 2
    v_exp_f32 v16, v16
    v_exp_f32 v17, v17
    v_smfmac_f32_32x32x32_bf16 v[128:143], v[192:195], v[72:79], v2
    v_exp_f32 v18, v18
    v_exp_f32 v19, v19
    ds_read_b128 v[172:175], v3 offset:12224
    v_exp_f32 v20, v20
    v_mfma_f32_32x32x4bf16_1k v[48:79], v[176:177], v[164:165], 0
    v_exp_f32 v21, v21
    v_exp_f32 v22, v22
    v_exp_f32 v23, v23
    v_exp_f32 v24, v24
    v_exp_f32 v25, v25
    v_exp_f32 v26, v26
    v_exp_f32 v27, v27
    v_exp_f32 v28, v28
    v_smfmac_f32_32x32x32_bf16 v[80:95], v[180:183], v[16:23], v2
    v_exp_f32 v29, v29
    v_exp_f32 v30, v30
    ds_read_b128 v[188:191], v5 offset:13248
    v_exp_f32 v31, v31
    v_exp_f32 v32, v32
    ds_read2st64_b32 v[178:179], v214 offset0:37 offset1:38
    v_exp_f32 v33, v33
    v_smfmac_f32_32x32x32_bf16 v[80:95], v[184:187], v[24:31], v2
    v_exp_f32 v34, v34
    v_exp_f32 v35, v35
    ds_read_b128 v[192:195], v5 offset:13856
    v_exp_f32 v36, v36
    v_exp_f32 v37, v37
    v_mfma_f32_32x32x16_bf16 v[48:63], v[168:171], v[152:155], v[48:63]
    v_exp_f32 v38, v38
    v_exp_f32 v39, v39
    v_exp_f32 v40, v40
    v_exp_f32 v41, v41
    v_mfma_f32_32x32x16_bf16 v[64:79], v[168:171], v[156:159], v[64:79]
    v_exp_f32 v42, v42
    v_exp_f32 v43, v43
    v_exp_f32 v44, v44
    v_exp_f32 v45, v45
    v_smfmac_f32_32x32x32_bf16 v[96:111], v[180:183], v[32:39], v2
    v_exp_f32 v46, v46
    v_exp_f32 v47, v47
    v_exp_f32 v48, v48
    v_exp_f32 v49, v49
    v_smfmac_f32_32x32x32_bf16 v[96:111], v[184:187], v[40:47], v2
    v_exp_f32 v50, v50
    v_exp_f32 v51, v51
    v_exp_f32 v52, v52
    s_waitcnt lgkmcnt(0)
    v_mfma_f32_32x32x4bf16_1k v[16:47], v[176:177], v[162:163], 0
    v_exp_f32 v53, v53
    v_exp_f32 v54, v54
    v_exp_f32 v55, v55
    v_exp_f32 v56, v56
    v_exp_f32 v57, v57
    v_exp_f32 v58, v58
    v_exp_f32 v59, v59
    v_exp_f32 v60, v60
    v_smfmac_f32_32x32x32_bf16 v[112:127], v[180:183], v[48:55], v2
    v_exp_f32 v61, v61
    v_exp_f32 v62, v62
    v_exp_f32 v63, v63
    v_exp_f32 v64, v64
    v_exp_f32 v65, v65
    v_smfmac_f32_32x32x32_bf16 v[112:127], v[184:187], v[56:63], v2
    v_exp_f32 v66, v66
    v_exp_f32 v67, v67
    v_exp_f32 v68, v68
    v_exp_f32 v69, v69
    v_mfma_f32_32x32x16_bf16 v[16:31], v[172:175], v[144:147], v[16:31]
    v_exp_f32 v70, v70
    v_exp_f32 v71, v71
    v_exp_f32 v72, v72
    v_exp_f32 v73, v73
    v_mfma_f32_32x32x16_bf16 v[32:47], v[172:175], v[148:151], v[32:47]
    v_exp_f32 v74, v74
    v_exp_f32 v75, v75
    v_exp_f32 v76, v76
    v_exp_f32 v77, v77
    v_smfmac_f32_32x32x32_bf16 v[128:143], v[180:183], v[64:71], v2
    v_exp_f32 v78, v78
    v_exp_f32 v79, v79
    v_exp_f32 v16, v16
    v_exp_f32 v17, v17
    v_smfmac_f32_32x32x32_bf16 v[128:143], v[184:187], v[72:79], v2
    v_exp_f32 v18, v18
    v_exp_f32 v19, v19
    ds_read_b128 v[168:171], v3 offset:14464
    v_exp_f32 v20, v20
    v_mfma_f32_32x32x4bf16_1k v[48:79], v[176:177], v[166:167], 0
    v_exp_f32 v21, v21
    v_exp_f32 v22, v22
    v_exp_f32 v23, v23
    v_exp_f32 v24, v24
    v_exp_f32 v25, v25
    v_exp_f32 v26, v26
    v_exp_f32 v27, v27
    v_exp_f32 v28, v28
    v_smfmac_f32_32x32x32_bf16 v[80:95], v[188:191], v[16:23], v2
    v_exp_f32 v29, v29
    v_exp_f32 v30, v30
    ds_read_b128 v[180:183], v5 offset:15488
    v_exp_f32 v31, v31
    v_exp_f32 v32, v32
    v_exp_f32 v33, v33
    v_smfmac_f32_32x32x32_bf16 v[80:95], v[192:195], v[24:31], v2
    v_exp_f32 v34, v34
    v_exp_f32 v35, v35
    ds_read_b128 v[184:187], v5 offset:16096
    v_exp_f32 v36, v36
    v_exp_f32 v37, v37
    v_mfma_f32_32x32x16_bf16 v[48:63], v[172:175], v[152:155], v[48:63]
    v_exp_f32 v38, v38
    v_exp_f32 v39, v39
    v_exp_f32 v40, v40
    v_exp_f32 v41, v41
    v_mfma_f32_32x32x16_bf16 v[64:79], v[172:175], v[156:159], v[64:79]
    v_exp_f32 v42, v42
    v_exp_f32 v43, v43
    v_exp_f32 v44, v44
    v_exp_f32 v45, v45
    v_smfmac_f32_32x32x32_bf16 v[96:111], v[188:191], v[32:39], v2
    v_exp_f32 v46, v46
    v_exp_f32 v47, v47
    v_exp_f32 v48, v48
    v_exp_f32 v49, v49
    v_smfmac_f32_32x32x32_bf16 v[96:111], v[192:195], v[40:47], v2
    v_exp_f32 v50, v50
    v_exp_f32 v51, v51
    v_exp_f32 v52, v52
    s_waitcnt lgkmcnt(0)
    v_mfma_f32_32x32x4bf16_1k v[16:47], v[178:179], v[160:161], 0
    v_exp_f32 v53, v53
    v_exp_f32 v54, v54
    v_exp_f32 v55, v55
    v_exp_f32 v56, v56
    v_exp_f32 v57, v57
    v_exp_f32 v58, v58
    v_exp_f32 v59, v59
    v_exp_f32 v60, v60
    v_smfmac_f32_32x32x32_bf16 v[112:127], v[188:191], v[48:55], v2
    v_exp_f32 v61, v61
    v_exp_f32 v62, v62
    v_exp_f32 v63, v63
    v_exp_f32 v64, v64
    v_exp_f32 v65, v65
    v_smfmac_f32_32x32x32_bf16 v[112:127], v[192:195], v[56:63], v2
    v_exp_f32 v66, v66
    v_exp_f32 v67, v67
    v_exp_f32 v68, v68
    v_exp_f32 v69, v69
    v_mfma_f32_32x32x16_bf16 v[16:31], v[168:171], v[144:147], v[16:31]
    v_exp_f32 v70, v70
    v_exp_f32 v71, v71
    v_exp_f32 v72, v72
    v_exp_f32 v73, v73
    v_mfma_f32_32x32x16_bf16 v[32:47], v[168:171], v[148:151], v[32:47]
    v_exp_f32 v74, v74
    v_exp_f32 v75, v75
    v_exp_f32 v76, v76
    v_exp_f32 v77, v77
    v_smfmac_f32_32x32x32_bf16 v[128:143], v[188:191], v[64:71], v2
    v_exp_f32 v78, v78
    v_exp_f32 v79, v79
    v_exp_f32 v16, v16
    v_exp_f32 v17, v17
    v_smfmac_f32_32x32x32_bf16 v[128:143], v[192:195], v[72:79], v2
    v_exp_f32 v18, v18
    v_exp_f32 v19, v19
    ds_read_b128 v[172:175], v3 offset:16704
    v_exp_f32 v20, v20
    v_mfma_f32_32x32x4bf16_1k v[48:79], v[178:179], v[164:165], 0
    v_exp_f32 v21, v21
    v_exp_f32 v22, v22
    v_exp_f32 v23, v23
    v_exp_f32 v24, v24
    v_exp_f32 v25, v25
    v_exp_f32 v26, v26
    v_exp_f32 v27, v27
    v_exp_f32 v28, v28
    v_smfmac_f32_32x32x32_bf16 v[80:95], v[180:183], v[16:23], v2
    v_exp_f32 v29, v29
    v_exp_f32 v30, v30
    ds_read_b128 v[188:191], v5 offset:17728
    v_exp_f32 v31, v31
    v_exp_f32 v32, v32
    ds_read2st64_b32 v[176:177], v4 offset0:74 offset1:75
    v_exp_f32 v33, v33
    v_smfmac_f32_32x32x32_bf16 v[80:95], v[184:187], v[24:31], v2
    v_exp_f32 v34, v34
    v_exp_f32 v35, v35
    ds_read_b128 v[192:195], v5 offset:18336
    v_exp_f32 v36, v36
    v_exp_f32 v37, v37
    v_mfma_f32_32x32x16_bf16 v[48:63], v[168:171], v[152:155], v[48:63]
    v_exp_f32 v38, v38
    v_exp_f32 v39, v39
    v_exp_f32 v40, v40
    v_exp_f32 v41, v41
    v_mfma_f32_32x32x16_bf16 v[64:79], v[168:171], v[156:159], v[64:79]
    v_exp_f32 v42, v42
    v_exp_f32 v43, v43
    v_exp_f32 v44, v44
    v_exp_f32 v45, v45
    v_smfmac_f32_32x32x32_bf16 v[96:111], v[180:183], v[32:39], v2
    v_exp_f32 v46, v46
    v_exp_f32 v47, v47
    v_exp_f32 v48, v48
    v_exp_f32 v49, v49
    v_smfmac_f32_32x32x32_bf16 v[96:111], v[184:187], v[40:47], v2
    v_exp_f32 v50, v50
    v_exp_f32 v51, v51
    v_exp_f32 v52, v52
    s_waitcnt lgkmcnt(0)
    v_mfma_f32_32x32x4bf16_1k v[16:47], v[178:179], v[162:163], 0
    v_exp_f32 v53, v53
    v_exp_f32 v54, v54
    v_exp_f32 v55, v55
    v_exp_f32 v56, v56
    v_exp_f32 v57, v57
    v_exp_f32 v58, v58
    v_exp_f32 v59, v59
    v_exp_f32 v60, v60
    v_smfmac_f32_32x32x32_bf16 v[112:127], v[180:183], v[48:55], v2
    v_exp_f32 v61, v61
    v_exp_f32 v62, v62
    v_exp_f32 v63, v63
    v_exp_f32 v64, v64
    v_exp_f32 v65, v65
    v_smfmac_f32_32x32x32_bf16 v[112:127], v[184:187], v[56:63], v2
    v_exp_f32 v66, v66
    v_exp_f32 v67, v67
    v_exp_f32 v68, v68
    v_exp_f32 v69, v69
    v_mfma_f32_32x32x16_bf16 v[16:31], v[172:175], v[144:147], v[16:31]
    v_exp_f32 v70, v70
    v_exp_f32 v71, v71
    v_exp_f32 v72, v72
    v_exp_f32 v73, v73
    v_mfma_f32_32x32x16_bf16 v[32:47], v[172:175], v[148:151], v[32:47]
    v_exp_f32 v74, v74
    v_exp_f32 v75, v75
    v_exp_f32 v76, v76
    v_exp_f32 v77, v77
    v_smfmac_f32_32x32x32_bf16 v[128:143], v[180:183], v[64:71], v2
    v_exp_f32 v78, v78
    v_exp_f32 v79, v79
    v_exp_f32 v16, v16
    v_exp_f32 v17, v17
    v_smfmac_f32_32x32x32_bf16 v[128:143], v[184:187], v[72:79], v2
    v_exp_f32 v18, v18
    v_exp_f32 v19, v19
    ds_read_b128 v[168:171], v3 offset:19456
    v_exp_f32 v20, v20
    v_mfma_f32_32x32x4bf16_1k v[48:79], v[178:179], v[166:167], 0
    v_exp_f32 v21, v21
    v_exp_f32 v22, v22
    v_exp_f32 v23, v23
    v_exp_f32 v24, v24
    v_exp_f32 v25, v25
    v_exp_f32 v26, v26
    v_exp_f32 v27, v27
    v_exp_f32 v28, v28
    v_smfmac_f32_32x32x32_bf16 v[80:95], v[188:191], v[16:23], v2
    v_exp_f32 v29, v29
    v_exp_f32 v30, v30
    ds_read_b128 v[180:183], v5 offset:20480
    v_exp_f32 v31, v31
    s_setprio 0
    v_exp_f32 v32, v32
    v_exp_f32 v33, v33
    v_smfmac_f32_32x32x32_bf16 v[80:95], v[192:195], v[24:31], v2
    v_exp_f32 v34, v34
    v_exp_f32 v35, v35
    ds_read_b128 v[184:187], v5 offset:21088
    v_exp_f32 v36, v36
    v_exp_f32 v37, v37
    v_mfma_f32_32x32x16_bf16 v[48:63], v[172:175], v[152:155], v[48:63]
    v_exp_f32 v38, v38
    v_exp_f32 v39, v39
    v_exp_f32 v40, v40
    v_exp_f32 v41, v41
    v_mfma_f32_32x32x16_bf16 v[64:79], v[172:175], v[156:159], v[64:79]
    v_exp_f32 v42, v42
    v_exp_f32 v43, v43
    v_exp_f32 v44, v44
    v_exp_f32 v45, v45
    v_smfmac_f32_32x32x32_bf16 v[96:111], v[188:191], v[32:39], v2
    v_exp_f32 v46, v46
    v_exp_f32 v47, v47
    v_exp_f32 v48, v48
    v_exp_f32 v49, v49
    v_smfmac_f32_32x32x32_bf16 v[96:111], v[192:195], v[40:47], v2
    v_exp_f32 v50, v50
    v_exp_f32 v51, v51
    v_exp_f32 v52, v52
    s_waitcnt lgkmcnt(0)
    v_mfma_f32_32x32x4bf16_1k v[16:47], v[176:177], v[160:161], 0
    v_exp_f32 v53, v53
    v_exp_f32 v54, v54
    v_exp_f32 v55, v55
    v_exp_f32 v56, v56
    v_exp_f32 v57, v57
    v_exp_f32 v58, v58
    v_exp_f32 v59, v59
    v_exp_f32 v60, v60
    v_smfmac_f32_32x32x32_bf16 v[112:127], v[188:191], v[48:55], v2
    v_exp_f32 v61, v61
    v_exp_f32 v62, v62
    v_exp_f32 v63, v63
    v_exp_f32 v64, v64
    v_exp_f32 v65, v65
    v_smfmac_f32_32x32x32_bf16 v[112:127], v[192:195], v[56:63], v2
    v_exp_f32 v66, v66
    v_exp_f32 v67, v67
    v_exp_f32 v68, v68
    v_exp_f32 v69, v69
    v_mfma_f32_32x32x16_bf16 v[16:31], v[168:171], v[144:147], v[16:31]
    v_exp_f32 v70, v70
    v_exp_f32 v71, v71
    v_exp_f32 v72, v72
    v_exp_f32 v73, v73
    v_mfma_f32_32x32x16_bf16 v[32:47], v[168:171], v[148:151], v[32:47]
    v_exp_f32 v74, v74
    v_exp_f32 v75, v75
    v_exp_f32 v76, v76
    v_exp_f32 v77, v77
    v_smfmac_f32_32x32x32_bf16 v[128:143], v[188:191], v[64:71], v2
    v_exp_f32 v78, v78
    v_exp_f32 v79, v79
    s_setprio 2
    v_exp_f32 v16, v16
    v_exp_f32 v17, v17
    v_smfmac_f32_32x32x32_bf16 v[128:143], v[192:195], v[72:79], v2
    v_exp_f32 v18, v18
    v_exp_f32 v19, v19
    ds_read_b128 v[172:175], v3 offset:21696
    v_exp_f32 v20, v20
    v_mfma_f32_32x32x4bf16_1k v[48:79], v[176:177], v[164:165], 0
    v_exp_f32 v21, v21
    v_exp_f32 v22, v22
    v_exp_f32 v23, v23
    v_exp_f32 v24, v24
    v_exp_f32 v25, v25
    v_exp_f32 v26, v26
    v_exp_f32 v27, v27
    v_exp_f32 v28, v28
    v_smfmac_f32_32x32x32_bf16 v[80:95], v[180:183], v[16:23], v2
    v_exp_f32 v29, v29
    v_exp_f32 v30, v30
    ds_read_b128 v[188:191], v5 offset:22720
    v_exp_f32 v31, v31
    v_exp_f32 v32, v32
    ds_read2st64_b32 v[178:179], v214 offset0:74 offset1:75
    v_exp_f32 v33, v33
    v_smfmac_f32_32x32x32_bf16 v[80:95], v[184:187], v[24:31], v2
    v_exp_f32 v34, v34
    v_exp_f32 v35, v35
    ds_read_b128 v[192:195], v5 offset:23328
    v_exp_f32 v36, v36
    v_exp_f32 v37, v37
    v_mfma_f32_32x32x16_bf16 v[48:63], v[168:171], v[152:155], v[48:63]
    v_exp_f32 v38, v38
    v_exp_f32 v39, v39
    v_exp_f32 v40, v40
    v_exp_f32 v41, v41
    v_mfma_f32_32x32x16_bf16 v[64:79], v[168:171], v[156:159], v[64:79]
    v_exp_f32 v42, v42
    v_exp_f32 v43, v43
    v_exp_f32 v44, v44
    v_exp_f32 v45, v45
    v_smfmac_f32_32x32x32_bf16 v[96:111], v[180:183], v[32:39], v2
    v_exp_f32 v46, v46
    v_exp_f32 v47, v47
    v_exp_f32 v48, v48
    v_exp_f32 v49, v49
    v_smfmac_f32_32x32x32_bf16 v[96:111], v[184:187], v[40:47], v2
    v_exp_f32 v50, v50
    v_exp_f32 v51, v51
    v_exp_f32 v52, v52
    s_waitcnt lgkmcnt(0)
    v_mfma_f32_32x32x4bf16_1k v[16:47], v[176:177], v[162:163], 0
    v_exp_f32 v53, v53
    v_exp_f32 v54, v54
    v_exp_f32 v55, v55
    v_exp_f32 v56, v56
    v_exp_f32 v57, v57
    v_exp_f32 v58, v58
    v_exp_f32 v59, v59
    v_exp_f32 v60, v60
    v_smfmac_f32_32x32x32_bf16 v[112:127], v[180:183], v[48:55], v2
    v_exp_f32 v61, v61
    v_exp_f32 v62, v62
    v_exp_f32 v63, v63
    v_exp_f32 v64, v64
    v_exp_f32 v65, v65
    v_smfmac_f32_32x32x32_bf16 v[112:127], v[184:187], v[56:63], v2
    v_exp_f32 v66, v66
    v_exp_f32 v67, v67
    v_exp_f32 v68, v68
    v_exp_f32 v69, v69
    v_mfma_f32_32x32x16_bf16 v[16:31], v[172:175], v[144:147], v[16:31]
    v_exp_f32 v70, v70
    v_exp_f32 v71, v71
    v_exp_f32 v72, v72
    v_exp_f32 v73, v73
    v_mfma_f32_32x32x16_bf16 v[32:47], v[172:175], v[148:151], v[32:47]
    v_exp_f32 v74, v74
    v_exp_f32 v75, v75
    v_exp_f32 v76, v76
    v_exp_f32 v77, v77
    v_smfmac_f32_32x32x32_bf16 v[128:143], v[180:183], v[64:71], v2
    v_exp_f32 v78, v78
    v_exp_f32 v79, v79
    v_exp_f32 v16, v16
    v_exp_f32 v17, v17
    v_smfmac_f32_32x32x32_bf16 v[128:143], v[184:187], v[72:79], v2
    v_exp_f32 v18, v18
    v_exp_f32 v19, v19
    ds_read_b128 v[168:171], v3 offset:23936
    v_exp_f32 v20, v20
    v_mfma_f32_32x32x4bf16_1k v[48:79], v[176:177], v[166:167], 0
    v_exp_f32 v21, v21
    v_exp_f32 v22, v22
    v_exp_f32 v23, v23
    v_exp_f32 v24, v24
    v_exp_f32 v25, v25
    v_exp_f32 v26, v26
    v_exp_f32 v27, v27
    v_exp_f32 v28, v28
    v_smfmac_f32_32x32x32_bf16 v[80:95], v[188:191], v[16:23], v2
    v_exp_f32 v29, v29
    v_exp_f32 v30, v30
    ds_read_b128 v[180:183], v5 offset:24960
    v_exp_f32 v31, v31
    v_exp_f32 v32, v32
    v_exp_f32 v33, v33
    v_smfmac_f32_32x32x32_bf16 v[80:95], v[192:195], v[24:31], v2
    v_exp_f32 v34, v34
    v_exp_f32 v35, v35
    ds_read_b128 v[184:187], v5 offset:25568
    v_exp_f32 v36, v36
    v_exp_f32 v37, v37
    v_mfma_f32_32x32x16_bf16 v[48:63], v[172:175], v[152:155], v[48:63]
    v_exp_f32 v38, v38
    v_exp_f32 v39, v39
    v_exp_f32 v40, v40
    v_exp_f32 v41, v41
    v_mfma_f32_32x32x16_bf16 v[64:79], v[172:175], v[156:159], v[64:79]
    v_exp_f32 v42, v42
    v_exp_f32 v43, v43
    v_exp_f32 v44, v44
    v_exp_f32 v45, v45
    v_smfmac_f32_32x32x32_bf16 v[96:111], v[188:191], v[32:39], v2
    v_exp_f32 v46, v46
    v_exp_f32 v47, v47
    v_exp_f32 v48, v48
    v_exp_f32 v49, v49
    v_smfmac_f32_32x32x32_bf16 v[96:111], v[192:195], v[40:47], v2
    v_exp_f32 v50, v50
    v_exp_f32 v51, v51
    v_exp_f32 v52, v52
    s_waitcnt lgkmcnt(0)
    v_mfma_f32_32x32x4bf16_1k v[16:47], v[178:179], v[160:161], 0
    v_exp_f32 v53, v53
    v_exp_f32 v54, v54
    v_exp_f32 v55, v55
    v_exp_f32 v56, v56
    v_exp_f32 v57, v57
    v_exp_f32 v58, v58
    v_exp_f32 v59, v59
    v_exp_f32 v60, v60
    v_smfmac_f32_32x32x32_bf16 v[112:127], v[188:191], v[48:55], v2
    v_exp_f32 v61, v61
    v_exp_f32 v62, v62
    v_exp_f32 v63, v63
    v_exp_f32 v64, v64
    v_exp_f32 v65, v65
    v_smfmac_f32_32x32x32_bf16 v[112:127], v[192:195], v[56:63], v2
    v_exp_f32 v66, v66
    v_exp_f32 v67, v67
    v_exp_f32 v68, v68
    v_exp_f32 v69, v69
    v_mfma_f32_32x32x16_bf16 v[16:31], v[168:171], v[144:147], v[16:31]
    v_exp_f32 v70, v70
    v_exp_f32 v71, v71
    v_exp_f32 v72, v72
    v_exp_f32 v73, v73
    v_mfma_f32_32x32x16_bf16 v[32:47], v[168:171], v[148:151], v[32:47]
    v_exp_f32 v74, v74
    v_exp_f32 v75, v75
    v_exp_f32 v76, v76
    v_exp_f32 v77, v77
    v_smfmac_f32_32x32x32_bf16 v[128:143], v[188:191], v[64:71], v2
    v_exp_f32 v78, v78
    v_exp_f32 v79, v79
    v_exp_f32 v16, v16
    v_exp_f32 v17, v17
    v_smfmac_f32_32x32x32_bf16 v[128:143], v[192:195], v[72:79], v2
    v_exp_f32 v18, v18
    v_exp_f32 v19, v19
    ds_read_b128 v[172:175], v3 offset:26176
    v_exp_f32 v20, v20
    v_mfma_f32_32x32x4bf16_1k v[48:79], v[178:179], v[164:165], 0
    v_exp_f32 v21, v21
    v_exp_f32 v22, v22
    v_exp_f32 v23, v23
    v_exp_f32 v24, v24
    v_exp_f32 v25, v25
    v_exp_f32 v26, v26
    v_exp_f32 v27, v27
    v_exp_f32 v28, v28
    v_smfmac_f32_32x32x32_bf16 v[80:95], v[180:183], v[16:23], v2
    v_exp_f32 v29, v29
    v_exp_f32 v30, v30
    ds_read_b128 v[188:191], v5 offset:27200
    v_exp_f32 v31, v31
    v_exp_f32 v32, v32
    ds_read2st64_b32 v[176:177], v4 offset0:111 offset1:112
    v_exp_f32 v33, v33
    v_smfmac_f32_32x32x32_bf16 v[80:95], v[184:187], v[24:31], v2
    v_exp_f32 v34, v34
    v_exp_f32 v35, v35
    ds_read_b128 v[192:195], v5 offset:27808
    v_exp_f32 v36, v36
    v_exp_f32 v37, v37
    v_mfma_f32_32x32x16_bf16 v[48:63], v[168:171], v[152:155], v[48:63]
    v_exp_f32 v38, v38
    v_exp_f32 v39, v39
    v_exp_f32 v40, v40
    v_exp_f32 v41, v41
    v_mfma_f32_32x32x16_bf16 v[64:79], v[168:171], v[156:159], v[64:79]
    v_exp_f32 v42, v42
    v_exp_f32 v43, v43
    v_exp_f32 v44, v44
    v_exp_f32 v45, v45
    v_smfmac_f32_32x32x32_bf16 v[96:111], v[180:183], v[32:39], v2
    v_exp_f32 v46, v46
    v_exp_f32 v47, v47
    v_exp_f32 v48, v48
    v_exp_f32 v49, v49
    v_smfmac_f32_32x32x32_bf16 v[96:111], v[184:187], v[40:47], v2
    v_exp_f32 v50, v50
    v_exp_f32 v51, v51
    v_exp_f32 v52, v52
    s_waitcnt lgkmcnt(0)
    v_mfma_f32_32x32x4bf16_1k v[16:47], v[178:179], v[162:163], 0
    v_exp_f32 v53, v53
    v_exp_f32 v54, v54
    v_exp_f32 v55, v55
    v_exp_f32 v56, v56
    v_exp_f32 v57, v57
    v_exp_f32 v58, v58
    v_exp_f32 v59, v59
    v_exp_f32 v60, v60
    v_smfmac_f32_32x32x32_bf16 v[112:127], v[180:183], v[48:55], v2
    v_exp_f32 v61, v61
    v_exp_f32 v62, v62
    v_exp_f32 v63, v63
    v_exp_f32 v64, v64
    v_exp_f32 v65, v65
    v_smfmac_f32_32x32x32_bf16 v[112:127], v[184:187], v[56:63], v2
    v_exp_f32 v66, v66
    v_exp_f32 v67, v67
    v_exp_f32 v68, v68
    v_exp_f32 v69, v69
    v_mfma_f32_32x32x16_bf16 v[16:31], v[172:175], v[144:147], v[16:31]
    v_exp_f32 v70, v70
    v_exp_f32 v71, v71
    v_exp_f32 v72, v72
    v_exp_f32 v73, v73
    v_mfma_f32_32x32x16_bf16 v[32:47], v[172:175], v[148:151], v[32:47]
    v_exp_f32 v74, v74
    v_exp_f32 v75, v75
    v_exp_f32 v76, v76
    v_exp_f32 v77, v77
    v_smfmac_f32_32x32x32_bf16 v[128:143], v[180:183], v[64:71], v2
    v_exp_f32 v78, v78
    v_exp_f32 v79, v79
    v_exp_f32 v16, v16
    v_exp_f32 v17, v17
    v_smfmac_f32_32x32x32_bf16 v[128:143], v[184:187], v[72:79], v2
    v_exp_f32 v18, v18
    v_exp_f32 v19, v19
    ds_read_b128 v[168:171], v3 offset:28928
    v_exp_f32 v20, v20
    v_mfma_f32_32x32x4bf16_1k v[48:79], v[178:179], v[166:167], 0
    v_exp_f32 v21, v21
    v_exp_f32 v22, v22
    v_exp_f32 v23, v23
    v_exp_f32 v24, v24
    v_exp_f32 v25, v25
    v_exp_f32 v26, v26
    v_exp_f32 v27, v27
    v_exp_f32 v28, v28
    v_smfmac_f32_32x32x32_bf16 v[80:95], v[188:191], v[16:23], v2
    v_exp_f32 v29, v29
    v_exp_f32 v30, v30
    ds_read_b128 v[180:183], v5 offset:29952
    v_exp_f32 v31, v31
    s_setprio 0
    v_exp_f32 v32, v32
    v_exp_f32 v33, v33
    v_smfmac_f32_32x32x32_bf16 v[80:95], v[192:195], v[24:31], v2
    v_exp_f32 v34, v34
    v_exp_f32 v35, v35
    ds_read_b128 v[184:187], v5 offset:30560
    v_exp_f32 v36, v36
    v_exp_f32 v37, v37
    v_mfma_f32_32x32x16_bf16 v[48:63], v[172:175], v[152:155], v[48:63]
    v_exp_f32 v38, v38
    v_exp_f32 v39, v39
    v_exp_f32 v40, v40
    v_exp_f32 v41, v41
    v_mfma_f32_32x32x16_bf16 v[64:79], v[172:175], v[156:159], v[64:79]
    v_exp_f32 v42, v42
    v_exp_f32 v43, v43
    v_exp_f32 v44, v44
    v_exp_f32 v45, v45
    v_smfmac_f32_32x32x32_bf16 v[96:111], v[188:191], v[32:39], v2
    v_exp_f32 v46, v46
    v_exp_f32 v47, v47
    v_exp_f32 v48, v48
    v_exp_f32 v49, v49
    v_smfmac_f32_32x32x32_bf16 v[96:111], v[192:195], v[40:47], v2
    v_exp_f32 v50, v50
    v_exp_f32 v51, v51
    v_exp_f32 v52, v52
    s_waitcnt lgkmcnt(0)
    v_mfma_f32_32x32x4bf16_1k v[16:47], v[176:177], v[160:161], 0
    v_exp_f32 v53, v53
    v_exp_f32 v54, v54
    v_exp_f32 v55, v55
    v_exp_f32 v56, v56
    v_exp_f32 v57, v57
    v_exp_f32 v58, v58
    v_exp_f32 v59, v59
    v_exp_f32 v60, v60
    v_smfmac_f32_32x32x32_bf16 v[112:127], v[188:191], v[48:55], v2
    v_exp_f32 v61, v61
    v_exp_f32 v62, v62
    v_exp_f32 v63, v63
    v_exp_f32 v64, v64
    v_exp_f32 v65, v65
    v_smfmac_f32_32x32x32_bf16 v[112:127], v[192:195], v[56:63], v2
    v_exp_f32 v66, v66
    v_exp_f32 v67, v67
    v_exp_f32 v68, v68
    v_exp_f32 v69, v69
    v_mfma_f32_32x32x16_bf16 v[16:31], v[168:171], v[144:147], v[16:31]
    v_exp_f32 v70, v70
    v_exp_f32 v71, v71
    v_exp_f32 v72, v72
    v_exp_f32 v73, v73
    v_mfma_f32_32x32x16_bf16 v[32:47], v[168:171], v[148:151], v[32:47]
    v_exp_f32 v74, v74
    v_exp_f32 v75, v75
    v_exp_f32 v76, v76
    v_exp_f32 v77, v77
    v_smfmac_f32_32x32x32_bf16 v[128:143], v[188:191], v[64:71], v2
    v_exp_f32 v78, v78
    v_exp_f32 v79, v79
    s_setprio 2
    v_exp_f32 v16, v16
    v_exp_f32 v17, v17
    v_smfmac_f32_32x32x32_bf16 v[128:143], v[192:195], v[72:79], v2
    v_exp_f32 v18, v18
    v_exp_f32 v19, v19
    ds_read_b128 v[172:175], v3 offset:31168
    v_exp_f32 v20, v20
    v_mfma_f32_32x32x4bf16_1k v[48:79], v[176:177], v[164:165], 0
    v_exp_f32 v21, v21
    v_exp_f32 v22, v22
    v_exp_f32 v23, v23
    v_exp_f32 v24, v24
    v_exp_f32 v25, v25
    v_exp_f32 v26, v26
    v_exp_f32 v27, v27
    v_exp_f32 v28, v28
    v_smfmac_f32_32x32x32_bf16 v[80:95], v[180:183], v[16:23], v2
    v_exp_f32 v29, v29
    v_exp_f32 v30, v30
    ds_read_b128 v[188:191], v5 offset:32192
    v_exp_f32 v31, v31
    v_exp_f32 v32, v32
    ds_read2st64_b32 v[178:179], v214 offset0:111 offset1:112
    v_exp_f32 v33, v33
    v_smfmac_f32_32x32x32_bf16 v[80:95], v[184:187], v[24:31], v2
    v_exp_f32 v34, v34
    v_exp_f32 v35, v35
    ds_read_b128 v[192:195], v5 offset:32800
    v_exp_f32 v36, v36
    v_exp_f32 v37, v37
    v_mfma_f32_32x32x16_bf16 v[48:63], v[168:171], v[152:155], v[48:63]
    v_exp_f32 v38, v38
    v_exp_f32 v39, v39
    v_exp_f32 v40, v40
    v_exp_f32 v41, v41
    v_mfma_f32_32x32x16_bf16 v[64:79], v[168:171], v[156:159], v[64:79]
    v_exp_f32 v42, v42
    v_exp_f32 v43, v43
    v_exp_f32 v44, v44
    v_exp_f32 v45, v45
    v_smfmac_f32_32x32x32_bf16 v[96:111], v[180:183], v[32:39], v2
    v_exp_f32 v46, v46
    v_exp_f32 v47, v47
    v_exp_f32 v48, v48
    v_exp_f32 v49, v49
    v_smfmac_f32_32x32x32_bf16 v[96:111], v[184:187], v[40:47], v2
    v_exp_f32 v50, v50
    v_exp_f32 v51, v51
    v_exp_f32 v52, v52
    s_waitcnt lgkmcnt(0)
    v_mfma_f32_32x32x4bf16_1k v[16:47], v[176:177], v[162:163], 0
    v_exp_f32 v53, v53
    v_exp_f32 v54, v54
    v_exp_f32 v55, v55
    v_exp_f32 v56, v56
    v_exp_f32 v57, v57
    v_exp_f32 v58, v58
    v_exp_f32 v59, v59
    v_exp_f32 v60, v60
    v_smfmac_f32_32x32x32_bf16 v[112:127], v[180:183], v[48:55], v2
    v_exp_f32 v61, v61
    v_exp_f32 v62, v62
    v_exp_f32 v63, v63
    v_exp_f32 v64, v64
    v_exp_f32 v65, v65
    v_smfmac_f32_32x32x32_bf16 v[112:127], v[184:187], v[56:63], v2
    v_exp_f32 v66, v66
    v_exp_f32 v67, v67
    v_exp_f32 v68, v68
    v_exp_f32 v69, v69
    v_mfma_f32_32x32x16_bf16 v[16:31], v[172:175], v[144:147], v[16:31]
    v_exp_f32 v70, v70
    v_exp_f32 v71, v71
    v_exp_f32 v72, v72
    v_exp_f32 v73, v73
    v_mfma_f32_32x32x16_bf16 v[32:47], v[172:175], v[148:151], v[32:47]
    v_exp_f32 v74, v74
    v_exp_f32 v75, v75
    v_exp_f32 v76, v76
    v_exp_f32 v77, v77
    v_smfmac_f32_32x32x32_bf16 v[128:143], v[180:183], v[64:71], v2
    v_exp_f32 v78, v78
    v_exp_f32 v79, v79
    v_exp_f32 v16, v16
    v_exp_f32 v17, v17
    v_smfmac_f32_32x32x32_bf16 v[128:143], v[184:187], v[72:79], v2
    v_exp_f32 v18, v18
    v_exp_f32 v19, v19
    ds_read_b128 v[168:171], v3 offset:33408
    v_exp_f32 v20, v20
    v_mfma_f32_32x32x4bf16_1k v[48:79], v[176:177], v[166:167], 0
    v_exp_f32 v21, v21
    v_exp_f32 v22, v22
    v_exp_f32 v23, v23
    v_exp_f32 v24, v24
    v_exp_f32 v25, v25
    v_exp_f32 v26, v26
    v_exp_f32 v27, v27
    v_exp_f32 v28, v28
    v_smfmac_f32_32x32x32_bf16 v[80:95], v[188:191], v[16:23], v2
    v_exp_f32 v29, v29
    v_exp_f32 v30, v30
    ds_read_b128 v[180:183], v5 offset:34432
    v_exp_f32 v31, v31
    v_exp_f32 v32, v32
    v_exp_f32 v33, v33
    v_smfmac_f32_32x32x32_bf16 v[80:95], v[192:195], v[24:31], v2
    v_exp_f32 v34, v34
    v_exp_f32 v35, v35
    ds_read_b128 v[184:187], v5 offset:35040
    v_exp_f32 v36, v36
    v_exp_f32 v37, v37
    v_mfma_f32_32x32x16_bf16 v[48:63], v[172:175], v[152:155], v[48:63]
    v_exp_f32 v38, v38
    v_exp_f32 v39, v39
    v_exp_f32 v40, v40
    v_exp_f32 v41, v41
    v_mfma_f32_32x32x16_bf16 v[64:79], v[172:175], v[156:159], v[64:79]
    v_exp_f32 v42, v42
    v_exp_f32 v43, v43
    v_exp_f32 v44, v44
    v_exp_f32 v45, v45
    v_smfmac_f32_32x32x32_bf16 v[96:111], v[188:191], v[32:39], v2
    v_exp_f32 v46, v46
    v_exp_f32 v47, v47
    v_exp_f32 v48, v48
    v_exp_f32 v49, v49
    v_smfmac_f32_32x32x32_bf16 v[96:111], v[192:195], v[40:47], v2
    v_exp_f32 v50, v50
    v_exp_f32 v51, v51
    v_exp_f32 v52, v52
    s_waitcnt lgkmcnt(0)
    v_mfma_f32_32x32x4bf16_1k v[16:47], v[178:179], v[160:161], 0
    v_exp_f32 v53, v53
    v_exp_f32 v54, v54
    v_exp_f32 v55, v55
    v_exp_f32 v56, v56
    v_exp_f32 v57, v57
    v_exp_f32 v58, v58
    v_exp_f32 v59, v59
    v_exp_f32 v60, v60
    v_smfmac_f32_32x32x32_bf16 v[112:127], v[188:191], v[48:55], v2
    v_exp_f32 v61, v61
    v_exp_f32 v62, v62
    v_exp_f32 v63, v63
    v_exp_f32 v64, v64
    v_exp_f32 v65, v65
    v_smfmac_f32_32x32x32_bf16 v[112:127], v[192:195], v[56:63], v2
    v_exp_f32 v66, v66
    v_exp_f32 v67, v67
    v_exp_f32 v68, v68
    v_exp_f32 v69, v69
    v_mfma_f32_32x32x16_bf16 v[16:31], v[168:171], v[144:147], v[16:31]
    v_exp_f32 v70, v70
    v_exp_f32 v71, v71
    v_exp_f32 v72, v72
    v_exp_f32 v73, v73
    v_mfma_f32_32x32x16_bf16 v[32:47], v[168:171], v[148:151], v[32:47]
    v_exp_f32 v74, v74
    v_exp_f32 v75, v75
    v_exp_f32 v76, v76
    v_exp_f32 v77, v77
    v_smfmac_f32_32x32x32_bf16 v[128:143], v[188:191], v[64:71], v2
    v_exp_f32 v78, v78
    v_exp_f32 v79, v79
    v_exp_f32 v16, v16
    v_exp_f32 v17, v17
    v_smfmac_f32_32x32x32_bf16 v[128:143], v[192:195], v[72:79], v2
    v_exp_f32 v18, v18
    v_exp_f32 v19, v19
    ds_read_b128 v[172:175], v3 offset:35648
    v_exp_f32 v20, v20
    v_mfma_f32_32x32x4bf16_1k v[48:79], v[178:179], v[164:165], 0
    v_exp_f32 v21, v21
    v_exp_f32 v22, v22
    v_exp_f32 v23, v23
    v_exp_f32 v24, v24
    v_exp_f32 v25, v25
    v_exp_f32 v26, v26
    v_exp_f32 v27, v27
    v_exp_f32 v28, v28
    v_smfmac_f32_32x32x32_bf16 v[80:95], v[180:183], v[16:23], v2
    v_exp_f32 v29, v29
    v_exp_f32 v30, v30
    ds_read_b128 v[188:191], v5 offset:36672
    v_exp_f32 v31, v31
    v_exp_f32 v32, v32
    ds_read2st64_b32 v[176:177], v215 offset0:0 offset1:1
    v_exp_f32 v33, v33
    v_smfmac_f32_32x32x32_bf16 v[80:95], v[184:187], v[24:31], v2
    v_exp_f32 v34, v34
    v_exp_f32 v35, v35
    ds_read_b128 v[192:195], v5 offset:37280
    v_exp_f32 v36, v36
    v_exp_f32 v37, v37
    v_mfma_f32_32x32x16_bf16 v[48:63], v[168:171], v[152:155], v[48:63]
    v_exp_f32 v38, v38
    v_exp_f32 v39, v39
    v_exp_f32 v40, v40
    v_exp_f32 v41, v41
    v_mfma_f32_32x32x16_bf16 v[64:79], v[168:171], v[156:159], v[64:79]
    v_exp_f32 v42, v42
    v_exp_f32 v43, v43
    v_exp_f32 v44, v44
    v_exp_f32 v45, v45
    v_smfmac_f32_32x32x32_bf16 v[96:111], v[180:183], v[32:39], v2
    v_exp_f32 v46, v46
    v_exp_f32 v47, v47
    v_exp_f32 v48, v48
    v_exp_f32 v49, v49
    v_smfmac_f32_32x32x32_bf16 v[96:111], v[184:187], v[40:47], v2
    v_exp_f32 v50, v50
    v_exp_f32 v51, v51
    v_exp_f32 v52, v52
    s_waitcnt lgkmcnt(0)
    v_mfma_f32_32x32x4bf16_1k v[16:47], v[178:179], v[162:163], 0
    v_exp_f32 v53, v53
    v_exp_f32 v54, v54
    v_exp_f32 v55, v55
    v_exp_f32 v56, v56
    v_exp_f32 v57, v57
    v_exp_f32 v58, v58
    v_exp_f32 v59, v59
    v_exp_f32 v60, v60
    v_smfmac_f32_32x32x32_bf16 v[112:127], v[180:183], v[48:55], v2
    v_exp_f32 v61, v61
    v_exp_f32 v62, v62
    v_exp_f32 v63, v63
    v_exp_f32 v64, v64
    v_exp_f32 v65, v65
    v_smfmac_f32_32x32x32_bf16 v[112:127], v[184:187], v[56:63], v2
    v_exp_f32 v66, v66
    v_exp_f32 v67, v67
    v_exp_f32 v68, v68
    v_exp_f32 v69, v69
    v_mfma_f32_32x32x16_bf16 v[16:31], v[172:175], v[144:147], v[16:31]
    v_exp_f32 v70, v70
    v_exp_f32 v71, v71
    v_exp_f32 v72, v72
    v_exp_f32 v73, v73
    v_mfma_f32_32x32x16_bf16 v[32:47], v[172:175], v[148:151], v[32:47]
    v_exp_f32 v74, v74
    v_exp_f32 v75, v75
    v_exp_f32 v76, v76
    v_exp_f32 v77, v77
    v_smfmac_f32_32x32x32_bf16 v[128:143], v[180:183], v[64:71], v2
    v_exp_f32 v78, v78
    v_exp_f32 v79, v79
    v_exp_f32 v16, v16
    v_exp_f32 v17, v17
    v_smfmac_f32_32x32x32_bf16 v[128:143], v[184:187], v[72:79], v2
    v_exp_f32 v18, v18
    v_exp_f32 v19, v19
    ds_read_b128 v[168:171], v212 offset:512
    v_exp_f32 v20, v20
    v_mfma_f32_32x32x4bf16_1k v[48:79], v[178:179], v[166:167], 0
    v_exp_f32 v21, v21
    v_exp_f32 v22, v22
    v_exp_f32 v23, v23
    v_exp_f32 v24, v24
    v_exp_f32 v25, v25
    v_exp_f32 v26, v26
    v_exp_f32 v27, v27
    v_exp_f32 v28, v28
    v_smfmac_f32_32x32x32_bf16 v[80:95], v[188:191], v[16:23], v2
    v_exp_f32 v29, v29
    v_exp_f32 v30, v30
    ds_read_b128 v[180:183], v213 offset:1536
    v_exp_f32 v31, v31
    s_setprio 0
    v_exp_f32 v32, v32
    v_exp_f32 v33, v33
    v_smfmac_f32_32x32x32_bf16 v[80:95], v[192:195], v[24:31], v2
    v_exp_f32 v34, v34
    v_exp_f32 v35, v35
    ds_read_b128 v[184:187], v213 offset:2144
    v_exp_f32 v36, v36
    v_exp_f32 v37, v37
    v_mfma_f32_32x32x16_bf16 v[48:63], v[172:175], v[152:155], v[48:63]
    v_exp_f32 v38, v38
    v_exp_f32 v39, v39
    v_exp_f32 v40, v40
    v_exp_f32 v41, v41
    v_mfma_f32_32x32x16_bf16 v[64:79], v[172:175], v[156:159], v[64:79]
    v_exp_f32 v42, v42
    v_exp_f32 v43, v43
    v_exp_f32 v44, v44
    v_exp_f32 v45, v45
    v_smfmac_f32_32x32x32_bf16 v[96:111], v[188:191], v[32:39], v2
    v_exp_f32 v46, v46
    v_exp_f32 v47, v47
    v_exp_f32 v48, v48
    v_exp_f32 v49, v49
    v_smfmac_f32_32x32x32_bf16 v[96:111], v[192:195], v[40:47], v2
    v_exp_f32 v50, v50
    v_exp_f32 v51, v51
    v_exp_f32 v52, v52
    s_waitcnt lgkmcnt(0)
    v_mfma_f32_32x32x4bf16_1k v[16:47], v[176:177], v[160:161], 0
    v_exp_f32 v53, v53
    v_exp_f32 v54, v54
    v_exp_f32 v55, v55
    v_exp_f32 v56, v56
    v_exp_f32 v57, v57
    v_exp_f32 v58, v58
    v_exp_f32 v59, v59
    v_exp_f32 v60, v60
    v_smfmac_f32_32x32x32_bf16 v[112:127], v[188:191], v[48:55], v2
    v_exp_f32 v61, v61
    v_exp_f32 v62, v62
    v_exp_f32 v63, v63
    v_exp_f32 v64, v64
    v_exp_f32 v65, v65
    v_smfmac_f32_32x32x32_bf16 v[112:127], v[192:195], v[56:63], v2
    v_exp_f32 v66, v66
    v_exp_f32 v67, v67
    v_exp_f32 v68, v68
    v_exp_f32 v69, v69
    v_mfma_f32_32x32x16_bf16 v[16:31], v[168:171], v[144:147], v[16:31]
    v_exp_f32 v70, v70
    v_exp_f32 v71, v71
    v_exp_f32 v72, v72
    v_exp_f32 v73, v73
    v_mfma_f32_32x32x16_bf16 v[32:47], v[168:171], v[148:151], v[32:47]
    v_exp_f32 v74, v74
    v_exp_f32 v75, v75
    v_exp_f32 v76, v76
    v_exp_f32 v77, v77
    v_smfmac_f32_32x32x32_bf16 v[128:143], v[188:191], v[64:71], v2
    v_exp_f32 v78, v78
    v_exp_f32 v79, v79
    s_setprio 2
    v_exp_f32 v16, v16
    v_exp_f32 v17, v17
    v_smfmac_f32_32x32x32_bf16 v[128:143], v[192:195], v[72:79], v2
    v_exp_f32 v18, v18
    v_exp_f32 v19, v19
    ds_read_b128 v[172:175], v212 offset:2752
    v_exp_f32 v20, v20
    v_mfma_f32_32x32x4bf16_1k v[48:79], v[176:177], v[164:165], 0
    v_exp_f32 v21, v21
    v_exp_f32 v22, v22
    v_exp_f32 v23, v23
    v_exp_f32 v24, v24
    v_exp_f32 v25, v25
    v_exp_f32 v26, v26
    v_exp_f32 v27, v27
    v_exp_f32 v28, v28
    v_smfmac_f32_32x32x32_bf16 v[80:95], v[180:183], v[16:23], v2
    v_exp_f32 v29, v29
    v_exp_f32 v30, v30
    ds_read_b128 v[188:191], v213 offset:3776
    v_exp_f32 v31, v31
    v_exp_f32 v32, v32
    ds_read2st64_b32 v[178:179], v216 offset0:0 offset1:1
    v_exp_f32 v33, v33
    v_smfmac_f32_32x32x32_bf16 v[80:95], v[184:187], v[24:31], v2
    v_exp_f32 v34, v34
    v_exp_f32 v35, v35
    ds_read_b128 v[192:195], v213 offset:4384
    v_exp_f32 v36, v36
    v_exp_f32 v37, v37
    v_mfma_f32_32x32x16_bf16 v[48:63], v[168:171], v[152:155], v[48:63]
    v_exp_f32 v38, v38
    v_exp_f32 v39, v39
    v_exp_f32 v40, v40
    v_exp_f32 v41, v41
    v_mfma_f32_32x32x16_bf16 v[64:79], v[168:171], v[156:159], v[64:79]
    v_exp_f32 v42, v42
    v_exp_f32 v43, v43
    v_exp_f32 v44, v44
    v_exp_f32 v45, v45
    v_smfmac_f32_32x32x32_bf16 v[96:111], v[180:183], v[32:39], v2
    v_exp_f32 v46, v46
    v_exp_f32 v47, v47
    v_exp_f32 v48, v48
    v_exp_f32 v49, v49
    v_smfmac_f32_32x32x32_bf16 v[96:111], v[184:187], v[40:47], v2
    v_exp_f32 v50, v50
    v_exp_f32 v51, v51
    v_exp_f32 v52, v52
    s_waitcnt lgkmcnt(0)
    v_mfma_f32_32x32x4bf16_1k v[16:47], v[176:177], v[162:163], 0
    v_exp_f32 v53, v53
    v_exp_f32 v54, v54
    v_exp_f32 v55, v55
    v_exp_f32 v56, v56
    v_exp_f32 v57, v57
    v_exp_f32 v58, v58
    v_exp_f32 v59, v59
    v_exp_f32 v60, v60
    v_smfmac_f32_32x32x32_bf16 v[112:127], v[180:183], v[48:55], v2
    v_exp_f32 v61, v61
    v_exp_f32 v62, v62
    v_exp_f32 v63, v63
    v_exp_f32 v64, v64
    v_exp_f32 v65, v65
    v_smfmac_f32_32x32x32_bf16 v[112:127], v[184:187], v[56:63], v2
    v_exp_f32 v66, v66
    v_exp_f32 v67, v67
    v_exp_f32 v68, v68
    v_exp_f32 v69, v69
    v_mfma_f32_32x32x16_bf16 v[16:31], v[172:175], v[144:147], v[16:31]
    v_exp_f32 v70, v70
    v_exp_f32 v71, v71
    v_exp_f32 v72, v72
    v_exp_f32 v73, v73
    v_mfma_f32_32x32x16_bf16 v[32:47], v[172:175], v[148:151], v[32:47]
    v_exp_f32 v74, v74
    v_exp_f32 v75, v75
    v_exp_f32 v76, v76
    v_exp_f32 v77, v77
    v_smfmac_f32_32x32x32_bf16 v[128:143], v[180:183], v[64:71], v2
    v_exp_f32 v78, v78
    v_exp_f32 v79, v79
    v_exp_f32 v16, v16
    v_exp_f32 v17, v17
    v_smfmac_f32_32x32x32_bf16 v[128:143], v[184:187], v[72:79], v2
    v_exp_f32 v18, v18
    v_exp_f32 v19, v19
    ds_read_b128 v[168:171], v212 offset:4992
    v_exp_f32 v20, v20
    v_mfma_f32_32x32x4bf16_1k v[48:79], v[176:177], v[166:167], 0
    v_exp_f32 v21, v21
    v_exp_f32 v22, v22
    v_exp_f32 v23, v23
    v_exp_f32 v24, v24
    v_exp_f32 v25, v25
    v_exp_f32 v26, v26
    v_exp_f32 v27, v27
    v_exp_f32 v28, v28
    v_smfmac_f32_32x32x32_bf16 v[80:95], v[188:191], v[16:23], v2
    v_exp_f32 v29, v29
    v_exp_f32 v30, v30
    ds_read_b128 v[180:183], v213 offset:6016
    v_exp_f32 v31, v31
    v_exp_f32 v32, v32
    v_exp_f32 v33, v33
    v_smfmac_f32_32x32x32_bf16 v[80:95], v[192:195], v[24:31], v2
    v_exp_f32 v34, v34
    v_exp_f32 v35, v35
    ds_read_b128 v[184:187], v213 offset:6624
    v_exp_f32 v36, v36
    v_exp_f32 v37, v37
    v_mfma_f32_32x32x16_bf16 v[48:63], v[172:175], v[152:155], v[48:63]
    v_exp_f32 v38, v38
    v_exp_f32 v39, v39
    v_exp_f32 v40, v40
    v_exp_f32 v41, v41
    v_mfma_f32_32x32x16_bf16 v[64:79], v[172:175], v[156:159], v[64:79]
    v_exp_f32 v42, v42
    v_exp_f32 v43, v43
    v_exp_f32 v44, v44
    v_exp_f32 v45, v45
    v_smfmac_f32_32x32x32_bf16 v[96:111], v[188:191], v[32:39], v2
    v_exp_f32 v46, v46
    v_exp_f32 v47, v47
    v_exp_f32 v48, v48
    v_exp_f32 v49, v49
    v_smfmac_f32_32x32x32_bf16 v[96:111], v[192:195], v[40:47], v2
    v_exp_f32 v50, v50
    v_exp_f32 v51, v51
    v_exp_f32 v52, v52
    s_waitcnt lgkmcnt(0)
    v_mfma_f32_32x32x4bf16_1k v[16:47], v[178:179], v[160:161], 0
    v_exp_f32 v53, v53
    v_exp_f32 v54, v54
    v_exp_f32 v55, v55
    v_exp_f32 v56, v56
    v_exp_f32 v57, v57
    v_exp_f32 v58, v58
    v_exp_f32 v59, v59
    v_exp_f32 v60, v60
    v_smfmac_f32_32x32x32_bf16 v[112:127], v[188:191], v[48:55], v2
    v_exp_f32 v61, v61
    v_exp_f32 v62, v62
    v_exp_f32 v63, v63
    v_exp_f32 v64, v64
    v_exp_f32 v65, v65
    v_smfmac_f32_32x32x32_bf16 v[112:127], v[192:195], v[56:63], v2
    v_exp_f32 v66, v66
    v_exp_f32 v67, v67
    v_exp_f32 v68, v68
    v_exp_f32 v69, v69
    v_mfma_f32_32x32x16_bf16 v[16:31], v[168:171], v[144:147], v[16:31]
    v_exp_f32 v70, v70
    v_exp_f32 v71, v71
    v_exp_f32 v72, v72
    v_exp_f32 v73, v73
    v_mfma_f32_32x32x16_bf16 v[32:47], v[168:171], v[148:151], v[32:47]
    v_exp_f32 v74, v74
    v_exp_f32 v75, v75
    v_exp_f32 v76, v76
    v_exp_f32 v77, v77
    v_smfmac_f32_32x32x32_bf16 v[128:143], v[188:191], v[64:71], v2
    v_exp_f32 v78, v78
    v_exp_f32 v79, v79
    v_exp_f32 v16, v16
    v_exp_f32 v17, v17
    v_smfmac_f32_32x32x32_bf16 v[128:143], v[192:195], v[72:79], v2
    v_exp_f32 v18, v18
    v_exp_f32 v19, v19
    ds_read_b128 v[172:175], v212 offset:7232
    v_exp_f32 v20, v20
    v_mfma_f32_32x32x4bf16_1k v[48:79], v[178:179], v[164:165], 0
    v_exp_f32 v21, v21
    v_exp_f32 v22, v22
    v_exp_f32 v23, v23
    v_exp_f32 v24, v24
    v_exp_f32 v25, v25
    v_exp_f32 v26, v26
    v_exp_f32 v27, v27
    v_exp_f32 v28, v28
    v_smfmac_f32_32x32x32_bf16 v[80:95], v[180:183], v[16:23], v2
    v_exp_f32 v29, v29
    v_exp_f32 v30, v30
    ds_read_b128 v[188:191], v213 offset:8256
    v_exp_f32 v31, v31
    v_exp_f32 v32, v32
    ds_read2st64_b32 v[176:177], v215 offset0:37 offset1:38
    v_exp_f32 v33, v33
    v_smfmac_f32_32x32x32_bf16 v[80:95], v[184:187], v[24:31], v2
    v_exp_f32 v34, v34
    v_exp_f32 v35, v35
    ds_read_b128 v[192:195], v213 offset:8864
    v_exp_f32 v36, v36
    v_exp_f32 v37, v37
    v_mfma_f32_32x32x16_bf16 v[48:63], v[168:171], v[152:155], v[48:63]
    v_exp_f32 v38, v38
    v_exp_f32 v39, v39
    v_exp_f32 v40, v40
    v_exp_f32 v41, v41
    v_mfma_f32_32x32x16_bf16 v[64:79], v[168:171], v[156:159], v[64:79]
    v_exp_f32 v42, v42
    v_exp_f32 v43, v43
    v_exp_f32 v44, v44
    v_exp_f32 v45, v45
    v_smfmac_f32_32x32x32_bf16 v[96:111], v[180:183], v[32:39], v2
    v_exp_f32 v46, v46
    v_exp_f32 v47, v47
    v_exp_f32 v48, v48
    v_exp_f32 v49, v49
    v_smfmac_f32_32x32x32_bf16 v[96:111], v[184:187], v[40:47], v2
    v_exp_f32 v50, v50
    v_exp_f32 v51, v51
    v_exp_f32 v52, v52
    s_waitcnt lgkmcnt(0)
    v_mfma_f32_32x32x4bf16_1k v[16:47], v[178:179], v[162:163], 0
    v_exp_f32 v53, v53
    v_exp_f32 v54, v54
    v_exp_f32 v55, v55
    v_exp_f32 v56, v56
    v_exp_f32 v57, v57
    v_exp_f32 v58, v58
    v_exp_f32 v59, v59
    v_exp_f32 v60, v60
    v_smfmac_f32_32x32x32_bf16 v[112:127], v[180:183], v[48:55], v2
    v_exp_f32 v61, v61
    v_exp_f32 v62, v62
    v_exp_f32 v63, v63
    v_exp_f32 v64, v64
    v_exp_f32 v65, v65
    v_smfmac_f32_32x32x32_bf16 v[112:127], v[184:187], v[56:63], v2
    v_exp_f32 v66, v66
    v_exp_f32 v67, v67
    v_exp_f32 v68, v68
    v_exp_f32 v69, v69
    v_mfma_f32_32x32x16_bf16 v[16:31], v[172:175], v[144:147], v[16:31]
    v_exp_f32 v70, v70
    v_exp_f32 v71, v71
    v_exp_f32 v72, v72
    v_exp_f32 v73, v73
    v_mfma_f32_32x32x16_bf16 v[32:47], v[172:175], v[148:151], v[32:47]
    v_exp_f32 v74, v74
    v_exp_f32 v75, v75
    v_exp_f32 v76, v76
    v_exp_f32 v77, v77
    v_smfmac_f32_32x32x32_bf16 v[128:143], v[180:183], v[64:71], v2
    v_exp_f32 v78, v78
    v_exp_f32 v79, v79
    v_exp_f32 v16, v16
    v_exp_f32 v17, v17
    v_smfmac_f32_32x32x32_bf16 v[128:143], v[184:187], v[72:79], v2
    v_exp_f32 v18, v18
    v_exp_f32 v19, v19
    ds_read_b128 v[168:171], v212 offset:9984
    v_exp_f32 v20, v20
    v_mfma_f32_32x32x4bf16_1k v[48:79], v[178:179], v[166:167], 0
    v_exp_f32 v21, v21
    v_exp_f32 v22, v22
    v_exp_f32 v23, v23
    v_exp_f32 v24, v24
    v_exp_f32 v25, v25
    v_exp_f32 v26, v26
    v_exp_f32 v27, v27
    v_exp_f32 v28, v28
    v_smfmac_f32_32x32x32_bf16 v[80:95], v[188:191], v[16:23], v2
    v_exp_f32 v29, v29
    v_exp_f32 v30, v30
    ds_read_b128 v[180:183], v213 offset:11008
    v_exp_f32 v31, v31
    s_setprio 0
    v_exp_f32 v32, v32
    v_exp_f32 v33, v33
    v_smfmac_f32_32x32x32_bf16 v[80:95], v[192:195], v[24:31], v2
    v_exp_f32 v34, v34
    v_exp_f32 v35, v35
    ds_read_b128 v[184:187], v213 offset:11616
    v_exp_f32 v36, v36
    v_exp_f32 v37, v37
    v_mfma_f32_32x32x16_bf16 v[48:63], v[172:175], v[152:155], v[48:63]
    v_exp_f32 v38, v38
    v_exp_f32 v39, v39
    v_exp_f32 v40, v40
    v_exp_f32 v41, v41
    v_mfma_f32_32x32x16_bf16 v[64:79], v[172:175], v[156:159], v[64:79]
    v_exp_f32 v42, v42
    v_exp_f32 v43, v43
    v_exp_f32 v44, v44
    v_exp_f32 v45, v45
    v_smfmac_f32_32x32x32_bf16 v[96:111], v[188:191], v[32:39], v2
    v_exp_f32 v46, v46
    v_exp_f32 v47, v47
    v_exp_f32 v48, v48
    v_exp_f32 v49, v49
    v_smfmac_f32_32x32x32_bf16 v[96:111], v[192:195], v[40:47], v2
    v_exp_f32 v50, v50
    v_exp_f32 v51, v51
    v_exp_f32 v52, v52
    s_waitcnt lgkmcnt(0)
    v_mfma_f32_32x32x4bf16_1k v[16:47], v[176:177], v[160:161], 0
    v_exp_f32 v53, v53
    v_exp_f32 v54, v54
    v_exp_f32 v55, v55
    v_exp_f32 v56, v56
    v_exp_f32 v57, v57
    v_exp_f32 v58, v58
    v_exp_f32 v59, v59
    v_exp_f32 v60, v60
    v_smfmac_f32_32x32x32_bf16 v[112:127], v[188:191], v[48:55], v2
    v_exp_f32 v61, v61
    v_exp_f32 v62, v62
    v_exp_f32 v63, v63
    v_exp_f32 v64, v64
    v_exp_f32 v65, v65
    v_smfmac_f32_32x32x32_bf16 v[112:127], v[192:195], v[56:63], v2
    v_exp_f32 v66, v66
    v_exp_f32 v67, v67
    v_exp_f32 v68, v68
    v_exp_f32 v69, v69
    v_mfma_f32_32x32x16_bf16 v[16:31], v[168:171], v[144:147], v[16:31]
    v_exp_f32 v70, v70
    v_exp_f32 v71, v71
    v_exp_f32 v72, v72
    v_exp_f32 v73, v73
    v_mfma_f32_32x32x16_bf16 v[32:47], v[168:171], v[148:151], v[32:47]
    v_exp_f32 v74, v74
    v_exp_f32 v75, v75
    v_exp_f32 v76, v76
    v_exp_f32 v77, v77
    v_smfmac_f32_32x32x32_bf16 v[128:143], v[188:191], v[64:71], v2
    v_exp_f32 v78, v78
    v_exp_f32 v79, v79
    s_setprio 2
    v_exp_f32 v16, v16
    v_exp_f32 v17, v17
    v_smfmac_f32_32x32x32_bf16 v[128:143], v[192:195], v[72:79], v2
    v_exp_f32 v18, v18
    v_exp_f32 v19, v19
    ds_read_b128 v[172:175], v212 offset:12224
    v_exp_f32 v20, v20
    v_mfma_f32_32x32x4bf16_1k v[48:79], v[176:177], v[164:165], 0
    v_exp_f32 v21, v21
    v_exp_f32 v22, v22
    v_exp_f32 v23, v23
    v_exp_f32 v24, v24
    v_exp_f32 v25, v25
    v_exp_f32 v26, v26
    v_exp_f32 v27, v27
    v_exp_f32 v28, v28
    v_smfmac_f32_32x32x32_bf16 v[80:95], v[180:183], v[16:23], v2
    v_exp_f32 v29, v29
    v_exp_f32 v30, v30
    ds_read_b128 v[188:191], v213 offset:13248
    v_exp_f32 v31, v31
    v_exp_f32 v32, v32
    ds_read2st64_b32 v[178:179], v216 offset0:37 offset1:38
    v_exp_f32 v33, v33
    v_smfmac_f32_32x32x32_bf16 v[80:95], v[184:187], v[24:31], v2
    v_exp_f32 v34, v34
    v_exp_f32 v35, v35
    ds_read_b128 v[192:195], v213 offset:13856
    v_exp_f32 v36, v36
    v_exp_f32 v37, v37
    v_mfma_f32_32x32x16_bf16 v[48:63], v[168:171], v[152:155], v[48:63]
    v_exp_f32 v38, v38
    v_exp_f32 v39, v39
    v_exp_f32 v40, v40
    v_exp_f32 v41, v41
    v_mfma_f32_32x32x16_bf16 v[64:79], v[168:171], v[156:159], v[64:79]
    v_exp_f32 v42, v42
    v_exp_f32 v43, v43
    v_exp_f32 v44, v44
    v_exp_f32 v45, v45
    v_smfmac_f32_32x32x32_bf16 v[96:111], v[180:183], v[32:39], v2
    v_exp_f32 v46, v46
    v_exp_f32 v47, v47
    v_exp_f32 v48, v48
    v_exp_f32 v49, v49
    v_smfmac_f32_32x32x32_bf16 v[96:111], v[184:187], v[40:47], v2
    v_exp_f32 v50, v50
    v_exp_f32 v51, v51
    v_exp_f32 v52, v52
    s_waitcnt lgkmcnt(0)
    v_mfma_f32_32x32x4bf16_1k v[16:47], v[176:177], v[162:163], 0
    v_exp_f32 v53, v53
    v_exp_f32 v54, v54
    v_exp_f32 v55, v55
    v_exp_f32 v56, v56
    v_exp_f32 v57, v57
    v_exp_f32 v58, v58
    v_exp_f32 v59, v59
    v_exp_f32 v60, v60
    v_smfmac_f32_32x32x32_bf16 v[112:127], v[180:183], v[48:55], v2
    v_exp_f32 v61, v61
    v_exp_f32 v62, v62
    v_exp_f32 v63, v63
    v_exp_f32 v64, v64
    v_exp_f32 v65, v65
    v_smfmac_f32_32x32x32_bf16 v[112:127], v[184:187], v[56:63], v2
    v_exp_f32 v66, v66
    v_exp_f32 v67, v67
    v_exp_f32 v68, v68
    v_exp_f32 v69, v69
    v_mfma_f32_32x32x16_bf16 v[16:31], v[172:175], v[144:147], v[16:31]
    v_exp_f32 v70, v70
    v_exp_f32 v71, v71
    v_exp_f32 v72, v72
    v_exp_f32 v73, v73
    v_mfma_f32_32x32x16_bf16 v[32:47], v[172:175], v[148:151], v[32:47]
    v_exp_f32 v74, v74
    v_exp_f32 v75, v75
    v_exp_f32 v76, v76
    v_exp_f32 v77, v77
    v_smfmac_f32_32x32x32_bf16 v[128:143], v[180:183], v[64:71], v2
    v_exp_f32 v78, v78
    v_exp_f32 v79, v79
    v_exp_f32 v16, v16
    v_exp_f32 v17, v17
    v_smfmac_f32_32x32x32_bf16 v[128:143], v[184:187], v[72:79], v2
    v_exp_f32 v18, v18
    v_exp_f32 v19, v19
    ds_read_b128 v[168:171], v212 offset:14464
    v_exp_f32 v20, v20
    v_mfma_f32_32x32x4bf16_1k v[48:79], v[176:177], v[166:167], 0
    v_exp_f32 v21, v21
    v_exp_f32 v22, v22
    v_exp_f32 v23, v23
    v_exp_f32 v24, v24
    v_exp_f32 v25, v25
    v_exp_f32 v26, v26
    v_exp_f32 v27, v27
    v_exp_f32 v28, v28
    v_smfmac_f32_32x32x32_bf16 v[80:95], v[188:191], v[16:23], v2
    v_exp_f32 v29, v29
    v_exp_f32 v30, v30
    ds_read_b128 v[180:183], v213 offset:15488
    v_exp_f32 v31, v31
    v_exp_f32 v32, v32
    v_exp_f32 v33, v33
    v_smfmac_f32_32x32x32_bf16 v[80:95], v[192:195], v[24:31], v2
    v_exp_f32 v34, v34
    v_exp_f32 v35, v35
    ds_read_b128 v[184:187], v213 offset:16096
    v_exp_f32 v36, v36
    v_exp_f32 v37, v37
    v_mfma_f32_32x32x16_bf16 v[48:63], v[172:175], v[152:155], v[48:63]
    v_exp_f32 v38, v38
    v_exp_f32 v39, v39
    v_exp_f32 v40, v40
    v_exp_f32 v41, v41
    v_mfma_f32_32x32x16_bf16 v[64:79], v[172:175], v[156:159], v[64:79]
    v_exp_f32 v42, v42
    v_exp_f32 v43, v43
    v_exp_f32 v44, v44
    v_exp_f32 v45, v45
    v_smfmac_f32_32x32x32_bf16 v[96:111], v[188:191], v[32:39], v2
    v_exp_f32 v46, v46
    v_exp_f32 v47, v47
    v_exp_f32 v48, v48
    v_exp_f32 v49, v49
    v_smfmac_f32_32x32x32_bf16 v[96:111], v[192:195], v[40:47], v2
    v_exp_f32 v50, v50
    v_exp_f32 v51, v51
    v_exp_f32 v52, v52
    s_waitcnt lgkmcnt(0)
    v_mfma_f32_32x32x4bf16_1k v[16:47], v[178:179], v[160:161], 0
    v_exp_f32 v53, v53
    v_exp_f32 v54, v54
    v_exp_f32 v55, v55
    v_exp_f32 v56, v56
    v_exp_f32 v57, v57
    v_exp_f32 v58, v58
    v_exp_f32 v59, v59
    v_exp_f32 v60, v60
    v_smfmac_f32_32x32x32_bf16 v[112:127], v[188:191], v[48:55], v2
    v_exp_f32 v61, v61
    v_exp_f32 v62, v62
    v_exp_f32 v63, v63
    v_exp_f32 v64, v64
    v_exp_f32 v65, v65
    v_smfmac_f32_32x32x32_bf16 v[112:127], v[192:195], v[56:63], v2
    v_exp_f32 v66, v66
    v_exp_f32 v67, v67
    v_exp_f32 v68, v68
    v_exp_f32 v69, v69
    v_mfma_f32_32x32x16_bf16 v[16:31], v[168:171], v[144:147], v[16:31]
    v_exp_f32 v70, v70
    v_exp_f32 v71, v71
    v_exp_f32 v72, v72
    v_exp_f32 v73, v73
    v_mfma_f32_32x32x16_bf16 v[32:47], v[168:171], v[148:151], v[32:47]
    v_exp_f32 v74, v74
    v_exp_f32 v75, v75
    v_exp_f32 v76, v76
    v_exp_f32 v77, v77
    v_smfmac_f32_32x32x32_bf16 v[128:143], v[188:191], v[64:71], v2
    v_exp_f32 v78, v78
    v_exp_f32 v79, v79
    v_exp_f32 v16, v16
    v_exp_f32 v17, v17
    v_smfmac_f32_32x32x32_bf16 v[128:143], v[192:195], v[72:79], v2
    v_exp_f32 v18, v18
    v_exp_f32 v19, v19
    ds_read_b128 v[172:175], v212 offset:16704
    v_exp_f32 v20, v20
    v_mfma_f32_32x32x4bf16_1k v[48:79], v[178:179], v[164:165], 0
    v_exp_f32 v21, v21
    v_exp_f32 v22, v22
    v_exp_f32 v23, v23
    v_exp_f32 v24, v24
    v_exp_f32 v25, v25
    v_exp_f32 v26, v26
    v_exp_f32 v27, v27
    v_exp_f32 v28, v28
    v_smfmac_f32_32x32x32_bf16 v[80:95], v[180:183], v[16:23], v2
    v_exp_f32 v29, v29
    v_exp_f32 v30, v30
    ds_read_b128 v[188:191], v213 offset:17728
    v_exp_f32 v31, v31
    v_exp_f32 v32, v32
    ds_read2st64_b32 v[176:177], v215 offset0:74 offset1:75
    v_exp_f32 v33, v33
    v_smfmac_f32_32x32x32_bf16 v[80:95], v[184:187], v[24:31], v2
    v_exp_f32 v34, v34
    v_exp_f32 v35, v35
    ds_read_b128 v[192:195], v213 offset:18336
    v_exp_f32 v36, v36
    v_exp_f32 v37, v37
    v_mfma_f32_32x32x16_bf16 v[48:63], v[168:171], v[152:155], v[48:63]
    v_exp_f32 v38, v38
    v_exp_f32 v39, v39
    v_exp_f32 v40, v40
    v_exp_f32 v41, v41
    v_mfma_f32_32x32x16_bf16 v[64:79], v[168:171], v[156:159], v[64:79]
    v_exp_f32 v42, v42
    v_exp_f32 v43, v43
    v_exp_f32 v44, v44
    v_exp_f32 v45, v45
    v_smfmac_f32_32x32x32_bf16 v[96:111], v[180:183], v[32:39], v2
    v_exp_f32 v46, v46
    v_exp_f32 v47, v47
    v_exp_f32 v48, v48
    v_exp_f32 v49, v49
    v_smfmac_f32_32x32x32_bf16 v[96:111], v[184:187], v[40:47], v2
    v_exp_f32 v50, v50
    v_exp_f32 v51, v51
    v_exp_f32 v52, v52
    s_waitcnt lgkmcnt(0)
    v_mfma_f32_32x32x4bf16_1k v[16:47], v[178:179], v[162:163], 0
    v_exp_f32 v53, v53
    v_exp_f32 v54, v54
    v_exp_f32 v55, v55
    v_exp_f32 v56, v56
    v_exp_f32 v57, v57
    v_exp_f32 v58, v58
    v_exp_f32 v59, v59
    v_exp_f32 v60, v60
    v_smfmac_f32_32x32x32_bf16 v[112:127], v[180:183], v[48:55], v2
    v_exp_f32 v61, v61
    v_exp_f32 v62, v62
    v_exp_f32 v63, v63
    v_exp_f32 v64, v64
    v_exp_f32 v65, v65
    v_smfmac_f32_32x32x32_bf16 v[112:127], v[184:187], v[56:63], v2
    v_exp_f32 v66, v66
    v_exp_f32 v67, v67
    v_exp_f32 v68, v68
    v_exp_f32 v69, v69
    v_mfma_f32_32x32x16_bf16 v[16:31], v[172:175], v[144:147], v[16:31]
    v_exp_f32 v70, v70
    v_exp_f32 v71, v71
    v_exp_f32 v72, v72
    v_exp_f32 v73, v73
    v_mfma_f32_32x32x16_bf16 v[32:47], v[172:175], v[148:151], v[32:47]
    v_exp_f32 v74, v74
    v_exp_f32 v75, v75
    v_exp_f32 v76, v76
    v_exp_f32 v77, v77
    v_smfmac_f32_32x32x32_bf16 v[128:143], v[180:183], v[64:71], v2
    v_exp_f32 v78, v78
    v_exp_f32 v79, v79
    v_exp_f32 v16, v16
    v_exp_f32 v17, v17
    v_smfmac_f32_32x32x32_bf16 v[128:143], v[184:187], v[72:79], v2
    v_exp_f32 v18, v18
    v_exp_f32 v19, v19
    ds_read_b128 v[168:171], v212 offset:19456
    v_exp_f32 v20, v20
    v_mfma_f32_32x32x4bf16_1k v[48:79], v[178:179], v[166:167], 0
    v_exp_f32 v21, v21
    v_exp_f32 v22, v22
    v_exp_f32 v23, v23
    v_exp_f32 v24, v24
    v_exp_f32 v25, v25
    v_exp_f32 v26, v26
    v_exp_f32 v27, v27
    v_exp_f32 v28, v28
    v_smfmac_f32_32x32x32_bf16 v[80:95], v[188:191], v[16:23], v2
    v_exp_f32 v29, v29
    v_exp_f32 v30, v30
    ds_read_b128 v[180:183], v213 offset:20480
    v_exp_f32 v31, v31
    s_setprio 0
    v_exp_f32 v32, v32
    v_exp_f32 v33, v33
    v_smfmac_f32_32x32x32_bf16 v[80:95], v[192:195], v[24:31], v2
    v_exp_f32 v34, v34
    v_exp_f32 v35, v35
    ds_read_b128 v[184:187], v213 offset:21088
    v_exp_f32 v36, v36
    v_exp_f32 v37, v37
    v_mfma_f32_32x32x16_bf16 v[48:63], v[172:175], v[152:155], v[48:63]
    v_exp_f32 v38, v38
    v_exp_f32 v39, v39
    v_exp_f32 v40, v40
    v_exp_f32 v41, v41
    v_mfma_f32_32x32x16_bf16 v[64:79], v[172:175], v[156:159], v[64:79]
    v_exp_f32 v42, v42
    v_exp_f32 v43, v43
    v_exp_f32 v44, v44
    v_exp_f32 v45, v45
    v_smfmac_f32_32x32x32_bf16 v[96:111], v[188:191], v[32:39], v2
    v_exp_f32 v46, v46
    v_exp_f32 v47, v47
    v_exp_f32 v48, v48
    v_exp_f32 v49, v49
    v_smfmac_f32_32x32x32_bf16 v[96:111], v[192:195], v[40:47], v2
    v_exp_f32 v50, v50
    v_exp_f32 v51, v51
    v_exp_f32 v52, v52
    s_waitcnt lgkmcnt(0)
    v_mfma_f32_32x32x4bf16_1k v[16:47], v[176:177], v[160:161], 0
    v_exp_f32 v53, v53
    v_exp_f32 v54, v54
    v_exp_f32 v55, v55
    v_exp_f32 v56, v56
    v_exp_f32 v57, v57
    v_exp_f32 v58, v58
    v_exp_f32 v59, v59
    v_exp_f32 v60, v60
    v_smfmac_f32_32x32x32_bf16 v[112:127], v[188:191], v[48:55], v2
    v_exp_f32 v61, v61
    v_exp_f32 v62, v62
    v_exp_f32 v63, v63
    v_exp_f32 v64, v64
    v_exp_f32 v65, v65
    v_smfmac_f32_32x32x32_bf16 v[112:127], v[192:195], v[56:63], v2
    v_exp_f32 v66, v66
    v_exp_f32 v67, v67
    v_exp_f32 v68, v68
    v_exp_f32 v69, v69
    v_mfma_f32_32x32x16_bf16 v[16:31], v[168:171], v[144:147], v[16:31]
    v_exp_f32 v70, v70
    v_exp_f32 v71, v71
    v_exp_f32 v72, v72
    v_exp_f32 v73, v73
    v_mfma_f32_32x32x16_bf16 v[32:47], v[168:171], v[148:151], v[32:47]
    v_exp_f32 v74, v74
    v_exp_f32 v75, v75
    v_exp_f32 v76, v76
    v_exp_f32 v77, v77
    v_smfmac_f32_32x32x32_bf16 v[128:143], v[188:191], v[64:71], v2
    v_exp_f32 v78, v78
    v_exp_f32 v79, v79
    s_waitcnt vmcnt(0)
    s_barrier
    s_setprio 2
    v_exp_f32 v16, v16
    v_exp_f32 v17, v17
    v_smfmac_f32_32x32x32_bf16 v[128:143], v[192:195], v[72:79], v2
    v_exp_f32 v18, v18
    v_exp_f32 v19, v19
    ds_read_b128 v[172:175], v212 offset:21696
    v_exp_f32 v20, v20
    v_mfma_f32_32x32x4bf16_1k v[48:79], v[176:177], v[164:165], 0
    v_exp_f32 v21, v21
    v_exp_f32 v22, v22
    v_exp_f32 v23, v23
    v_exp_f32 v24, v24
    v_exp_f32 v25, v25
    v_exp_f32 v26, v26
    v_exp_f32 v27, v27
    v_exp_f32 v28, v28
    v_smfmac_f32_32x32x32_bf16 v[80:95], v[180:183], v[16:23], v2
    s_lshr_b32 s38, s35, 1
    s_and_b32 s39, s35, 1
    s_mul_i32 s42, s38, 165888
    s_lshl_b32 s36, s52, 7
    s_add_u32 s43, s42, s36
    s_mul_i32 s36, s39, 9216
    s_add_u32 s36, s36, s43
    s_and_b32 s45, s38, 1
    s_mul_i32 s37, s45, 18432
    s_lshl_b32 s44, s39, 10
    s_add_u32 s37, s37, s44
    s_lshr_b32 s38, s38, 1
    s_mul_i32 s38, s38, 75776
    s_add_u32 s37, s37, s38
    s_mov_b32 m0, s37
    s_nop 0
    buffer_load_dwordx4 v217, s[8:11], s36 offen lds
    v_exp_f32 v29, v29
    v_exp_f32 v30, v30
    ds_read_b128 v[188:191], v213 offset:22720
    v_exp_f32 v31, v31
    s_add_u32 s36, s36, 20736
    s_add_u32 s37, s37, 2048
    s_mov_b32 m0, s37
    s_nop 0
    buffer_load_dwordx4 v217, s[8:11], s36 offen lds
    v_exp_f32 v32, v32
    ds_read2st64_b32 v[178:179], v216 offset0:74 offset1:75
    v_exp_f32 v33, v33
    v_smfmac_f32_32x32x32_bf16 v[80:95], v[184:187], v[24:31], v2
    v_exp_f32 v34, v34
    v_exp_f32 v35, v35
    ds_read_b128 v[192:195], v213 offset:23328
    v_exp_f32 v36, v36
    v_exp_f32 v37, v37
    v_mfma_f32_32x32x16_bf16 v[48:63], v[168:171], v[152:155], v[48:63]
    s_add_u32 s36, s36, 20736
    s_add_u32 s37, s37, 2048
    s_mov_b32 m0, s37
    s_nop 0
    buffer_load_dwordx4 v217, s[8:11], s36 offen lds
    v_exp_f32 v38, v38
    v_exp_f32 v39, v39
    v_exp_f32 v40, v40
    v_exp_f32 v41, v41
    v_mfma_f32_32x32x16_bf16 v[64:79], v[168:171], v[156:159], v[64:79]
    v_exp_f32 v42, v42
    v_exp_f32 v43, v43
    v_exp_f32 v44, v44
    v_exp_f32 v45, v45
    v_smfmac_f32_32x32x32_bf16 v[96:111], v[180:183], v[32:39], v2
    v_exp_f32 v46, v46
    v_exp_f32 v47, v47
    s_add_u32 s36, s36, 20736
    s_add_u32 s37, s37, 2048
    s_mov_b32 m0, s37
    s_nop 0
    buffer_load_dwordx4 v217, s[8:11], s36 offen lds
    v_exp_f32 v48, v48
    v_exp_f32 v49, v49
    v_smfmac_f32_32x32x32_bf16 v[96:111], v[184:187], v[40:47], v2
    v_exp_f32 v50, v50
    v_exp_f32 v51, v51
    v_exp_f32 v52, v52
    s_waitcnt lgkmcnt(0)
    v_mfma_f32_32x32x4bf16_1k v[16:47], v[176:177], v[162:163], 0
    v_exp_f32 v53, v53
    v_exp_f32 v54, v54
    v_exp_f32 v55, v55
    v_exp_f32 v56, v56
    v_exp_f32 v57, v57
    v_exp_f32 v58, v58
    v_exp_f32 v59, v59
    v_exp_f32 v60, v60
    v_smfmac_f32_32x32x32_bf16 v[112:127], v[180:183], v[48:55], v2
    s_add_u32 s36, s36, 20736
    s_add_u32 s37, s37, 2048
    s_mov_b32 m0, s37
    s_nop 0
    buffer_load_dwordx4 v217, s[8:11], s36 offen lds
    v_exp_f32 v61, v61
    v_exp_f32 v62, v62
    v_exp_f32 v63, v63
    s_add_u32 s36, s36, 20736
    s_add_u32 s37, s37, 2048
    s_mov_b32 m0, s37
    s_nop 0
    buffer_load_dwordx4 v217, s[8:11], s36 offen lds
    v_exp_f32 v64, v64
    v_exp_f32 v65, v65
    v_smfmac_f32_32x32x32_bf16 v[112:127], v[184:187], v[56:63], v2
    v_exp_f32 v66, v66
    v_exp_f32 v67, v67
    v_exp_f32 v68, v68
    v_exp_f32 v69, v69
    v_mfma_f32_32x32x16_bf16 v[16:31], v[172:175], v[144:147], v[16:31]
    s_add_u32 s36, s36, 20736
    s_add_u32 s37, s37, 2048
    s_mov_b32 m0, s37
    s_nop 0
    buffer_load_dwordx4 v217, s[8:11], s36 offen lds
    v_exp_f32 v70, v70
    v_exp_f32 v71, v71
    v_exp_f32 v72, v72
    v_exp_f32 v73, v73
    v_mfma_f32_32x32x16_bf16 v[32:47], v[172:175], v[148:151], v[32:47]
    v_exp_f32 v74, v74
    v_exp_f32 v75, v75
    v_exp_f32 v76, v76
    v_exp_f32 v77, v77
    v_smfmac_f32_32x32x32_bf16 v[128:143], v[180:183], v[64:71], v2
    v_exp_f32 v78, v78
    v_exp_f32 v79, v79
    s_add_u32 s36, s36, 20736
    s_add_u32 s37, s37, 2048
    s_mov_b32 m0, s37
    s_nop 0
    buffer_load_dwordx4 v217, s[8:11], s36 offen lds
    v_exp_f32 v16, v16
    v_exp_f32 v17, v17
    v_smfmac_f32_32x32x32_bf16 v[128:143], v[184:187], v[72:79], v2
    v_exp_f32 v18, v18
    v_exp_f32 v19, v19
    ds_read_b128 v[168:171], v212 offset:23936
    v_exp_f32 v20, v20
    v_mfma_f32_32x32x4bf16_1k v[48:79], v[176:177], v[166:167], 0
    v_exp_f32 v21, v21
    v_exp_f32 v22, v22
    v_exp_f32 v23, v23
    v_exp_f32 v24, v24
    v_exp_f32 v25, v25
    v_exp_f32 v26, v26
    v_exp_f32 v27, v27
    v_exp_f32 v28, v28
    v_smfmac_f32_32x32x32_bf16 v[80:95], v[188:191], v[16:23], v2
    s_add_u32 s36, s36, 20736
    s_add_u32 s37, s37, 2048
    s_mul_i32 s36, s39, 1152
    s_add_u32 s36, s36, s43
    s_add_u32 s36, s36, 18432
    s_mov_b32 m0, s37
    s_nop 0
    buffer_load_dwordx4 v218, s[8:11], s36 offen lds
    v_exp_f32 v29, v29
    v_exp_f32 v30, v30
    ds_read_b128 v[180:183], v213 offset:24960
    v_exp_f32 v31, v31
    s_lshr_b32 s36, s34, 1
    s_lshl_b32 s36, s36, 6
    s_add_u32 s42, s42, s36
    s_add_u32 s42, s42, 1024
    s_mul_i32 s36, s39, 20736
    s_add_u32 s36, s36, s42
    s_mul_i32 s43, s45, 9216
    s_add_u32 s43, s43, s38
    s_add_u32 s43, s43, 36864
    s_add_u32 s37, s43, s44
    s_mov_b32 m0, s37
    s_nop 0
    buffer_load_dwordx4 v219, s[8:11], s36 offen lds
    v_exp_f32 v32, v32
    v_exp_f32 v33, v33
    v_smfmac_f32_32x32x32_bf16 v[80:95], v[192:195], v[24:31], v2
    v_exp_f32 v34, v34
    v_exp_f32 v35, v35
    ds_read_b128 v[184:187], v213 offset:25568
    v_exp_f32 v36, v36
    v_exp_f32 v37, v37
    v_mfma_f32_32x32x16_bf16 v[48:63], v[172:175], v[152:155], v[48:63]
    s_add_u32 s36, s36, 41472
    s_add_u32 s37, s37, 2048
    s_mov_b32 m0, s37
    s_nop 0
    buffer_load_dwordx4 v219, s[8:11], s36 offen lds
    v_exp_f32 v38, v38
    v_exp_f32 v39, v39
    v_exp_f32 v40, v40
    v_exp_f32 v41, v41
    v_mfma_f32_32x32x16_bf16 v[64:79], v[172:175], v[156:159], v[64:79]
    v_exp_f32 v42, v42
    v_exp_f32 v43, v43
    v_exp_f32 v44, v44
    v_exp_f32 v45, v45
    v_smfmac_f32_32x32x32_bf16 v[96:111], v[188:191], v[32:39], v2
    v_exp_f32 v46, v46
    v_exp_f32 v47, v47
    s_add_u32 s36, s36, 41472
    s_add_u32 s37, s37, 2048
    s_mov_b32 m0, s37
    s_nop 0
    buffer_load_dwordx4 v219, s[8:11], s36 offen lds
    v_exp_f32 v48, v48
    v_exp_f32 v49, v49
    v_smfmac_f32_32x32x32_bf16 v[96:111], v[192:195], v[40:47], v2
    v_exp_f32 v50, v50
    v_exp_f32 v51, v51
    v_exp_f32 v52, v52
    s_waitcnt lgkmcnt(0)
    v_mfma_f32_32x32x4bf16_1k v[16:47], v[178:179], v[160:161], 0
    v_exp_f32 v53, v53
    v_exp_f32 v54, v54
    v_exp_f32 v55, v55
    v_exp_f32 v56, v56
    v_exp_f32 v57, v57
    v_exp_f32 v58, v58
    v_exp_f32 v59, v59
    v_exp_f32 v60, v60
    v_smfmac_f32_32x32x32_bf16 v[112:127], v[188:191], v[48:55], v2
    s_add_u32 s36, s36, 41472
    s_add_u32 s37, s37, 2048
    s_mov_b32 m0, s37
    s_nop 0
    buffer_load_dwordx4 v219, s[8:11], s36 offen lds
    v_exp_f32 v61, v61
    v_exp_f32 v62, v62
    v_exp_f32 v63, v63
    s_cmp_eq_u32 s39, 0
    s_cbranch_scc0 L_con_wox0
    s_add_u32 s36, s42, 18432
    s_add_u32 s37, s43, 8192
    s_mov_b32 m0, s37
    s_nop 0
    buffer_load_dwordx4 v220, s[8:11], s36 offen lds
L_con_wox0:
    v_exp_f32 v64, v64
    v_exp_f32 v65, v65
    v_smfmac_f32_32x32x32_bf16 v[112:127], v[192:195], v[56:63], v2
    v_exp_f32 v66, v66
    v_exp_f32 v67, v67
    v_exp_f32 v68, v68
    v_exp_f32 v69, v69
    v_mfma_f32_32x32x16_bf16 v[16:31], v[168:171], v[144:147], v[16:31]
    v_exp_f32 v70, v70
    v_exp_f32 v71, v71
    v_exp_f32 v72, v72
    v_exp_f32 v73, v73
    v_mfma_f32_32x32x16_bf16 v[32:47], v[168:171], v[148:151], v[32:47]
    v_exp_f32 v74, v74
    v_exp_f32 v75, v75
    v_exp_f32 v76, v76
    v_exp_f32 v77, v77
    v_smfmac_f32_32x32x32_bf16 v[128:143], v[188:191], v[64:71], v2
    v_exp_f32 v78, v78
    v_exp_f32 v79, v79
    v_exp_f32 v16, v16
    v_exp_f32 v17, v17
    v_smfmac_f32_32x32x32_bf16 v[128:143], v[192:195], v[72:79], v2
    v_exp_f32 v18, v18
    v_exp_f32 v19, v19
    ds_read_b128 v[172:175], v212 offset:26176
    v_exp_f32 v20, v20
    v_mfma_f32_32x32x4bf16_1k v[48:79], v[178:179], v[164:165], 0
    v_exp_f32 v21, v21
    v_exp_f32 v22, v22
    v_exp_f32 v23, v23
    v_exp_f32 v24, v24
    v_exp_f32 v25, v25
    v_exp_f32 v26, v26
    v_exp_f32 v27, v27
    v_exp_f32 v28, v28
    v_smfmac_f32_32x32x32_bf16 v[80:95], v[180:183], v[16:23], v2
    v_exp_f32 v29, v29
    v_exp_f32 v30, v30
    ds_read_b128 v[188:191], v213 offset:27200
    v_exp_f32 v31, v31
    v_exp_f32 v32, v32
    ds_read2st64_b32 v[176:177], v215 offset0:111 offset1:112
    v_exp_f32 v33, v33
    v_smfmac_f32_32x32x32_bf16 v[80:95], v[184:187], v[24:31], v2
    v_exp_f32 v34, v34
    v_exp_f32 v35, v35
    ds_read_b128 v[192:195], v213 offset:27808
    v_exp_f32 v36, v36
    v_exp_f32 v37, v37
    v_mfma_f32_32x32x16_bf16 v[48:63], v[168:171], v[152:155], v[48:63]
    v_exp_f32 v38, v38
    v_exp_f32 v39, v39
    v_exp_f32 v40, v40
    v_exp_f32 v41, v41
    v_mfma_f32_32x32x16_bf16 v[64:79], v[168:171], v[156:159], v[64:79]
    v_exp_f32 v42, v42
    v_exp_f32 v43, v43
    v_exp_f32 v44, v44
    v_exp_f32 v45, v45
    v_smfmac_f32_32x32x32_bf16 v[96:111], v[180:183], v[32:39], v2
    v_exp_f32 v46, v46
    v_exp_f32 v47, v47
    v_exp_f32 v48, v48
    v_exp_f32 v49, v49
    v_smfmac_f32_32x32x32_bf16 v[96:111], v[184:187], v[40:47], v2
    v_exp_f32 v50, v50
    v_exp_f32 v51, v51
    v_exp_f32 v52, v52
    s_waitcnt lgkmcnt(0)
    v_mfma_f32_32x32x4bf16_1k v[16:47], v[178:179], v[162:163], 0
    v_exp_f32 v53, v53
    v_exp_f32 v54, v54
    v_exp_f32 v55, v55
    v_exp_f32 v56, v56
    v_exp_f32 v57, v57
    v_exp_f32 v58, v58
    v_exp_f32 v59, v59
    v_exp_f32 v60, v60
    v_smfmac_f32_32x32x32_bf16 v[112:127], v[180:183], v[48:55], v2
    v_exp_f32 v61, v61
    v_exp_f32 v62, v62
    v_exp_f32 v63, v63
    v_exp_f32 v64, v64
    v_exp_f32 v65, v65
    v_smfmac_f32_32x32x32_bf16 v[112:127], v[184:187], v[56:63], v2
    v_exp_f32 v66, v66
    v_exp_f32 v67, v67
    v_exp_f32 v68, v68
    v_exp_f32 v69, v69
    v_mfma_f32_32x32x16_bf16 v[16:31], v[172:175], v[144:147], v[16:31]
    v_exp_f32 v70, v70
    v_exp_f32 v71, v71
    v_exp_f32 v72, v72
    v_exp_f32 v73, v73
    v_mfma_f32_32x32x16_bf16 v[32:47], v[172:175], v[148:151], v[32:47]
    v_exp_f32 v74, v74
    v_exp_f32 v75, v75
    v_exp_f32 v76, v76
    v_exp_f32 v77, v77
    v_smfmac_f32_32x32x32_bf16 v[128:143], v[180:183], v[64:71], v2
    v_exp_f32 v78, v78
    v_exp_f32 v79, v79
    v_exp_f32 v16, v16
    v_exp_f32 v17, v17
    v_smfmac_f32_32x32x32_bf16 v[128:143], v[184:187], v[72:79], v2
    v_exp_f32 v18, v18
    v_exp_f32 v19, v19
    ds_read_b128 v[168:171], v212 offset:28928
    v_exp_f32 v20, v20
    v_mfma_f32_32x32x4bf16_1k v[48:79], v[178:179], v[166:167], 0
    v_exp_f32 v21, v21
    v_exp_f32 v22, v22
    v_exp_f32 v23, v23
    v_exp_f32 v24, v24
    v_exp_f32 v25, v25
    v_exp_f32 v26, v26
    v_exp_f32 v27, v27
    v_exp_f32 v28, v28
    v_smfmac_f32_32x32x32_bf16 v[80:95], v[188:191], v[16:23], v2
    v_exp_f32 v29, v29
    v_exp_f32 v30, v30
    ds_read_b128 v[180:183], v213 offset:29952
    v_exp_f32 v31, v31
    s_setprio 0
    v_exp_f32 v32, v32
    v_exp_f32 v33, v33
    v_smfmac_f32_32x32x32_bf16 v[80:95], v[192:195], v[24:31], v2
    v_exp_f32 v34, v34
    v_exp_f32 v35, v35
    ds_read_b128 v[184:187], v213 offset:30560
    v_exp_f32 v36, v36
    v_exp_f32 v37, v37
    v_mfma_f32_32x32x16_bf16 v[48:63], v[172:175], v[152:155], v[48:63]
    v_exp_f32 v38, v38
    v_exp_f32 v39, v39
    v_exp_f32 v40, v40
    v_exp_f32 v41, v41
    v_mfma_f32_32x32x16_bf16 v[64:79], v[172:175], v[156:159], v[64:79]
    v_exp_f32 v42, v42
    v_exp_f32 v43, v43
    v_exp_f32 v44, v44
    v_exp_f32 v45, v45
    v_smfmac_f32_32x32x32_bf16 v[96:111], v[188:191], v[32:39], v2
    v_exp_f32 v46, v46
    v_exp_f32 v47, v47
    v_exp_f32 v48, v48
    v_exp_f32 v49, v49
    v_smfmac_f32_32x32x32_bf16 v[96:111], v[192:195], v[40:47], v2
    v_exp_f32 v50, v50
    v_exp_f32 v51, v51
    v_exp_f32 v52, v52
    s_waitcnt lgkmcnt(0)
    v_mfma_f32_32x32x4bf16_1k v[16:47], v[176:177], v[160:161], 0
    v_exp_f32 v53, v53
    v_exp_f32 v54, v54
    v_exp_f32 v55, v55
    v_exp_f32 v56, v56
    v_exp_f32 v57, v57
    v_exp_f32 v58, v58
    v_exp_f32 v59, v59
    v_exp_f32 v60, v60
    v_smfmac_f32_32x32x32_bf16 v[112:127], v[188:191], v[48:55], v2
    v_exp_f32 v61, v61
    v_exp_f32 v62, v62
    v_exp_f32 v63, v63
    v_exp_f32 v64, v64
    v_exp_f32 v65, v65
    v_smfmac_f32_32x32x32_bf16 v[112:127], v[192:195], v[56:63], v2
    v_exp_f32 v66, v66
    v_exp_f32 v67, v67
    v_exp_f32 v68, v68
    v_exp_f32 v69, v69
    v_mfma_f32_32x32x16_bf16 v[16:31], v[168:171], v[144:147], v[16:31]
    v_exp_f32 v70, v70
    v_exp_f32 v71, v71
    v_exp_f32 v72, v72
    v_exp_f32 v73, v73
    v_mfma_f32_32x32x16_bf16 v[32:47], v[168:171], v[148:151], v[32:47]
    v_exp_f32 v74, v74
    v_exp_f32 v75, v75
    v_exp_f32 v76, v76
    v_exp_f32 v77, v77
    v_smfmac_f32_32x32x32_bf16 v[128:143], v[188:191], v[64:71], v2
    v_exp_f32 v78, v78
    v_exp_f32 v79, v79
    s_setprio 2
    v_exp_f32 v16, v16
    v_exp_f32 v17, v17
    v_smfmac_f32_32x32x32_bf16 v[128:143], v[192:195], v[72:79], v2
    v_exp_f32 v18, v18
    v_exp_f32 v19, v19
    ds_read_b128 v[172:175], v212 offset:31168
    v_exp_f32 v20, v20
    v_mfma_f32_32x32x4bf16_1k v[48:79], v[176:177], v[164:165], 0
    v_exp_f32 v21, v21
    v_exp_f32 v22, v22
    v_exp_f32 v23, v23
    v_exp_f32 v24, v24
    v_exp_f32 v25, v25
    v_exp_f32 v26, v26
    v_exp_f32 v27, v27
    v_exp_f32 v28, v28
    v_smfmac_f32_32x32x32_bf16 v[80:95], v[180:183], v[16:23], v2
    v_exp_f32 v29, v29
    v_exp_f32 v30, v30
    ds_read_b128 v[188:191], v213 offset:32192
    v_exp_f32 v31, v31
    v_exp_f32 v32, v32
    ds_read2st64_b32 v[178:179], v216 offset0:111 offset1:112
    v_exp_f32 v33, v33
    v_smfmac_f32_32x32x32_bf16 v[80:95], v[184:187], v[24:31], v2
    v_exp_f32 v34, v34
    v_exp_f32 v35, v35
    ds_read_b128 v[192:195], v213 offset:32800
    v_exp_f32 v36, v36
    v_exp_f32 v37, v37
    v_mfma_f32_32x32x16_bf16 v[48:63], v[168:171], v[152:155], v[48:63]
    v_exp_f32 v38, v38
    v_exp_f32 v39, v39
    v_exp_f32 v40, v40
    v_exp_f32 v41, v41
    v_mfma_f32_32x32x16_bf16 v[64:79], v[168:171], v[156:159], v[64:79]
    v_exp_f32 v42, v42
    v_exp_f32 v43, v43
    v_exp_f32 v44, v44
    v_exp_f32 v45, v45
    v_smfmac_f32_32x32x32_bf16 v[96:111], v[180:183], v[32:39], v2
    v_exp_f32 v46, v46
    v_exp_f32 v47, v47
    v_exp_f32 v48, v48
    v_exp_f32 v49, v49
    v_smfmac_f32_32x32x32_bf16 v[96:111], v[184:187], v[40:47], v2
    v_exp_f32 v50, v50
    v_exp_f32 v51, v51
    v_exp_f32 v52, v52
    s_waitcnt lgkmcnt(0)
    v_mfma_f32_32x32x4bf16_1k v[16:47], v[176:177], v[162:163], 0
    v_exp_f32 v53, v53
    v_exp_f32 v54, v54
    v_exp_f32 v55, v55
    v_exp_f32 v56, v56
    v_exp_f32 v57, v57
    v_exp_f32 v58, v58
    v_exp_f32 v59, v59
    v_exp_f32 v60, v60
    v_smfmac_f32_32x32x32_bf16 v[112:127], v[180:183], v[48:55], v2
    v_exp_f32 v61, v61
    v_exp_f32 v62, v62
    v_exp_f32 v63, v63
    v_exp_f32 v64, v64
    v_exp_f32 v65, v65
    v_smfmac_f32_32x32x32_bf16 v[112:127], v[184:187], v[56:63], v2
    v_exp_f32 v66, v66
    v_exp_f32 v67, v67
    v_exp_f32 v68, v68
    v_exp_f32 v69, v69
    v_mfma_f32_32x32x16_bf16 v[16:31], v[172:175], v[144:147], v[16:31]
    v_exp_f32 v70, v70
    v_exp_f32 v71, v71
    v_exp_f32 v72, v72
    v_exp_f32 v73, v73
    v_mfma_f32_32x32x16_bf16 v[32:47], v[172:175], v[148:151], v[32:47]
    v_exp_f32 v74, v74
    v_exp_f32 v75, v75
    v_exp_f32 v76, v76
    v_exp_f32 v77, v77
    v_smfmac_f32_32x32x32_bf16 v[128:143], v[180:183], v[64:71], v2
    v_exp_f32 v78, v78
    v_exp_f32 v79, v79
    s_and_b32 s44, s35, 3
    s_mul_i32 s3, s44, 5120
    s_cmp_ge_u32 s35, 4
    s_mov_b32 s45, 55296
    s_cselect_b32 s45, 131072, s45
    s_add_u32 s3, s3, s45
    s_cmp_ge_u32 s35, 4
    s_mov_b32 s45, 151552
    s_cselect_b32 s45, 156672, s45
    s_cmp_eq_u32 s44, 3
    s_cselect_b32 s3, s45, s3
    v_lshl_add_u32 v13, v1, 4, s3
    s_xor_b32 s37, s35, 4
    s_and_b32 s44, s37, 3
    s_mul_i32 s3, s44, 5120
    s_cmp_ge_u32 s37, 4
    s_mov_b32 s45, 55296
    s_cselect_b32 s45, 131072, s45
    s_add_u32 s3, s3, s45
    s_cmp_ge_u32 s37, 4
    s_mov_b32 s45, 151552
    s_cselect_b32 s45, 156672, s45
    s_cmp_eq_u32 s44, 3
    s_cselect_b32 s3, s45, s3
    v_lshl_add_u32 v14, v1, 4, s3
    v_lshl_add_u32 v9, v1, 2, s3
    v_lshlrev_b32 v12, 2, v1
    v_mov_b32 v10, 161792
    v_mov_b32 v11, 0
    ds_write_b32 v10, v11
    s_and_b32 s36, s33, 1
    s_lshl_b32 s36, s36, 1
    s_lshr_b32 s37, s35, 2
    s_add_u32 s36, s36, s37
    s_lshl_b32 s37, s53, 2
    s_add_u32 s36, s36, s37
    s_mul_i32 s36, s36, 36
    s_mul_i32 s37, s34, 9
    s_add_u32 s36, s36, s37
    s_lshl_b32 s36, s36, 10
    s_and_b32 s37, s35, 3
    s_lshl_b32 s61, s37, 8
    s_add_u32 s61, s61, s36
    s_add_u32 s61, s61, 8192
    s_lshl_b32 s37, s37, 11
    s_add_u32 s60, s36, s37
    s_and_b32 s36, s33, 1
    s_lshl_b32 s36, s36, 1
    s_and_b32 s43, s34, 1
    s_lshr_b32 s37, s35, 2
    s_and_b32 s40, s35, 1
    s_xor_b32 s38, s40, s37
    s_xor_b32 s38, s38, s43
    s_xor_b32 s38, s38, 1
    s_add_u32 s38, s38, s36
    s_lshr_b32 s39, s34, 1
    s_xor_b32 s39, s39, s37
    s_xor_b32 s37, s37, s43
    s_lshr_b32 s3, s34, 1
    s_xor_b32 s40, s40, s3
    s_xor_b32 s36, s36, 2
    s_add_u32 s40, s40, s36
    s_bitcmp1_b32 s35, 1
    s_cselect_b32 s38, s40, s38
    s_cselect_b32 s39, s37, s39
    s_and_b32 s3, s35, 6
    s_cmp_eq_u32 s3, 0
    s_cselect_b32 s37, s43, 0
    s_cselect_b32 s51, 1, 0
    s_lshl_b32 s36, s53, 2
    s_add_u32 s36, s36, s38
    s_lshl_b32 s36, s36, 1
    s_add_u32 s36, s36, s39
    s_lshl_b32 s36, s36, 1
    s_xor_b32 s3, s43, 1
    s_and_b32 s3, s3, s51
    s_add_u32 s36, s36, s3
    s_mul_i32 s57, s36, 9216
    s_mul_i32 s36, s39, 75776
    s_mul_i32 s40, s37, 9216
    s_add_u32 s41, s36, 36864
    s_add_u32 s65, s41, s40
    s_sub_u32 s66, s41, s40
    s_add_u32 s66, s66, 9216
    s_lshl_b32 s40, s40, 1
    s_add_u32 s63, s36, s40
    s_sub_u32 s64, s36, s40
    s_add_u32 s64, s64, 18432
    s_lshl_b32 s3, s38, 13
    s_cmp_ge_u32 s38, 2
    s_mov_b32 s36, 55296
    s_cselect_b32 s36, 114688, s36
    s_add_u32 s67, s3, s36
    s_and_b32 s36, s53, 15
    s_lshl_b32 s36, s36, 2
    s_add_u32 s36, s36, s38
    s_mul_i32 s36, s36, 73728
    s_mul_i32 s37, s32, 1152
    s_add_u32 s40, s36, s37
    s_lshr_b32 s36, s34, 1
    s_lshl_b32 s36, s36, 6
    s_add_u32 s41, s40, s36
    s_add_u32 s41, s41, 1024
    s_lshl_b32 s36, s52, 7
    s_add_u32 s40, s40, s36
    s_add_u32 s56, s40, 36864
    s_add_u32 s42, s41, 36864
    s_bitcmp1_b32 s38, 0
    s_mov_b32 s96, 131072
    s_cselect_b32 s96, 55296, s96
    s_mov_b32 s97, 156672
    s_cselect_b32 s97, 151552, s97
    s_lshl_b32 s37, s53, 10
    s_add_u32 s37, s37, 32768
    s_lshl_b32 s36, s52, 7
    s_add_u32 s36, s36, s37
    v_exp_f32 v16, v16
    v_exp_f32 v17, v17
    v_smfmac_f32_32x32x32_bf16 v[128:143], v[184:187], v[72:79], v2
    v_exp_f32 v18, v18
    v_exp_f32 v19, v19
    ds_read_b128 v[168:171], v212 offset:33408
    v_exp_f32 v20, v20
    v_mfma_f32_32x32x4bf16_1k v[48:79], v[176:177], v[166:167], 0
    v_exp_f32 v21, v21
    v_exp_f32 v22, v22
    v_exp_f32 v23, v23
    v_exp_f32 v24, v24
    v_exp_f32 v25, v25
    v_exp_f32 v26, v26
    v_exp_f32 v27, v27
    v_exp_f32 v28, v28
    v_smfmac_f32_32x32x32_bf16 v[80:95], v[188:191], v[16:23], v2
    v_exp_f32 v29, v29
    v_exp_f32 v30, v30
    ds_read_b128 v[180:183], v213 offset:34432
    v_exp_f32 v31, v31
    v_exp_f32 v32, v32
    v_exp_f32 v33, v33
    v_smfmac_f32_32x32x32_bf16 v[80:95], v[192:195], v[24:31], v2
    v_exp_f32 v34, v34
    v_exp_f32 v35, v35
    ds_read_b128 v[184:187], v213 offset:35040
    v_exp_f32 v36, v36
    v_exp_f32 v37, v37
    v_mfma_f32_32x32x16_bf16 v[48:63], v[172:175], v[152:155], v[48:63]
    v_exp_f32 v38, v38
    v_exp_f32 v39, v39
    v_exp_f32 v40, v40
    v_exp_f32 v41, v41
    v_mfma_f32_32x32x16_bf16 v[64:79], v[172:175], v[156:159], v[64:79]
    v_exp_f32 v42, v42
    v_exp_f32 v43, v43
    v_exp_f32 v44, v44
    v_exp_f32 v45, v45
    v_smfmac_f32_32x32x32_bf16 v[96:111], v[188:191], v[32:39], v2
    v_exp_f32 v46, v46
    v_exp_f32 v47, v47
    s_setprio 0
    v_exp_f32 v48, v48
    v_exp_f32 v49, v49
    v_smfmac_f32_32x32x32_bf16 v[96:111], v[192:195], v[40:47], v2
    v_exp_f32 v50, v50
    v_exp_f32 v51, v51
    v_exp_f32 v52, v52
    s_waitcnt lgkmcnt(0)
    v_mfma_f32_32x32x4bf16_1k v[16:47], v[178:179], v[160:161], 0
    v_exp_f32 v53, v53
    v_exp_f32 v54, v54
    v_exp_f32 v55, v55
    v_exp_f32 v56, v56
    v_exp_f32 v57, v57
    v_exp_f32 v58, v58
    v_exp_f32 v59, v59
    v_exp_f32 v60, v60
    v_smfmac_f32_32x32x32_bf16 v[112:127], v[188:191], v[48:55], v2
    v_exp_f32 v61, v61
    v_exp_f32 v62, v62
    v_exp_f32 v63, v63
    v_exp_f32 v64, v64
    v_exp_f32 v65, v65
    v_smfmac_f32_32x32x32_bf16 v[112:127], v[192:195], v[56:63], v2
    v_exp_f32 v66, v66
    v_exp_f32 v67, v67
    v_exp_f32 v68, v68
    v_exp_f32 v69, v69
    v_mfma_f32_32x32x16_bf16 v[16:31], v[168:171], v[144:147], v[16:31]
    v_exp_f32 v70, v70
    v_exp_f32 v71, v71
    v_exp_f32 v72, v72
    v_exp_f32 v73, v73
    v_mfma_f32_32x32x16_bf16 v[32:47], v[168:171], v[148:151], v[32:47]
    v_exp_f32 v74, v74
    v_exp_f32 v75, v75
    v_exp_f32 v76, v76
    v_exp_f32 v77, v77
    v_smfmac_f32_32x32x32_bf16 v[128:143], v[188:191], v[64:71], v2
    v_exp_f32 v78, v78
    v_exp_f32 v79, v79
    s_waitcnt vmcnt(0)
    s_barrier
    s_setprio 2
    v_exp_f32 v16, v16
    v_exp_f32 v17, v17
    v_smfmac_f32_32x32x32_bf16 v[128:143], v[192:195], v[72:79], v2
    v_exp_f32 v18, v18
    v_exp_f32 v19, v19
    ds_read_b128 v[172:175], v212 offset:35648
    v_exp_f32 v20, v20
    v_mfma_f32_32x32x4bf16_1k v[48:79], v[178:179], v[164:165], 0
    v_exp_f32 v21, v21
    v_exp_f32 v22, v22
    v_exp_f32 v23, v23
    v_exp_f32 v24, v24
    v_exp_f32 v25, v25
    v_exp_f32 v26, v26
    v_exp_f32 v27, v27
    v_exp_f32 v28, v28
    v_smfmac_f32_32x32x32_bf16 v[80:95], v[180:183], v[16:23], v2
    v_exp_f32 v29, v29
    v_exp_f32 v30, v30
    ds_read_b128 v[188:191], v213 offset:36672
    v_exp_f32 v31, v31
    v_exp_f32 v32, v32
    v_exp_f32 v33, v33
    v_smfmac_f32_32x32x32_bf16 v[80:95], v[184:187], v[24:31], v2
    v_exp_f32 v34, v34
    v_exp_f32 v35, v35
    ds_read_b128 v[192:195], v213 offset:37280
    v_exp_f32 v36, v36
    v_exp_f32 v37, v37
    v_mfma_f32_32x32x16_bf16 v[48:63], v[168:171], v[152:155], v[48:63]
    v_exp_f32 v38, v38
    v_exp_f32 v39, v39
    v_exp_f32 v40, v40
    v_exp_f32 v41, v41
    v_mfma_f32_32x32x16_bf16 v[64:79], v[168:171], v[156:159], v[64:79]
    v_exp_f32 v42, v42
    v_exp_f32 v43, v43
    v_exp_f32 v44, v44
    v_exp_f32 v45, v45
    v_smfmac_f32_32x32x32_bf16 v[96:111], v[180:183], v[32:39], v2
    v_exp_f32 v46, v46
    v_exp_f32 v47, v47
    v_exp_f32 v48, v48
    v_exp_f32 v49, v49
    v_smfmac_f32_32x32x32_bf16 v[96:111], v[184:187], v[40:47], v2
    v_exp_f32 v50, v50
    v_exp_f32 v51, v51
    v_exp_f32 v52, v52
    s_waitcnt lgkmcnt(0)
    v_mfma_f32_32x32x4bf16_1k v[16:47], v[178:179], v[162:163], 0
    v_exp_f32 v53, v53
    v_exp_f32 v54, v54
    v_exp_f32 v55, v55
    v_exp_f32 v56, v56
    v_exp_f32 v57, v57
    v_exp_f32 v58, v58
    v_exp_f32 v59, v59
    v_exp_f32 v60, v60
    v_smfmac_f32_32x32x32_bf16 v[112:127], v[180:183], v[48:55], v2
    v_exp_f32 v61, v61
    v_exp_f32 v62, v62
    v_exp_f32 v63, v63
    v_exp_f32 v64, v64
    v_exp_f32 v65, v65
    v_smfmac_f32_32x32x32_bf16 v[112:127], v[184:187], v[56:63], v2
    v_exp_f32 v66, v66
    v_exp_f32 v67, v67
    v_exp_f32 v68, v68
    v_exp_f32 v69, v69
    v_mfma_f32_32x32x16_bf16 v[16:31], v[172:175], v[144:147], v[16:31]
    v_exp_f32 v70, v70
    v_exp_f32 v71, v71
    v_exp_f32 v72, v72
    v_exp_f32 v73, v73
    v_mfma_f32_32x32x16_bf16 v[32:47], v[172:175], v[148:151], v[32:47]
    v_exp_f32 v74, v74
    v_exp_f32 v75, v75
    v_exp_f32 v76, v76
    v_exp_f32 v77, v77
    v_smfmac_f32_32x32x32_bf16 v[128:143], v[180:183], v[64:71], v2
    v_exp_f32 v78, v78
    v_exp_f32 v79, v79
    s_setprio 0
    v_exp_f32 v16, v16
    v_exp_f32 v17, v17
    v_smfmac_f32_32x32x32_bf16 v[128:143], v[184:187], v[72:79], v2
    v_exp_f32 v18, v18
    v_exp_f32 v19, v19
    v_exp_f32 v20, v20
    v_mfma_f32_32x32x4bf16_1k v[48:79], v[178:179], v[166:167], 0
    v_exp_f32 v21, v21
    v_exp_f32 v22, v22
    v_exp_f32 v23, v23
    v_exp_f32 v24, v24
    v_exp_f32 v25, v25
    v_exp_f32 v26, v26
    v_exp_f32 v27, v27
    v_exp_f32 v28, v28
    v_smfmac_f32_32x32x32_bf16 v[80:95], v[188:191], v[16:23], v2
    v_exp_f32 v29, v29
    v_exp_f32 v30, v30
    v_exp_f32 v31, v31
    v_exp_f32 v32, v32
    v_exp_f32 v33, v33
    v_smfmac_f32_32x32x32_bf16 v[80:95], v[192:195], v[24:31], v2
    v_exp_f32 v34, v34
    v_exp_f32 v35, v35
    v_exp_f32 v36, v36
    v_exp_f32 v37, v37
    v_mfma_f32_32x32x16_bf16 v[48:63], v[172:175], v[152:155], v[48:63]
    v_exp_f32 v38, v38
    v_exp_f32 v39, v39
    v_exp_f32 v40, v40
    v_exp_f32 v41, v41
    v_mfma_f32_32x32x16_bf16 v[64:79], v[172:175], v[156:159], v[64:79]
    v_exp_f32 v42, v42
    v_exp_f32 v43, v43
    v_exp_f32 v44, v44
    v_exp_f32 v45, v45
    v_smfmac_f32_32x32x32_bf16 v[96:111], v[188:191], v[32:39], v2
    v_exp_f32 v46, v46
    v_exp_f32 v47, v47
    ds_write_b128 v13, v[80:83] offset:0
    v_exp_f32 v48, v48
    v_exp_f32 v49, v49
    v_smfmac_f32_32x32x32_bf16 v[96:111], v[192:195], v[40:47], v2
    ds_write_b128 v13, v[84:87] offset:1024
    v_exp_f32 v50, v50
    v_exp_f32 v51, v51
    v_exp_f32 v52, v52
    ds_write_b64 v13, v[88:89] offset:4096
    v_exp_f32 v53, v53
    v_exp_f32 v54, v54
    v_exp_f32 v55, v55
    v_exp_f32 v56, v56
    v_exp_f32 v57, v57
    v_smfmac_f32_32x32x32_bf16 v[112:127], v[188:191], v[48:55], v2
    v_exp_f32 v58, v58
    ds_write_b128 v13, v[96:99] offset:2048
    v_exp_f32 v59, v59
    v_exp_f32 v60, v60
    ds_write_b128 v13, v[100:103] offset:3072
    v_exp_f32 v61, v61
    v_exp_f32 v62, v62
    ds_write_b64 v13, v[104:105] offset:4104
    v_exp_f32 v63, v63
    v_exp_f32 v64, v64
    v_exp_f32 v65, v65
    v_exp_f32 v66, v66
    v_smfmac_f32_32x32x32_bf16 v[112:127], v[192:195], v[56:63], v2
    s_waitcnt lgkmcnt(0)
    s_barrier
    ds_read_b64 v[24:25], v14 offset:4096
    ds_read_b128 v[16:19], v14 offset:0
    ds_read_b128 v[20:23], v14 offset:1024
    ds_read_b64 v[40:41], v14 offset:4104
    ds_read_b128 v[32:35], v14 offset:2048
    ds_read_b128 v[36:39], v14 offset:3072
    v_exp_f32 v67, v67
    v_exp_f32 v68, v68
    v_exp_f32 v69, v69
    v_exp_f32 v70, v70
    v_exp_f32 v71, v71
    v_exp_f32 v72, v72
    v_exp_f32 v73, v73
    v_smfmac_f32_32x32x32_bf16 v[128:143], v[188:191], v[64:71], v2
    v_exp_f32 v74, v74
    v_exp_f32 v75, v75
    v_exp_f32 v76, v76
    v_exp_f32 v77, v77
    v_exp_f32 v78, v78
    v_exp_f32 v79, v79
    s_nop 1
    v_smfmac_f32_32x32x32_bf16 v[128:143], v[192:195], v[72:79], v2
    s_setprio 2
    s_branch L_con_attD
L_con_roleB:
    s_setprio 1
    s_lshr_b32 s37, s2, 3
    s_add_u32 s36, s58, 12288
    s_add_u32 s38, s36, 75776
    s_and_b32 s37, s37, 15
    s_lshl_b32 s39, s37, 12
    s_add_u32 s3, s39, s36
    s_mov_b32 m0, s3
    s_cmp_ge_u32 s37, 13
    buffer_load_dwordx4 v15, s[16:19], s3 offen sc1 lds
    s_cbranch_scc1 L_con_s20
    s_add_u32 s3, s39, s38
    s_mov_b32 m0, s3
    s_nop 0
    buffer_load_dwordx4 v15, s[16:19], s3 offen sc1 lds
L_con_s20:
    s_add_u32 s37, s37, 1
    s_and_b32 s37, s37, 15
    s_lshl_b32 s39, s37, 12
    s_add_u32 s3, s39, s36
    s_mov_b32 m0, s3
    s_cmp_ge_u32 s37, 13
    buffer_load_dwordx4 v15, s[16:19], s3 offen sc1 lds
    s_cbranch_scc1 L_con_s21
    s_add_u32 s3, s39, s38
    s_mov_b32 m0, s3
    s_nop 0
    buffer_load_dwordx4 v15, s[16:19], s3 offen sc1 lds
L_con_s21:
    s_add_u32 s37, s37, 1
    s_and_b32 s37, s37, 15
    s_lshl_b32 s39, s37, 12
    s_add_u32 s3, s39, s36
    s_mov_b32 m0, s3
    s_cmp_ge_u32 s37, 13
    buffer_load_dwordx4 v15, s[16:19], s3 offen sc1 lds
    s_cbranch_scc1 L_con_s22
    s_add_u32 s3, s39, s38
    s_mov_b32 m0, s3
    s_nop 0
    buffer_load_dwordx4 v15, s[16:19], s3 offen sc1 lds
L_con_s22:
    s_add_u32 s37, s37, 1
    s_and_b32 s37, s37, 15
    s_lshl_b32 s39, s37, 12
    s_add_u32 s3, s39, s36
    s_mov_b32 m0, s3
    s_cmp_ge_u32 s37, 13
    buffer_load_dwordx4 v15, s[16:19], s3 offen sc1 lds
    s_cbranch_scc1 L_con_s23
    s_add_u32 s3, s39, s38
    s_mov_b32 m0, s3
    s_nop 0
    buffer_load_dwordx4 v15, s[16:19], s3 offen sc1 lds
L_con_s23:
    s_add_u32 s37, s37, 1
    s_and_b32 s37, s37, 15
    s_lshl_b32 s39, s37, 12
    s_add_u32 s3, s39, s36
    s_mov_b32 m0, s3
    s_cmp_ge_u32 s37, 13
    buffer_load_dwordx4 v15, s[16:19], s3 offen sc1 lds
    s_cbranch_scc1 L_con_s24
    s_add_u32 s3, s39, s38
    s_mov_b32 m0, s3
    s_nop 0
    buffer_load_dwordx4 v15, s[16:19], s3 offen sc1 lds
L_con_s24:
    s_add_u32 s37, s37, 1
    s_and_b32 s37, s37, 15
    s_lshl_b32 s39, s37, 12
    s_add_u32 s3, s39, s36
    s_mov_b32 m0, s3
    s_cmp_ge_u32 s37, 13
    buffer_load_dwordx4 v15, s[16:19], s3 offen sc1 lds
    s_cbranch_scc1 L_con_s25
    s_add_u32 s3, s39, s38
    s_mov_b32 m0, s3
    s_nop 0
    buffer_load_dwordx4 v15, s[16:19], s3 offen sc1 lds
L_con_s25:
    s_add_u32 s37, s37, 1
    s_and_b32 s37, s37, 15
    s_lshl_b32 s39, s37, 12
    s_add_u32 s3, s39, s36
    s_mov_b32 m0, s3
    s_cmp_ge_u32 s37, 13
    buffer_load_dwordx4 v15, s[16:19], s3 offen sc1 lds
    s_cbranch_scc1 L_con_s26
    s_add_u32 s3, s39, s38
    s_mov_b32 m0, s3
    s_nop 0
    buffer_load_dwordx4 v15, s[16:19], s3 offen sc1 lds
L_con_s26:
    s_add_u32 s37, s37, 1
    s_and_b32 s37, s37, 15
    s_lshl_b32 s39, s37, 12
    s_add_u32 s3, s39, s36
    s_mov_b32 m0, s3
    s_cmp_ge_u32 s37, 13
    buffer_load_dwordx4 v15, s[16:19], s3 offen sc1 lds
    s_cbranch_scc1 L_con_s27
    s_add_u32 s3, s39, s38
    s_mov_b32 m0, s3
    s_nop 0
    buffer_load_dwordx4 v15, s[16:19], s3 offen sc1 lds
L_con_s27:
    s_add_u32 s37, s37, 1
    s_and_b32 s37, s37, 15
    s_lshl_b32 s39, s37, 12
    s_add_u32 s3, s39, s36
    s_mov_b32 m0, s3
    s_cmp_ge_u32 s37, 13
    buffer_load_dwordx4 v15, s[16:19], s3 offen sc1 lds
    s_cbranch_scc1 L_con_s28
    s_add_u32 s3, s39, s38
    s_mov_b32 m0, s3
    s_nop 0
    buffer_load_dwordx4 v15, s[16:19], s3 offen sc1 lds
L_con_s28:
    s_add_u32 s37, s37, 1
    s_and_b32 s37, s37, 15
    s_lshl_b32 s39, s37, 12
    s_add_u32 s3, s39, s36
    s_mov_b32 m0, s3
    s_cmp_ge_u32 s37, 13
    buffer_load_dwordx4 v15, s[16:19], s3 offen sc1 lds
    s_cbranch_scc1 L_con_s29
    s_add_u32 s3, s39, s38
    s_mov_b32 m0, s3
    s_nop 0
    buffer_load_dwordx4 v15, s[16:19], s3 offen sc1 lds
L_con_s29:
    s_add_u32 s37, s37, 1
    s_and_b32 s37, s37, 15
    s_lshl_b32 s39, s37, 12
    s_add_u32 s3, s39, s36
    s_mov_b32 m0, s3
    s_cmp_ge_u32 s37, 13
    buffer_load_dwordx4 v15, s[16:19], s3 offen sc1 lds
    s_cbranch_scc1 L_con_s210
    s_add_u32 s3, s39, s38
    s_mov_b32 m0, s3
    s_nop 0
    buffer_load_dwordx4 v15, s[16:19], s3 offen sc1 lds
L_con_s210:
    s_add_u32 s37, s37, 1
    s_and_b32 s37, s37, 15
    s_lshl_b32 s39, s37, 12
    s_add_u32 s3, s39, s36
    s_mov_b32 m0, s3
    s_cmp_ge_u32 s37, 13
    buffer_load_dwordx4 v15, s[16:19], s3 offen sc1 lds
    s_cbranch_scc1 L_con_s211
    s_add_u32 s3, s39, s38
    s_mov_b32 m0, s3
    s_nop 0
    buffer_load_dwordx4 v15, s[16:19], s3 offen sc1 lds
L_con_s211:
    s_add_u32 s37, s37, 1
    s_and_b32 s37, s37, 15
    s_lshl_b32 s39, s37, 12
    s_add_u32 s3, s39, s36
    s_mov_b32 m0, s3
    s_cmp_ge_u32 s37, 13
    buffer_load_dwordx4 v15, s[16:19], s3 offen sc1 lds
    s_cbranch_scc1 L_con_s212
    s_add_u32 s3, s39, s38
    s_mov_b32 m0, s3
    s_nop 0
    buffer_load_dwordx4 v15, s[16:19], s3 offen sc1 lds
L_con_s212:
    s_add_u32 s37, s37, 1
    s_and_b32 s37, s37, 15
    s_lshl_b32 s39, s37, 12
    s_add_u32 s3, s39, s36
    s_mov_b32 m0, s3
    s_cmp_ge_u32 s37, 13
    buffer_load_dwordx4 v15, s[16:19], s3 offen sc1 lds
    s_cbranch_scc1 L_con_s213
    s_add_u32 s3, s39, s38
    s_mov_b32 m0, s3
    s_nop 0
    buffer_load_dwordx4 v15, s[16:19], s3 offen sc1 lds
L_con_s213:
    s_add_u32 s37, s37, 1
    s_and_b32 s37, s37, 15
    s_lshl_b32 s39, s37, 12
    s_add_u32 s3, s39, s36
    s_mov_b32 m0, s3
    s_cmp_ge_u32 s37, 13
    buffer_load_dwordx4 v15, s[16:19], s3 offen sc1 lds
    s_cbranch_scc1 L_con_s214
    s_add_u32 s3, s39, s38
    s_mov_b32 m0, s3
    s_nop 0
    buffer_load_dwordx4 v15, s[16:19], s3 offen sc1 lds
L_con_s214:
    s_add_u32 s37, s37, 1
    s_and_b32 s37, s37, 15
    s_lshl_b32 s39, s37, 12
    s_add_u32 s3, s39, s36
    s_mov_b32 m0, s3
    s_cmp_ge_u32 s37, 13
    buffer_load_dwordx4 v15, s[16:19], s3 offen sc1 lds
    s_cbranch_scc1 L_con_s215
    s_add_u32 s3, s39, s38
    s_mov_b32 m0, s3
    s_nop 0
    buffer_load_dwordx4 v15, s[16:19], s3 offen sc1 lds
L_con_s215:
    s_add_u32 s37, s37, 1
    ds_read_b128 v[168:171], v3 offset:512
    ds_read2_b32 v[144:145], v197 offset0:0 offset1:1
    ds_read2_b32 v[146:147], v197 offset0:2 offset1:3
    ds_read2st64_b32 v[176:177], v4 offset0:0 offset1:1
    ds_read_b32 v200, v199 offset:32
    ds_read2_b32 v[148:149], v197 offset0:9 offset1:10
    ds_read2_b32 v[150:151], v197 offset0:11 offset1:12
    ds_read_b32 v202, v205 offset:32
    ds_read2_b32 v[152:153], v198 offset0:0 offset1:1
    ds_read2_b32 v[154:155], v198 offset0:2 offset1:3
    ds_read_b128 v[180:183], v5 offset:1536
    ds_read_b128 v[184:187], v5 offset:2144
    s_waitcnt lgkmcnt(9)
    v_mfma_f32_32x32x16_bf16 v[16:31], v[168:171], v[144:147], 0
    s_waitcnt lgkmcnt(7)
    v_mfma_f32_32x32x8bf16_1k v[16:31], v[176:177], v[200:201], v[16:31]
    ds_read_b32 v164, v207 offset:32
    ds_read2_b32 v[156:157], v198 offset0:9 offset1:10
    ds_read2_b32 v[158:159], v198 offset0:11 offset1:12
    s_waitcnt lgkmcnt(8)
    v_mfma_f32_32x32x16_bf16 v[32:47], v[168:171], v[148:151], 0
    s_waitcnt lgkmcnt(7)
    v_mfma_f32_32x32x8bf16_1k v[32:47], v[176:177], v[202:203], v[32:47]
    ds_read_b32 v160, v196 offset:32
    ds_read_b32 v163, v196 offset:32
    ds_read_b32 v167, v207 offset:32
    s_nop 0
    s_waitcnt lgkmcnt(0)
    v_exp_f32 v16, v16
    v_exp_f32 v17, v17
    v_exp_f32 v18, v18
    v_exp_f32 v19, v19
    ds_read_b128 v[172:175], v3 offset:2752
    v_exp_f32 v20, v20
    v_mfma_f32_32x32x4bf16_1k v[48:79], v[176:177], v[164:165], 0
    v_exp_f32 v21, v21
    v_exp_f32 v22, v22
    v_exp_f32 v23, v23
    v_exp_f32 v24, v24
    v_exp_f32 v25, v25
    v_exp_f32 v26, v26
    v_exp_f32 v27, v27
    v_exp_f32 v28, v28
    v_smfmac_f32_32x32x32_bf16 v[80:95], v[180:183], v[16:23], v2
    v_exp_f32 v29, v29
    v_exp_f32 v30, v30
    ds_read_b128 v[188:191], v5 offset:3776
    v_exp_f32 v31, v31
    v_exp_f32 v32, v32
    ds_read2st64_b32 v[178:179], v214 offset0:0 offset1:1
    v_exp_f32 v33, v33
    v_smfmac_f32_32x32x32_bf16 v[80:95], v[184:187], v[24:31], v2
    v_exp_f32 v34, v34
    v_exp_f32 v35, v35
    ds_read_b128 v[192:195], v5 offset:4384
    v_exp_f32 v36, v36
    v_exp_f32 v37, v37
    v_mfma_f32_32x32x16_bf16 v[48:63], v[168:171], v[152:155], v[48:63]
    v_exp_f32 v38, v38
    v_exp_f32 v39, v39
    v_exp_f32 v40, v40
    v_exp_f32 v41, v41
    v_mfma_f32_32x32x16_bf16 v[64:79], v[168:171], v[156:159], v[64:79]
    v_exp_f32 v42, v42
    v_exp_f32 v43, v43
    v_exp_f32 v44, v44
    v_exp_f32 v45, v45
    v_smfmac_f32_32x32x32_bf16 v[96:111], v[180:183], v[32:39], v2
    v_exp_f32 v46, v46
    v_exp_f32 v47, v47
    v_exp_f32 v48, v48
    v_exp_f32 v49, v49
    v_smfmac_f32_32x32x32_bf16 v[96:111], v[184:187], v[40:47], v2
    v_exp_f32 v50, v50
    v_exp_f32 v51, v51
    v_exp_f32 v52, v52
    s_waitcnt lgkmcnt(0)
    v_mfma_f32_32x32x4bf16_1k v[16:47], v[176:177], v[162:163], 0
    v_exp_f32 v53, v53
    v_exp_f32 v54, v54
    v_exp_f32 v55, v55
    v_exp_f32 v56, v56
    v_exp_f32 v57, v57
    v_exp_f32 v58, v58
    v_exp_f32 v59, v59
    v_exp_f32 v60, v60
    v_smfmac_f32_32x32x32_bf16 v[112:127], v[180:183], v[48:55], v2
    v_exp_f32 v61, v61
    v_exp_f32 v62, v62
    v_exp_f32 v63, v63
    v_exp_f32 v64, v64
    v_exp_f32 v65, v65
    v_smfmac_f32_32x32x32_bf16 v[112:127], v[184:187], v[56:63], v2
    v_exp_f32 v66, v66
    v_exp_f32 v67, v67
    v_exp_f32 v68, v68
    v_exp_f32 v69, v69
    v_mfma_f32_32x32x16_bf16 v[16:31], v[172:175], v[144:147], v[16:31]
    v_exp_f32 v70, v70
    v_exp_f32 v71, v71
    v_exp_f32 v72, v72
    v_exp_f32 v73, v73
    v_mfma_f32_32x32x16_bf16 v[32:47], v[172:175], v[148:151], v[32:47]
    v_exp_f32 v74, v74
    v_exp_f32 v75, v75
    v_exp_f32 v76, v76
    v_exp_f32 v77, v77
    v_smfmac_f32_32x32x32_bf16 v[128:143], v[180:183], v[64:71], v2
    v_exp_f32 v78, v78
    v_exp_f32 v79, v79
    v_exp_f32 v16, v16
    v_exp_f32 v17, v17
    v_smfmac_f32_32x32x32_bf16 v[128:143], v[184:187], v[72:79], v2
    v_exp_f32 v18, v18
    v_exp_f32 v19, v19
    ds_read_b128 v[168:171], v3 offset:4992
    v_exp_f32 v20, v20
    v_mfma_f32_32x32x4bf16_1k v[48:79], v[176:177], v[166:167], 0
    v_exp_f32 v21, v21
    v_exp_f32 v22, v22
    v_exp_f32 v23, v23
    v_exp_f32 v24, v24
    v_exp_f32 v25, v25
    v_exp_f32 v26, v26
    v_exp_f32 v27, v27
    v_exp_f32 v28, v28
    v_smfmac_f32_32x32x32_bf16 v[80:95], v[188:191], v[16:23], v2
    v_exp_f32 v29, v29
    v_exp_f32 v30, v30
    ds_read_b128 v[180:183], v5 offset:6016
    v_exp_f32 v31, v31
    v_exp_f32 v32, v32
    v_exp_f32 v33, v33
    v_smfmac_f32_32x32x32_bf16 v[80:95], v[192:195], v[24:31], v2
    v_exp_f32 v34, v34
    v_exp_f32 v35, v35
    ds_read_b128 v[184:187], v5 offset:6624
    v_exp_f32 v36, v36
    v_exp_f32 v37, v37
    v_mfma_f32_32x32x16_bf16 v[48:63], v[172:175], v[152:155], v[48:63]
    v_exp_f32 v38, v38
    v_exp_f32 v39, v39
    v_exp_f32 v40, v40
    v_exp_f32 v41, v41
    v_mfma_f32_32x32x16_bf16 v[64:79], v[172:175], v[156:159], v[64:79]
    v_exp_f32 v42, v42
    v_exp_f32 v43, v43
    v_exp_f32 v44, v44
    v_exp_f32 v45, v45
    v_smfmac_f32_32x32x32_bf16 v[96:111], v[188:191], v[32:39], v2
    v_exp_f32 v46, v46
    v_exp_f32 v47, v47
    v_exp_f32 v48, v48
    v_exp_f32 v49, v49
    v_smfmac_f32_32x32x32_bf16 v[96:111], v[192:195], v[40:47], v2
    v_exp_f32 v50, v50
    v_exp_f32 v51, v51
    v_exp_f32 v52, v52
    s_waitcnt lgkmcnt(0)
    v_mfma_f32_32x32x4bf16_1k v[16:47], v[178:179], v[160:161], 0
    v_exp_f32 v53, v53
    v_exp_f32 v54, v54
    v_exp_f32 v55, v55
    v_exp_f32 v56, v56
    v_exp_f32 v57, v57
    v_exp_f32 v58, v58
    v_exp_f32 v59, v59
    v_exp_f32 v60, v60
    v_smfmac_f32_32x32x32_bf16 v[112:127], v[188:191], v[48:55], v2
    v_exp_f32 v61, v61
    v_exp_f32 v62, v62
    v_exp_f32 v63, v63
    v_exp_f32 v64, v64
    v_exp_f32 v65, v65
    v_smfmac_f32_32x32x32_bf16 v[112:127], v[192:195], v[56:63], v2
    v_exp_f32 v66, v66
    v_exp_f32 v67, v67
    v_exp_f32 v68, v68
    v_exp_f32 v69, v69
    v_mfma_f32_32x32x16_bf16 v[16:31], v[168:171], v[144:147], v[16:31]
    v_exp_f32 v70, v70
    v_exp_f32 v71, v71
    v_exp_f32 v72, v72
    v_exp_f32 v73, v73
    v_mfma_f32_32x32x16_bf16 v[32:47], v[168:171], v[148:151], v[32:47]
    v_exp_f32 v74, v74
    v_exp_f32 v75, v75
    v_exp_f32 v76, v76
    v_exp_f32 v77, v77
    v_smfmac_f32_32x32x32_bf16 v[128:143], v[188:191], v[64:71], v2
    v_exp_f32 v78, v78
    v_exp_f32 v79, v79
    v_exp_f32 v16, v16
    v_exp_f32 v17, v17
    v_smfmac_f32_32x32x32_bf16 v[128:143], v[192:195], v[72:79], v2
    v_exp_f32 v18, v18
    v_exp_f32 v19, v19
    ds_read_b128 v[172:175], v3 offset:7232
    v_exp_f32 v20, v20
    v_mfma_f32_32x32x4bf16_1k v[48:79], v[178:179], v[164:165], 0
    v_exp_f32 v21, v21
    v_exp_f32 v22, v22
    v_exp_f32 v23, v23
    v_exp_f32 v24, v24
    v_exp_f32 v25, v25
    v_exp_f32 v26, v26
    v_exp_f32 v27, v27
    v_exp_f32 v28, v28
    v_smfmac_f32_32x32x32_bf16 v[80:95], v[180:183], v[16:23], v2
    v_exp_f32 v29, v29
    v_exp_f32 v30, v30
    ds_read_b128 v[188:191], v5 offset:8256
    v_exp_f32 v31, v31
    v_exp_f32 v32, v32
    ds_read2st64_b32 v[176:177], v4 offset0:37 offset1:38
    v_exp_f32 v33, v33
    v_smfmac_f32_32x32x32_bf16 v[80:95], v[184:187], v[24:31], v2
    v_exp_f32 v34, v34
    v_exp_f32 v35, v35
    ds_read_b128 v[192:195], v5 offset:8864
    v_exp_f32 v36, v36
    v_exp_f32 v37, v37
    v_mfma_f32_32x32x16_bf16 v[48:63], v[168:171], v[152:155], v[48:63]
    v_exp_f32 v38, v38
    v_exp_f32 v39, v39
    v_exp_f32 v40, v40
    v_exp_f32 v41, v41
    v_mfma_f32_32x32x16_bf16 v[64:79], v[168:171], v[156:159], v[64:79]
    v_exp_f32 v42, v42
    v_exp_f32 v43, v43
    v_exp_f32 v44, v44
    v_exp_f32 v45, v45
    v_smfmac_f32_32x32x32_bf16 v[96:111], v[180:183], v[32:39], v2
    v_exp_f32 v46, v46
    v_exp_f32 v47, v47
    v_exp_f32 v48, v48
    v_exp_f32 v49, v49
    v_smfmac_f32_32x32x32_bf16 v[96:111], v[184:187], v[40:47], v2
    v_exp_f32 v50, v50
    v_exp_f32 v51, v51
    v_exp_f32 v52, v52
    s_waitcnt lgkmcnt(0)
    v_mfma_f32_32x32x4bf16_1k v[16:47], v[178:179], v[162:163], 0
    v_exp_f32 v53, v53
    v_exp_f32 v54, v54
    v_exp_f32 v55, v55
    v_exp_f32 v56, v56
    v_exp_f32 v57, v57
    v_exp_f32 v58, v58
    v_exp_f32 v59, v59
    v_exp_f32 v60, v60
    v_smfmac_f32_32x32x32_bf16 v[112:127], v[180:183], v[48:55], v2
    v_exp_f32 v61, v61
    v_exp_f32 v62, v62
    v_exp_f32 v63, v63
    v_exp_f32 v64, v64
    v_exp_f32 v65, v65
    v_smfmac_f32_32x32x32_bf16 v[112:127], v[184:187], v[56:63], v2
    v_exp_f32 v66, v66
    v_exp_f32 v67, v67
    v_exp_f32 v68, v68
    v_exp_f32 v69, v69
    v_mfma_f32_32x32x16_bf16 v[16:31], v[172:175], v[144:147], v[16:31]
    v_exp_f32 v70, v70
    v_exp_f32 v71, v71
    v_exp_f32 v72, v72
    v_exp_f32 v73, v73
    v_mfma_f32_32x32x16_bf16 v[32:47], v[172:175], v[148:151], v[32:47]
    v_exp_f32 v74, v74
    v_exp_f32 v75, v75
    v_exp_f32 v76, v76
    v_exp_f32 v77, v77
    v_smfmac_f32_32x32x32_bf16 v[128:143], v[180:183], v[64:71], v2
    v_exp_f32 v78, v78
    v_exp_f32 v79, v79
    v_exp_f32 v16, v16
    v_exp_f32 v17, v17
    v_smfmac_f32_32x32x32_bf16 v[128:143], v[184:187], v[72:79], v2
    v_exp_f32 v18, v18
    v_exp_f32 v19, v19
    ds_read_b128 v[168:171], v3 offset:9984
    v_exp_f32 v20, v20
    v_mfma_f32_32x32x4bf16_1k v[48:79], v[178:179], v[166:167], 0
    v_exp_f32 v21, v21
    v_exp_f32 v22, v22
    v_exp_f32 v23, v23
    v_exp_f32 v24, v24
    v_exp_f32 v25, v25
    v_exp_f32 v26, v26
    v_exp_f32 v27, v27
    v_exp_f32 v28, v28
    v_smfmac_f32_32x32x32_bf16 v[80:95], v[188:191], v[16:23], v2
    v_exp_f32 v29, v29
    v_exp_f32 v30, v30
    ds_read_b128 v[180:183], v5 offset:11008
    v_exp_f32 v31, v31
    v_exp_f32 v32, v32
    v_exp_f32 v33, v33
    v_smfmac_f32_32x32x32_bf16 v[80:95], v[192:195], v[24:31], v2
    v_exp_f32 v34, v34
    v_exp_f32 v35, v35
    ds_read_b128 v[184:187], v5 offset:11616
    v_exp_f32 v36, v36
    v_exp_f32 v37, v37
    v_mfma_f32_32x32x16_bf16 v[48:63], v[172:175], v[152:155], v[48:63]
    v_exp_f32 v38, v38
    v_exp_f32 v39, v39
    v_exp_f32 v40, v40
    v_exp_f32 v41, v41
    v_mfma_f32_32x32x16_bf16 v[64:79], v[172:175], v[156:159], v[64:79]
    v_exp_f32 v42, v42
    v_exp_f32 v43, v43
    v_exp_f32 v44, v44
    v_exp_f32 v45, v45
    v_smfmac_f32_32x32x32_bf16 v[96:111], v[188:191], v[32:39], v2
    v_exp_f32 v46, v46
    v_exp_f32 v47, v47
    v_exp_f32 v48, v48
    v_exp_f32 v49, v49
    v_smfmac_f32_32x32x32_bf16 v[96:111], v[192:195], v[40:47], v2
    v_exp_f32 v50, v50
    v_exp_f32 v51, v51
    v_exp_f32 v52, v52
    s_waitcnt lgkmcnt(0)
    v_mfma_f32_32x32x4bf16_1k v[16:47], v[176:177], v[160:161], 0
    v_exp_f32 v53, v53
    v_exp_f32 v54, v54
    v_exp_f32 v55, v55
    v_exp_f32 v56, v56
    v_exp_f32 v57, v57
    v_exp_f32 v58, v58
    v_exp_f32 v59, v59
    v_exp_f32 v60, v60
    v_smfmac_f32_32x32x32_bf16 v[112:127], v[188:191], v[48:55], v2
    v_exp_f32 v61, v61
    v_exp_f32 v62, v62
    v_exp_f32 v63, v63
    v_exp_f32 v64, v64
    v_exp_f32 v65, v65
    v_smfmac_f32_32x32x32_bf16 v[112:127], v[192:195], v[56:63], v2
    v_exp_f32 v66, v66
    v_exp_f32 v67, v67
    v_exp_f32 v68, v68
    v_exp_f32 v69, v69
    v_mfma_f32_32x32x16_bf16 v[16:31], v[168:171], v[144:147], v[16:31]
    v_exp_f32 v70, v70
    v_exp_f32 v71, v71
    v_exp_f32 v72, v72
    v_exp_f32 v73, v73
    v_mfma_f32_32x32x16_bf16 v[32:47], v[168:171], v[148:151], v[32:47]
    v_exp_f32 v74, v74
    v_exp_f32 v75, v75
    v_exp_f32 v76, v76
    v_exp_f32 v77, v77
    v_smfmac_f32_32x32x32_bf16 v[128:143], v[188:191], v[64:71], v2
    v_exp_f32 v78, v78
    v_exp_f32 v79, v79
    s_waitcnt vmcnt(0)
    s_barrier
    v_exp_f32 v16, v16
    v_exp_f32 v17, v17
    v_smfmac_f32_32x32x32_bf16 v[128:143], v[192:195], v[72:79], v2
    v_exp_f32 v18, v18
    v_exp_f32 v19, v19
    ds_read_b128 v[172:175], v3 offset:12224
    v_exp_f32 v20, v20
    v_mfma_f32_32x32x4bf16_1k v[48:79], v[176:177], v[164:165], 0
    v_exp_f32 v21, v21
    v_exp_f32 v22, v22
    v_exp_f32 v23, v23
    v_exp_f32 v24, v24
    v_exp_f32 v25, v25
    v_exp_f32 v26, v26
    v_exp_f32 v27, v27
    v_exp_f32 v28, v28
    v_smfmac_f32_32x32x32_bf16 v[80:95], v[180:183], v[16:23], v2
    s_add_u32 s36, s58, 75776
    s_add_u32 s3, s36, 65536
    s_mov_b32 m0, s3
    s_nop 0
    buffer_load_dwordx4 v15, s[16:19], s3 offen sc1 lds
    v_exp_f32 v29, v29
    v_exp_f32 v30, v30
    ds_read_b128 v[188:191], v5 offset:13248
    v_exp_f32 v31, v31
    v_exp_f32 v32, v32
    ds_read2st64_b32 v[178:179], v214 offset0:37 offset1:38
    v_exp_f32 v33, v33
    v_smfmac_f32_32x32x32_bf16 v[80:95], v[184:187], v[24:31], v2
    v_exp_f32 v34, v34
    v_exp_f32 v35, v35
    ds_read_b128 v[192:195], v5 offset:13856
    v_exp_f32 v36, v36
    v_exp_f32 v37, v37
    v_mfma_f32_32x32x16_bf16 v[48:63], v[168:171], v[152:155], v[48:63]
    s_add_u32 s3, s36, 69632
    s_mov_b32 m0, s3
    s_nop 0
    buffer_load_dwordx4 v15, s[16:19], s3 offen sc1 lds
    v_exp_f32 v38, v38
    v_exp_f32 v39, v39
    v_exp_f32 v40, v40
    v_exp_f32 v41, v41
    v_mfma_f32_32x32x16_bf16 v[64:79], v[168:171], v[156:159], v[64:79]
    v_exp_f32 v42, v42
    v_exp_f32 v43, v43
    v_exp_f32 v44, v44
    v_exp_f32 v45, v45
    v_smfmac_f32_32x32x32_bf16 v[96:111], v[180:183], v[32:39], v2
    v_exp_f32 v46, v46
    v_exp_f32 v47, v47
    v_exp_f32 v48, v48
    v_exp_f32 v49, v49
    v_smfmac_f32_32x32x32_bf16 v[96:111], v[184:187], v[40:47], v2
    v_exp_f32 v50, v50
    v_exp_f32 v51, v51
    v_exp_f32 v52, v52
    s_waitcnt lgkmcnt(0)
    v_mfma_f32_32x32x4bf16_1k v[16:47], v[176:177], v[162:163], 0
    v_exp_f32 v53, v53
    v_exp_f32 v54, v54
    v_exp_f32 v55, v55
    v_exp_f32 v56, v56
    v_exp_f32 v57, v57
    v_exp_f32 v58, v58
    v_exp_f32 v59, v59
    v_exp_f32 v60, v60
    v_smfmac_f32_32x32x32_bf16 v[112:127], v[180:183], v[48:55], v2
    s_add_u32 s3, s36, 73728
    s_mov_b32 m0, s3
    s_nop 0
    buffer_load_dwordx4 v15, s[16:19], s3 offen sc1 lds
    v_exp_f32 v61, v61
    v_exp_f32 v62, v62
    v_exp_f32 v63, v63
    v_exp_f32 v64, v64
    v_exp_f32 v65, v65
    v_smfmac_f32_32x32x32_bf16 v[112:127], v[184:187], v[56:63], v2
    v_exp_f32 v66, v66
    v_exp_f32 v67, v67
    v_exp_f32 v68, v68
    v_exp_f32 v69, v69
    v_mfma_f32_32x32x16_bf16 v[16:31], v[172:175], v[144:147], v[16:31]
    s_mov_b32 s8, s54
    s_mov_b32 s9, s55
    s_mov_b32 s10, 663552
    s_mov_b32 s11, 0x20000
    s_lshr_b32 s3, s2, 3
    s_mul_i32 s3, s3, 162
    s_mul_i32 s37, s35, 21
    s_add_u32 s3, s3, s37
    s_lshl_b32 s3, s3, 7
    v_lshlrev_b32 v14, 7, v1
    s_mov_b32 exec_lo, 0x1fffff
    s_mov_b32 exec_hi, 0
    buffer_load_dword v204, v14, s[8:11], s3 offen
    s_mov_b64 exec, -1
    v_exp_f32 v70, v70
    v_exp_f32 v71, v71
    v_exp_f32 v72, v72
    v_exp_f32 v73, v73
    v_mfma_f32_32x32x16_bf16 v[32:47], v[172:175], v[148:151], v[32:47]
    v_exp_f32 v74, v74
    v_exp_f32 v75, v75
    v_exp_f32 v76, v76
    v_exp_f32 v77, v77
    v_smfmac_f32_32x32x32_bf16 v[128:143], v[180:183], v[64:71], v2
    v_exp_f32 v78, v78
    v_exp_f32 v79, v79
    v_exp_f32 v16, v16
    v_exp_f32 v17, v17
    v_smfmac_f32_32x32x32_bf16 v[128:143], v[184:187], v[72:79], v2
    v_exp_f32 v18, v18
    v_exp_f32 v19, v19
    ds_read_b128 v[168:171], v3 offset:14464
    v_exp_f32 v20, v20
    v_mfma_f32_32x32x4bf16_1k v[48:79], v[176:177], v[166:167], 0
    v_exp_f32 v21, v21
    v_exp_f32 v22, v22
    v_exp_f32 v23, v23
    v_exp_f32 v24, v24
    v_exp_f32 v25, v25
    v_exp_f32 v26, v26
    v_exp_f32 v27, v27
    v_exp_f32 v28, v28
    v_smfmac_f32_32x32x32_bf16 v[80:95], v[188:191], v[16:23], v2
    v_exp_f32 v29, v29
    v_exp_f32 v30, v30
    ds_read_b128 v[180:183], v5 offset:15488
    v_exp_f32 v31, v31
    v_exp_f32 v32, v32
    v_exp_f32 v33, v33
    v_smfmac_f32_32x32x32_bf16 v[80:95], v[192:195], v[24:31], v2
    v_exp_f32 v34, v34
    v_exp_f32 v35, v35
    ds_read_b128 v[184:187], v5 offset:16096
    v_exp_f32 v36, v36
    v_exp_f32 v37, v37
    v_mfma_f32_32x32x16_bf16 v[48:63], v[172:175], v[152:155], v[48:63]
    v_exp_f32 v38, v38
    v_exp_f32 v39, v39
    v_exp_f32 v40, v40
    v_exp_f32 v41, v41
    v_mfma_f32_32x32x16_bf16 v[64:79], v[172:175], v[156:159], v[64:79]
    v_exp_f32 v42, v42
    v_exp_f32 v43, v43
    v_exp_f32 v44, v44
    v_exp_f32 v45, v45
    v_smfmac_f32_32x32x32_bf16 v[96:111], v[188:191], v[32:39], v2
    v_exp_f32 v46, v46
    v_exp_f32 v47, v47
    v_exp_f32 v48, v48
    v_exp_f32 v49, v49
    v_smfmac_f32_32x32x32_bf16 v[96:111], v[192:195], v[40:47], v2
    v_exp_f32 v50, v50
    v_exp_f32 v51, v51
    v_exp_f32 v52, v52
    s_waitcnt lgkmcnt(0)
    v_mfma_f32_32x32x4bf16_1k v[16:47], v[178:179], v[160:161], 0
    v_exp_f32 v53, v53
    v_exp_f32 v54, v54
    v_exp_f32 v55, v55
    v_exp_f32 v56, v56
    v_exp_f32 v57, v57
    v_exp_f32 v58, v58
    v_exp_f32 v59, v59
    v_exp_f32 v60, v60
    v_smfmac_f32_32x32x32_bf16 v[112:127], v[188:191], v[48:55], v2
    v_exp_f32 v61, v61
    v_exp_f32 v62, v62
    v_exp_f32 v63, v63
    v_exp_f32 v64, v64
    v_exp_f32 v65, v65
    v_smfmac_f32_32x32x32_bf16 v[112:127], v[192:195], v[56:63], v2
    v_exp_f32 v66, v66
    v_exp_f32 v67, v67
    v_exp_f32 v68, v68
    v_exp_f32 v69, v69
    v_mfma_f32_32x32x16_bf16 v[16:31], v[168:171], v[144:147], v[16:31]
    v_exp_f32 v70, v70
    v_exp_f32 v71, v71
    v_exp_f32 v72, v72
    v_exp_f32 v73, v73
    v_mfma_f32_32x32x16_bf16 v[32:47], v[168:171], v[148:151], v[32:47]
    v_exp_f32 v74, v74
    v_exp_f32 v75, v75
    v_exp_f32 v76, v76
    v_exp_f32 v77, v77
    v_smfmac_f32_32x32x32_bf16 v[128:143], v[188:191], v[64:71], v2
    v_exp_f32 v78, v78
    v_exp_f32 v79, v79
    v_exp_f32 v16, v16
    v_exp_f32 v17, v17
    v_smfmac_f32_32x32x32_bf16 v[128:143], v[192:195], v[72:79], v2
    v_exp_f32 v18, v18
    v_exp_f32 v19, v19
    ds_read_b128 v[172:175], v3 offset:16704
    v_exp_f32 v20, v20
    v_mfma_f32_32x32x4bf16_1k v[48:79], v[178:179], v[164:165], 0
    v_exp_f32 v21, v21
    v_exp_f32 v22, v22
    v_exp_f32 v23, v23
    v_exp_f32 v24, v24
    v_exp_f32 v25, v25
    v_exp_f32 v26, v26
    v_exp_f32 v27, v27
    v_exp_f32 v28, v28
    v_smfmac_f32_32x32x32_bf16 v[80:95], v[180:183], v[16:23], v2
    v_exp_f32 v29, v29
    v_exp_f32 v30, v30
    ds_read_b128 v[188:191], v5 offset:17728
    v_exp_f32 v31, v31
    v_exp_f32 v32, v32
    ds_read2st64_b32 v[176:177], v4 offset0:74 offset1:75
    v_exp_f32 v33, v33
    v_smfmac_f32_32x32x32_bf16 v[80:95], v[184:187], v[24:31], v2
    v_exp_f32 v34, v34
    v_exp_f32 v35, v35
    ds_read_b128 v[192:195], v5 offset:18336
    v_exp_f32 v36, v36
    v_exp_f32 v37, v37
    v_mfma_f32_32x32x16_bf16 v[48:63], v[168:171], v[152:155], v[48:63]
    v_exp_f32 v38, v38
    v_exp_f32 v39, v39
    v_exp_f32 v40, v40
    v_exp_f32 v41, v41
    v_mfma_f32_32x32x16_bf16 v[64:79], v[168:171], v[156:159], v[64:79]
    v_exp_f32 v42, v42
    v_exp_f32 v43, v43
    v_exp_f32 v44, v44
    v_exp_f32 v45, v45
    v_smfmac_f32_32x32x32_bf16 v[96:111], v[180:183], v[32:39], v2
    v_exp_f32 v46, v46
    v_exp_f32 v47, v47
    v_exp_f32 v48, v48
    v_exp_f32 v49, v49
    v_smfmac_f32_32x32x32_bf16 v[96:111], v[184:187], v[40:47], v2
    v_exp_f32 v50, v50
    v_exp_f32 v51, v51
    v_exp_f32 v52, v52
    s_waitcnt lgkmcnt(0)
    v_mfma_f32_32x32x4bf16_1k v[16:47], v[178:179], v[162:163], 0
    v_exp_f32 v53, v53
    v_exp_f32 v54, v54
    v_exp_f32 v55, v55
    v_exp_f32 v56, v56
    v_exp_f32 v57, v57
    v_exp_f32 v58, v58
    v_exp_f32 v59, v59
    v_exp_f32 v60, v60
    v_smfmac_f32_32x32x32_bf16 v[112:127], v[180:183], v[48:55], v2
    v_exp_f32 v61, v61
    v_exp_f32 v62, v62
    v_exp_f32 v63, v63
    v_exp_f32 v64, v64
    v_exp_f32 v65, v65
    v_smfmac_f32_32x32x32_bf16 v[112:127], v[184:187], v[56:63], v2
    v_exp_f32 v66, v66
    v_exp_f32 v67, v67
    v_exp_f32 v68, v68
    v_exp_f32 v69, v69
    v_mfma_f32_32x32x16_bf16 v[16:31], v[172:175], v[144:147], v[16:31]
    v_exp_f32 v70, v70
    v_exp_f32 v71, v71
    v_exp_f32 v72, v72
    v_exp_f32 v73, v73
    v_mfma_f32_32x32x16_bf16 v[32:47], v[172:175], v[148:151], v[32:47]
    v_exp_f32 v74, v74
    v_exp_f32 v75, v75
    v_exp_f32 v76, v76
    v_exp_f32 v77, v77
    v_smfmac_f32_32x32x32_bf16 v[128:143], v[180:183], v[64:71], v2
    v_exp_f32 v78, v78
    v_exp_f32 v79, v79
    v_exp_f32 v16, v16
    v_exp_f32 v17, v17
    v_smfmac_f32_32x32x32_bf16 v[128:143], v[184:187], v[72:79], v2
    v_exp_f32 v18, v18
    v_exp_f32 v19, v19
    ds_read_b128 v[168:171], v3 offset:19456
    v_exp_f32 v20, v20
    v_mfma_f32_32x32x4bf16_1k v[48:79], v[178:179], v[166:167], 0
    v_exp_f32 v21, v21
    v_exp_f32 v22, v22
    v_exp_f32 v23, v23
    v_exp_f32 v24, v24
    v_exp_f32 v25, v25
    v_exp_f32 v26, v26
    v_exp_f32 v27, v27
    v_exp_f32 v28, v28
    v_smfmac_f32_32x32x32_bf16 v[80:95], v[188:191], v[16:23], v2
    v_exp_f32 v29, v29
    v_exp_f32 v30, v30
    ds_read_b128 v[180:183], v5 offset:20480
    v_exp_f32 v31, v31
    v_exp_f32 v32, v32
    v_exp_f32 v33, v33
    v_smfmac_f32_32x32x32_bf16 v[80:95], v[192:195], v[24:31], v2
    v_exp_f32 v34, v34
    v_exp_f32 v35, v35
    ds_read_b128 v[184:187], v5 offset:21088
    v_exp_f32 v36, v36
    v_exp_f32 v37, v37
    v_mfma_f32_32x32x16_bf16 v[48:63], v[172:175], v[152:155], v[48:63]
    v_exp_f32 v38, v38
    v_exp_f32 v39, v39
    v_exp_f32 v40, v40
    v_exp_f32 v41, v41
    v_mfma_f32_32x32x16_bf16 v[64:79], v[172:175], v[156:159], v[64:79]
    v_exp_f32 v42, v42
    v_exp_f32 v43, v43
    v_exp_f32 v44, v44
    v_exp_f32 v45, v45
    v_smfmac_f32_32x32x32_bf16 v[96:111], v[188:191], v[32:39], v2
    v_exp_f32 v46, v46
    v_exp_f32 v47, v47
    v_exp_f32 v48, v48
    v_exp_f32 v49, v49
    v_smfmac_f32_32x32x32_bf16 v[96:111], v[192:195], v[40:47], v2
    v_exp_f32 v50, v50
    v_exp_f32 v51, v51
    v_exp_f32 v52, v52
    s_waitcnt lgkmcnt(0)
    v_mfma_f32_32x32x4bf16_1k v[16:47], v[176:177], v[160:161], 0
    v_exp_f32 v53, v53
    v_exp_f32 v54, v54
    v_exp_f32 v55, v55
    v_exp_f32 v56, v56
    v_exp_f32 v57, v57
    v_exp_f32 v58, v58
    v_exp_f32 v59, v59
    v_exp_f32 v60, v60
    v_smfmac_f32_32x32x32_bf16 v[112:127], v[188:191], v[48:55], v2
    v_exp_f32 v61, v61
    v_exp_f32 v62, v62
    v_exp_f32 v63, v63
    v_exp_f32 v64, v64
    v_exp_f32 v65, v65
    v_smfmac_f32_32x32x32_bf16 v[112:127], v[192:195], v[56:63], v2
    v_exp_f32 v66, v66
    v_exp_f32 v67, v67
    v_exp_f32 v68, v68
    v_exp_f32 v69, v69
    v_mfma_f32_32x32x16_bf16 v[16:31], v[168:171], v[144:147], v[16:31]
    v_exp_f32 v70, v70
    v_exp_f32 v71, v71
    v_exp_f32 v72, v72
    v_exp_f32 v73, v73
    v_mfma_f32_32x32x16_bf16 v[32:47], v[168:171], v[148:151], v[32:47]
    v_exp_f32 v74, v74
    v_exp_f32 v75, v75
    v_exp_f32 v76, v76
    v_exp_f32 v77, v77
    v_smfmac_f32_32x32x32_bf16 v[128:143], v[188:191], v[64:71], v2
    v_exp_f32 v78, v78
    v_exp_f32 v79, v79
    v_exp_f32 v16, v16
    v_exp_f32 v17, v17
    v_smfmac_f32_32x32x32_bf16 v[128:143], v[192:195], v[72:79], v2
    v_exp_f32 v18, v18
    v_exp_f32 v19, v19
    ds_read_b128 v[172:175], v3 offset:21696
    v_exp_f32 v20, v20
    v_mfma_f32_32x32x4bf16_1k v[48:79], v[176:177], v[164:165], 0
    v_exp_f32 v21, v21
    v_exp_f32 v22, v22
    v_exp_f32 v23, v23
    v_exp_f32 v24, v24
    v_exp_f32 v25, v25
    v_exp_f32 v26, v26
    v_exp_f32 v27, v27
    v_exp_f32 v28, v28
    v_smfmac_f32_32x32x32_bf16 v[80:95], v[180:183], v[16:23], v2
    v_exp_f32 v29, v29
    v_exp_f32 v30, v30
    ds_read_b128 v[188:191], v5 offset:22720
    v_exp_f32 v31, v31
    v_exp_f32 v32, v32
    ds_read2st64_b32 v[178:179], v214 offset0:74 offset1:75
    v_exp_f32 v33, v33
    v_smfmac_f32_32x32x32_bf16 v[80:95], v[184:187], v[24:31], v2
    v_exp_f32 v34, v34
    v_exp_f32 v35, v35
    ds_read_b128 v[192:195], v5 offset:23328
    v_exp_f32 v36, v36
    v_exp_f32 v37, v37
    v_mfma_f32_32x32x16_bf16 v[48:63], v[168:171], v[152:155], v[48:63]
    v_exp_f32 v38, v38
    v_exp_f32 v39, v39
    v_exp_f32 v40, v40
    v_exp_f32 v41, v41
    v_mfma_f32_32x32x16_bf16 v[64:79], v[168:171], v[156:159], v[64:79]
    v_exp_f32 v42, v42
    v_exp_f32 v43, v43
    v_exp_f32 v44, v44
    v_exp_f32 v45, v45
    v_smfmac_f32_32x32x32_bf16 v[96:111], v[180:183], v[32:39], v2
    v_exp_f32 v46, v46
    v_exp_f32 v47, v47
    v_exp_f32 v48, v48
    v_exp_f32 v49, v49
    v_smfmac_f32_32x32x32_bf16 v[96:111], v[184:187], v[40:47], v2
    v_exp_f32 v50, v50
    v_exp_f32 v51, v51
    v_exp_f32 v52, v52
    s_waitcnt lgkmcnt(0)
    v_mfma_f32_32x32x4bf16_1k v[16:47], v[176:177], v[162:163], 0
    v_exp_f32 v53, v53
    v_exp_f32 v54, v54
    v_exp_f32 v55, v55
    v_exp_f32 v56, v56
    v_exp_f32 v57, v57
    v_exp_f32 v58, v58
    v_exp_f32 v59, v59
    v_exp_f32 v60, v60
    v_smfmac_f32_32x32x32_bf16 v[112:127], v[180:183], v[48:55], v2
    v_exp_f32 v61, v61
    v_exp_f32 v62, v62
    v_exp_f32 v63, v63
    v_exp_f32 v64, v64
    v_exp_f32 v65, v65
    v_smfmac_f32_32x32x32_bf16 v[112:127], v[184:187], v[56:63], v2
    v_exp_f32 v66, v66
    v_exp_f32 v67, v67
    v_exp_f32 v68, v68
    v_exp_f32 v69, v69
    v_mfma_f32_32x32x16_bf16 v[16:31], v[172:175], v[144:147], v[16:31]
    v_exp_f32 v70, v70
    v_exp_f32 v71, v71
    v_exp_f32 v72, v72
    v_exp_f32 v73, v73
    v_mfma_f32_32x32x16_bf16 v[32:47], v[172:175], v[148:151], v[32:47]
    v_exp_f32 v74, v74
    v_exp_f32 v75, v75
    v_exp_f32 v76, v76
    v_exp_f32 v77, v77
    v_smfmac_f32_32x32x32_bf16 v[128:143], v[180:183], v[64:71], v2
    v_exp_f32 v78, v78
    v_exp_f32 v79, v79
    v_exp_f32 v16, v16
    v_exp_f32 v17, v17
    v_smfmac_f32_32x32x32_bf16 v[128:143], v[184:187], v[72:79], v2
    v_exp_f32 v18, v18
    v_exp_f32 v19, v19
    ds_read_b128 v[168:171], v3 offset:23936
    v_exp_f32 v20, v20
    v_mfma_f32_32x32x4bf16_1k v[48:79], v[176:177], v[166:167], 0
    v_exp_f32 v21, v21
    v_exp_f32 v22, v22
    v_exp_f32 v23, v23
    v_exp_f32 v24, v24
    v_exp_f32 v25, v25
    v_exp_f32 v26, v26
    v_exp_f32 v27, v27
    v_exp_f32 v28, v28
    v_smfmac_f32_32x32x32_bf16 v[80:95], v[188:191], v[16:23], v2
    v_exp_f32 v29, v29
    v_exp_f32 v30, v30
    ds_read_b128 v[180:183], v5 offset:24960
    v_exp_f32 v31, v31
    v_exp_f32 v32, v32
    v_exp_f32 v33, v33
    v_smfmac_f32_32x32x32_bf16 v[80:95], v[192:195], v[24:31], v2
    v_exp_f32 v34, v34
    v_exp_f32 v35, v35
    ds_read_b128 v[184:187], v5 offset:25568
    v_exp_f32 v36, v36
    v_exp_f32 v37, v37
    v_mfma_f32_32x32x16_bf16 v[48:63], v[172:175], v[152:155], v[48:63]
    v_exp_f32 v38, v38
    v_exp_f32 v39, v39
    v_exp_f32 v40, v40
    v_exp_f32 v41, v41
    v_mfma_f32_32x32x16_bf16 v[64:79], v[172:175], v[156:159], v[64:79]
    v_exp_f32 v42, v42
    v_exp_f32 v43, v43
    v_exp_f32 v44, v44
    v_exp_f32 v45, v45
    v_smfmac_f32_32x32x32_bf16 v[96:111], v[188:191], v[32:39], v2
    v_exp_f32 v46, v46
    v_exp_f32 v47, v47
    v_exp_f32 v48, v48
    v_exp_f32 v49, v49
    v_smfmac_f32_32x32x32_bf16 v[96:111], v[192:195], v[40:47], v2
    v_exp_f32 v50, v50
    v_exp_f32 v51, v51
    v_exp_f32 v52, v52
    s_waitcnt lgkmcnt(0)
    v_mfma_f32_32x32x4bf16_1k v[16:47], v[178:179], v[160:161], 0
    v_exp_f32 v53, v53
    v_exp_f32 v54, v54
    v_exp_f32 v55, v55
    v_exp_f32 v56, v56
    v_exp_f32 v57, v57
    v_exp_f32 v58, v58
    v_exp_f32 v59, v59
    v_exp_f32 v60, v60
    v_smfmac_f32_32x32x32_bf16 v[112:127], v[188:191], v[48:55], v2
    v_exp_f32 v61, v61
    v_exp_f32 v62, v62
    v_exp_f32 v63, v63
    v_exp_f32 v64, v64
    v_exp_f32 v65, v65
    v_smfmac_f32_32x32x32_bf16 v[112:127], v[192:195], v[56:63], v2
    v_exp_f32 v66, v66
    v_exp_f32 v67, v67
    v_exp_f32 v68, v68
    v_exp_f32 v69, v69
    v_mfma_f32_32x32x16_bf16 v[16:31], v[168:171], v[144:147], v[16:31]
    v_exp_f32 v70, v70
    v_exp_f32 v71, v71
    v_exp_f32 v72, v72
    v_exp_f32 v73, v73
    v_mfma_f32_32x32x16_bf16 v[32:47], v[168:171], v[148:151], v[32:47]
    v_exp_f32 v74, v74
    v_exp_f32 v75, v75
    v_exp_f32 v76, v76
    v_exp_f32 v77, v77
    v_smfmac_f32_32x32x32_bf16 v[128:143], v[188:191], v[64:71], v2
    v_exp_f32 v78, v78
    v_exp_f32 v79, v79
    v_exp_f32 v16, v16
    v_exp_f32 v17, v17
    v_smfmac_f32_32x32x32_bf16 v[128:143], v[192:195], v[72:79], v2
    v_exp_f32 v18, v18
    v_exp_f32 v19, v19
    ds_read_b128 v[172:175], v3 offset:26176
    v_exp_f32 v20, v20
    v_mfma_f32_32x32x4bf16_1k v[48:79], v[178:179], v[164:165], 0
    v_exp_f32 v21, v21
    v_exp_f32 v22, v22
    v_exp_f32 v23, v23
    v_exp_f32 v24, v24
    v_exp_f32 v25, v25
    v_exp_f32 v26, v26
    v_exp_f32 v27, v27
    v_exp_f32 v28, v28
    v_smfmac_f32_32x32x32_bf16 v[80:95], v[180:183], v[16:23], v2
    v_exp_f32 v29, v29
    v_exp_f32 v30, v30
    ds_read_b128 v[188:191], v5 offset:27200
    v_exp_f32 v31, v31
    v_exp_f32 v32, v32
    ds_read2st64_b32 v[176:177], v4 offset0:111 offset1:112
    v_exp_f32 v33, v33
    v_smfmac_f32_32x32x32_bf16 v[80:95], v[184:187], v[24:31], v2
    v_exp_f32 v34, v34
    v_exp_f32 v35, v35
    ds_read_b128 v[192:195], v5 offset:27808
    v_exp_f32 v36, v36
    v_exp_f32 v37, v37
    v_mfma_f32_32x32x16_bf16 v[48:63], v[168:171], v[152:155], v[48:63]
    v_exp_f32 v38, v38
    v_exp_f32 v39, v39
    v_exp_f32 v40, v40
    v_exp_f32 v41, v41
    v_mfma_f32_32x32x16_bf16 v[64:79], v[168:171], v[156:159], v[64:79]
    v_exp_f32 v42, v42
    v_exp_f32 v43, v43
    v_exp_f32 v44, v44
    v_exp_f32 v45, v45
    v_smfmac_f32_32x32x32_bf16 v[96:111], v[180:183], v[32:39], v2
    v_exp_f32 v46, v46
    v_exp_f32 v47, v47
    v_exp_f32 v48, v48
    v_exp_f32 v49, v49
    v_smfmac_f32_32x32x32_bf16 v[96:111], v[184:187], v[40:47], v2
    v_exp_f32 v50, v50
    v_exp_f32 v51, v51
    v_exp_f32 v52, v52
    s_waitcnt lgkmcnt(0)
    v_mfma_f32_32x32x4bf16_1k v[16:47], v[178:179], v[162:163], 0
    v_exp_f32 v53, v53
    v_exp_f32 v54, v54
    v_exp_f32 v55, v55
    v_exp_f32 v56, v56
    v_exp_f32 v57, v57
    v_exp_f32 v58, v58
    v_exp_f32 v59, v59
    v_exp_f32 v60, v60
    v_smfmac_f32_32x32x32_bf16 v[112:127], v[180:183], v[48:55], v2
    v_exp_f32 v61, v61
    v_exp_f32 v62, v62
    v_exp_f32 v63, v63
    v_exp_f32 v64, v64
    v_exp_f32 v65, v65
    v_smfmac_f32_32x32x32_bf16 v[112:127], v[184:187], v[56:63], v2
    v_exp_f32 v66, v66
    v_exp_f32 v67, v67
    v_exp_f32 v68, v68
    v_exp_f32 v69, v69
    v_mfma_f32_32x32x16_bf16 v[16:31], v[172:175], v[144:147], v[16:31]
    v_exp_f32 v70, v70
    v_exp_f32 v71, v71
    v_exp_f32 v72, v72
    v_exp_f32 v73, v73
    v_mfma_f32_32x32x16_bf16 v[32:47], v[172:175], v[148:151], v[32:47]
    v_exp_f32 v74, v74
    v_exp_f32 v75, v75
    v_exp_f32 v76, v76
    v_exp_f32 v77, v77
    v_smfmac_f32_32x32x32_bf16 v[128:143], v[180:183], v[64:71], v2
    v_exp_f32 v78, v78
    v_exp_f32 v79, v79
    v_exp_f32 v16, v16
    v_exp_f32 v17, v17
    v_smfmac_f32_32x32x32_bf16 v[128:143], v[184:187], v[72:79], v2
    v_exp_f32 v18, v18
    v_exp_f32 v19, v19
    ds_read_b128 v[168:171], v3 offset:28928
    v_exp_f32 v20, v20
    v_mfma_f32_32x32x4bf16_1k v[48:79], v[178:179], v[166:167], 0
    v_exp_f32 v21, v21
    v_exp_f32 v22, v22
    v_exp_f32 v23, v23
    v_exp_f32 v24, v24
    v_exp_f32 v25, v25
    v_exp_f32 v26, v26
    v_exp_f32 v27, v27
    v_exp_f32 v28, v28
    v_smfmac_f32_32x32x32_bf16 v[80:95], v[188:191], v[16:23], v2
    v_exp_f32 v29, v29
    v_exp_f32 v30, v30
    ds_read_b128 v[180:183], v5 offset:29952
    v_exp_f32 v31, v31
    v_exp_f32 v32, v32
    v_exp_f32 v33, v33
    v_smfmac_f32_32x32x32_bf16 v[80:95], v[192:195], v[24:31], v2
    v_exp_f32 v34, v34
    v_exp_f32 v35, v35
    ds_read_b128 v[184:187], v5 offset:30560
    v_exp_f32 v36, v36
    v_exp_f32 v37, v37
    v_mfma_f32_32x32x16_bf16 v[48:63], v[172:175], v[152:155], v[48:63]
    v_exp_f32 v38, v38
    v_exp_f32 v39, v39
    v_exp_f32 v40, v40
    v_exp_f32 v41, v41
    v_mfma_f32_32x32x16_bf16 v[64:79], v[172:175], v[156:159], v[64:79]
    v_exp_f32 v42, v42
    v_exp_f32 v43, v43
    v_exp_f32 v44, v44
    v_exp_f32 v45, v45
    v_smfmac_f32_32x32x32_bf16 v[96:111], v[188:191], v[32:39], v2
    v_exp_f32 v46, v46
    v_exp_f32 v47, v47
    v_exp_f32 v48, v48
    v_exp_f32 v49, v49
    v_smfmac_f32_32x32x32_bf16 v[96:111], v[192:195], v[40:47], v2
    v_exp_f32 v50, v50
    v_exp_f32 v51, v51
    v_exp_f32 v52, v52
    s_waitcnt lgkmcnt(0)
    v_mfma_f32_32x32x4bf16_1k v[16:47], v[176:177], v[160:161], 0
    v_exp_f32 v53, v53
    v_exp_f32 v54, v54
    v_exp_f32 v55, v55
    v_exp_f32 v56, v56
    v_exp_f32 v57, v57
    v_exp_f32 v58, v58
    v_exp_f32 v59, v59
    v_exp_f32 v60, v60
    v_smfmac_f32_32x32x32_bf16 v[112:127], v[188:191], v[48:55], v2
    v_exp_f32 v61, v61
    v_exp_f32 v62, v62
    v_exp_f32 v63, v63
    v_exp_f32 v64, v64
    v_exp_f32 v65, v65
    v_smfmac_f32_32x32x32_bf16 v[112:127], v[192:195], v[56:63], v2
    v_exp_f32 v66, v66
    v_exp_f32 v67, v67
    v_exp_f32 v68, v68
    v_exp_f32 v69, v69
    v_mfma_f32_32x32x16_bf16 v[16:31], v[168:171], v[144:147], v[16:31]
    v_exp_f32 v70, v70
    v_exp_f32 v71, v71
    v_exp_f32 v72, v72
    v_exp_f32 v73, v73
    v_mfma_f32_32x32x16_bf16 v[32:47], v[168:171], v[148:151], v[32:47]
    v_exp_f32 v74, v74
    v_exp_f32 v75, v75
    v_exp_f32 v76, v76
    v_exp_f32 v77, v77
    v_smfmac_f32_32x32x32_bf16 v[128:143], v[188:191], v[64:71], v2
    v_exp_f32 v78, v78
    v_exp_f32 v79, v79
    v_exp_f32 v16, v16
    v_exp_f32 v17, v17
    v_smfmac_f32_32x32x32_bf16 v[128:143], v[192:195], v[72:79], v2
    v_exp_f32 v18, v18
    v_exp_f32 v19, v19
    ds_read_b128 v[172:175], v3 offset:31168
    v_exp_f32 v20, v20
    v_mfma_f32_32x32x4bf16_1k v[48:79], v[176:177], v[164:165], 0
    v_exp_f32 v21, v21
    v_exp_f32 v22, v22
    v_exp_f32 v23, v23
    v_exp_f32 v24, v24
    v_exp_f32 v25, v25
    v_exp_f32 v26, v26
    v_exp_f32 v27, v27
    v_exp_f32 v28, v28
    v_smfmac_f32_32x32x32_bf16 v[80:95], v[180:183], v[16:23], v2
    v_exp_f32 v29, v29
    v_exp_f32 v30, v30
    ds_read_b128 v[188:191], v5 offset:32192
    v_exp_f32 v31, v31
    v_exp_f32 v32, v32
    ds_read2st64_b32 v[178:179], v214 offset0:111 offset1:112
    v_exp_f32 v33, v33
    v_smfmac_f32_32x32x32_bf16 v[80:95], v[184:187], v[24:31], v2
    v_exp_f32 v34, v34
    v_exp_f32 v35, v35
    ds_read_b128 v[192:195], v5 offset:32800
    v_exp_f32 v36, v36
    v_exp_f32 v37, v37
    v_mfma_f32_32x32x16_bf16 v[48:63], v[168:171], v[152:155], v[48:63]
    v_exp_f32 v38, v38
    v_exp_f32 v39, v39
    v_exp_f32 v40, v40
    v_exp_f32 v41, v41
    v_mfma_f32_32x32x16_bf16 v[64:79], v[168:171], v[156:159], v[64:79]
    v_exp_f32 v42, v42
    v_exp_f32 v43, v43
    v_exp_f32 v44, v44
    v_exp_f32 v45, v45
    v_smfmac_f32_32x32x32_bf16 v[96:111], v[180:183], v[32:39], v2
    v_exp_f32 v46, v46
    v_exp_f32 v47, v47
    v_exp_f32 v48, v48
    v_exp_f32 v49, v49
    v_smfmac_f32_32x32x32_bf16 v[96:111], v[184:187], v[40:47], v2
    v_exp_f32 v50, v50
    v_exp_f32 v51, v51
    v_exp_f32 v52, v52
    s_waitcnt lgkmcnt(0)
    v_mfma_f32_32x32x4bf16_1k v[16:47], v[176:177], v[162:163], 0
    v_exp_f32 v53, v53
    v_exp_f32 v54, v54
    v_exp_f32 v55, v55
    v_exp_f32 v56, v56
    v_exp_f32 v57, v57
    v_exp_f32 v58, v58
    v_exp_f32 v59, v59
    v_exp_f32 v60, v60
    v_smfmac_f32_32x32x32_bf16 v[112:127], v[180:183], v[48:55], v2
    v_exp_f32 v61, v61
    v_exp_f32 v62, v62
    v_exp_f32 v63, v63
    v_exp_f32 v64, v64
    v_exp_f32 v65, v65
    v_smfmac_f32_32x32x32_bf16 v[112:127], v[184:187], v[56:63], v2
    v_exp_f32 v66, v66
    v_exp_f32 v67, v67
    v_exp_f32 v68, v68
    v_exp_f32 v69, v69
    v_mfma_f32_32x32x16_bf16 v[16:31], v[172:175], v[144:147], v[16:31]
    v_exp_f32 v70, v70
    v_exp_f32 v71, v71
    v_exp_f32 v72, v72
    v_exp_f32 v73, v73
    v_mfma_f32_32x32x16_bf16 v[32:47], v[172:175], v[148:151], v[32:47]
    v_exp_f32 v74, v74
    v_exp_f32 v75, v75
    v_exp_f32 v76, v76
    v_exp_f32 v77, v77
    v_smfmac_f32_32x32x32_bf16 v[128:143], v[180:183], v[64:71], v2
    v_exp_f32 v78, v78
    v_exp_f32 v79, v79
    v_exp_f32 v16, v16
    v_exp_f32 v17, v17
    v_smfmac_f32_32x32x32_bf16 v[128:143], v[184:187], v[72:79], v2
    v_exp_f32 v18, v18
    v_exp_f32 v19, v19
    ds_read_b128 v[168:171], v3 offset:33408
    v_exp_f32 v20, v20
    v_mfma_f32_32x32x4bf16_1k v[48:79], v[176:177], v[166:167], 0
    v_exp_f32 v21, v21
    v_exp_f32 v22, v22
    v_exp_f32 v23, v23
    v_exp_f32 v24, v24
    v_exp_f32 v25, v25
    v_exp_f32 v26, v26
    v_exp_f32 v27, v27
    v_exp_f32 v28, v28
    v_smfmac_f32_32x32x32_bf16 v[80:95], v[188:191], v[16:23], v2
    v_exp_f32 v29, v29
    v_exp_f32 v30, v30
    ds_read_b128 v[180:183], v5 offset:34432
    v_exp_f32 v31, v31
    v_exp_f32 v32, v32
    v_exp_f32 v33, v33
    v_smfmac_f32_32x32x32_bf16 v[80:95], v[192:195], v[24:31], v2
    v_exp_f32 v34, v34
    v_exp_f32 v35, v35
    ds_read_b128 v[184:187], v5 offset:35040
    v_exp_f32 v36, v36
    v_exp_f32 v37, v37
    v_mfma_f32_32x32x16_bf16 v[48:63], v[172:175], v[152:155], v[48:63]
    v_exp_f32 v38, v38
    v_exp_f32 v39, v39
    v_exp_f32 v40, v40
    v_exp_f32 v41, v41
    v_mfma_f32_32x32x16_bf16 v[64:79], v[172:175], v[156:159], v[64:79]
    v_exp_f32 v42, v42
    v_exp_f32 v43, v43
    v_exp_f32 v44, v44
    v_exp_f32 v45, v45
    v_smfmac_f32_32x32x32_bf16 v[96:111], v[188:191], v[32:39], v2
    v_exp_f32 v46, v46
    v_exp_f32 v47, v47
    v_exp_f32 v48, v48
    v_exp_f32 v49, v49
    v_smfmac_f32_32x32x32_bf16 v[96:111], v[192:195], v[40:47], v2
    v_exp_f32 v50, v50
    v_exp_f32 v51, v51
    v_exp_f32 v52, v52
    s_waitcnt lgkmcnt(0)
    v_mfma_f32_32x32x4bf16_1k v[16:47], v[178:179], v[160:161], 0
    v_exp_f32 v53, v53
    v_exp_f32 v54, v54
    v_exp_f32 v55, v55
    v_exp_f32 v56, v56
    v_exp_f32 v57, v57
    v_exp_f32 v58, v58
    v_exp_f32 v59, v59
    v_exp_f32 v60, v60
    v_smfmac_f32_32x32x32_bf16 v[112:127], v[188:191], v[48:55], v2
    v_exp_f32 v61, v61
    v_exp_f32 v62, v62
    v_exp_f32 v63, v63
    v_exp_f32 v64, v64
    v_exp_f32 v65, v65
    v_smfmac_f32_32x32x32_bf16 v[112:127], v[192:195], v[56:63], v2
    v_exp_f32 v66, v66
    v_exp_f32 v67, v67
    v_exp_f32 v68, v68
    v_exp_f32 v69, v69
    v_mfma_f32_32x32x16_bf16 v[16:31], v[168:171], v[144:147], v[16:31]
    v_exp_f32 v70, v70
    v_exp_f32 v71, v71
    v_exp_f32 v72, v72
    v_exp_f32 v73, v73
    v_mfma_f32_32x32x16_bf16 v[32:47], v[168:171], v[148:151], v[32:47]
    v_exp_f32 v74, v74
    v_exp_f32 v75, v75
    v_exp_f32 v76, v76
    v_exp_f32 v77, v77
    v_smfmac_f32_32x32x32_bf16 v[128:143], v[188:191], v[64:71], v2
    v_exp_f32 v78, v78
    v_exp_f32 v79, v79
    v_exp_f32 v16, v16
    v_exp_f32 v17, v17
    v_smfmac_f32_32x32x32_bf16 v[128:143], v[192:195], v[72:79], v2
    v_exp_f32 v18, v18
    v_exp_f32 v19, v19
    ds_read_b128 v[172:175], v3 offset:35648
    v_exp_f32 v20, v20
    v_mfma_f32_32x32x4bf16_1k v[48:79], v[178:179], v[164:165], 0
    v_exp_f32 v21, v21
    v_exp_f32 v22, v22
    v_exp_f32 v23, v23
    v_exp_f32 v24, v24
    v_exp_f32 v25, v25
    v_exp_f32 v26, v26
    v_exp_f32 v27, v27
    v_exp_f32 v28, v28
    v_smfmac_f32_32x32x32_bf16 v[80:95], v[180:183], v[16:23], v2
    v_exp_f32 v29, v29
    v_exp_f32 v30, v30
    ds_read_b128 v[188:191], v5 offset:36672
    v_exp_f32 v31, v31
    v_exp_f32 v32, v32
    ds_read2st64_b32 v[176:177], v215 offset0:0 offset1:1
    v_exp_f32 v33, v33
    v_smfmac_f32_32x32x32_bf16 v[80:95], v[184:187], v[24:31], v2
    v_exp_f32 v34, v34
    v_exp_f32 v35, v35
    ds_read_b128 v[192:195], v5 offset:37280
    v_exp_f32 v36, v36
    v_exp_f32 v37, v37
    v_mfma_f32_32x32x16_bf16 v[48:63], v[168:171], v[152:155], v[48:63]
    v_exp_f32 v38, v38
    v_exp_f32 v39, v39
    v_exp_f32 v40, v40
    v_exp_f32 v41, v41
    v_mfma_f32_32x32x16_bf16 v[64:79], v[168:171], v[156:159], v[64:79]
    v_exp_f32 v42, v42
    v_exp_f32 v43, v43
    v_exp_f32 v44, v44
    v_exp_f32 v45, v45
    v_smfmac_f32_32x32x32_bf16 v[96:111], v[180:183], v[32:39], v2
    v_exp_f32 v46, v46
    v_exp_f32 v47, v47
    v_exp_f32 v48, v48
    v_exp_f32 v49, v49
    v_smfmac_f32_32x32x32_bf16 v[96:111], v[184:187], v[40:47], v2
    v_exp_f32 v50, v50
    v_exp_f32 v51, v51
    v_exp_f32 v52, v52
    s_waitcnt lgkmcnt(0)
    v_mfma_f32_32x32x4bf16_1k v[16:47], v[178:179], v[162:163], 0
    v_exp_f32 v53, v53
    v_exp_f32 v54, v54
    v_exp_f32 v55, v55
    v_exp_f32 v56, v56
    v_exp_f32 v57, v57
    v_exp_f32 v58, v58
    v_exp_f32 v59, v59
    v_exp_f32 v60, v60
    v_smfmac_f32_32x32x32_bf16 v[112:127], v[180:183], v[48:55], v2
    v_exp_f32 v61, v61
    v_exp_f32 v62, v62
    v_exp_f32 v63, v63
    v_exp_f32 v64, v64
    v_exp_f32 v65, v65
    v_smfmac_f32_32x32x32_bf16 v[112:127], v[184:187], v[56:63], v2
    v_exp_f32 v66, v66
    v_exp_f32 v67, v67
    v_exp_f32 v68, v68
    v_exp_f32 v69, v69
    v_mfma_f32_32x32x16_bf16 v[16:31], v[172:175], v[144:147], v[16:31]
    v_exp_f32 v70, v70
    v_exp_f32 v71, v71
    v_exp_f32 v72, v72
    v_exp_f32 v73, v73
    v_mfma_f32_32x32x16_bf16 v[32:47], v[172:175], v[148:151], v[32:47]
    v_exp_f32 v74, v74
    v_exp_f32 v75, v75
    v_exp_f32 v76, v76
    v_exp_f32 v77, v77
    v_smfmac_f32_32x32x32_bf16 v[128:143], v[180:183], v[64:71], v2
    v_exp_f32 v78, v78
    v_exp_f32 v79, v79
    v_exp_f32 v16, v16
    v_exp_f32 v17, v17
    v_smfmac_f32_32x32x32_bf16 v[128:143], v[184:187], v[72:79], v2
    v_exp_f32 v18, v18
    v_exp_f32 v19, v19
    ds_read_b128 v[168:171], v212 offset:512
    v_exp_f32 v20, v20
    v_mfma_f32_32x32x4bf16_1k v[48:79], v[178:179], v[166:167], 0
    v_exp_f32 v21, v21
    v_exp_f32 v22, v22
    v_exp_f32 v23, v23
    v_exp_f32 v24, v24
    v_exp_f32 v25, v25
    v_exp_f32 v26, v26
    v_exp_f32 v27, v27
    v_exp_f32 v28, v28
    v_smfmac_f32_32x32x32_bf16 v[80:95], v[188:191], v[16:23], v2
    v_exp_f32 v29, v29
    v_exp_f32 v30, v30
    ds_read_b128 v[180:183], v213 offset:1536
    v_exp_f32 v31, v31
    v_exp_f32 v32, v32
    v_exp_f32 v33, v33
    v_smfmac_f32_32x32x32_bf16 v[80:95], v[192:195], v[24:31], v2
    v_exp_f32 v34, v34
    v_exp_f32 v35, v35
    ds_read_b128 v[184:187], v213 offset:2144
    v_exp_f32 v36, v36
    v_exp_f32 v37, v37
    v_mfma_f32_32x32x16_bf16 v[48:63], v[172:175], v[152:155], v[48:63]
    v_exp_f32 v38, v38
    v_exp_f32 v39, v39
    v_exp_f32 v40, v40
    v_exp_f32 v41, v41
    v_mfma_f32_32x32x16_bf16 v[64:79], v[172:175], v[156:159], v[64:79]
    v_exp_f32 v42, v42
    v_exp_f32 v43, v43
    v_exp_f32 v44, v44
    v_exp_f32 v45, v45
    v_smfmac_f32_32x32x32_bf16 v[96:111], v[188:191], v[32:39], v2
    v_exp_f32 v46, v46
    v_exp_f32 v47, v47
    v_exp_f32 v48, v48
    v_exp_f32 v49, v49
    v_smfmac_f32_32x32x32_bf16 v[96:111], v[192:195], v[40:47], v2
    v_exp_f32 v50, v50
    v_exp_f32 v51, v51
    v_exp_f32 v52, v52
    s_waitcnt lgkmcnt(0)
    v_mfma_f32_32x32x4bf16_1k v[16:47], v[176:177], v[160:161], 0
    v_exp_f32 v53, v53
    v_exp_f32 v54, v54
    v_exp_f32 v55, v55
    v_exp_f32 v56, v56
    v_exp_f32 v57, v57
    v_exp_f32 v58, v58
    v_exp_f32 v59, v59
    v_exp_f32 v60, v60
    v_smfmac_f32_32x32x32_bf16 v[112:127], v[188:191], v[48:55], v2
    v_exp_f32 v61, v61
    v_exp_f32 v62, v62
    v_exp_f32 v63, v63
    v_exp_f32 v64, v64
    v_exp_f32 v65, v65
    v_smfmac_f32_32x32x32_bf16 v[112:127], v[192:195], v[56:63], v2
    v_exp_f32 v66, v66
    v_exp_f32 v67, v67
    v_exp_f32 v68, v68
    v_exp_f32 v69, v69
    v_mfma_f32_32x32x16_bf16 v[16:31], v[168:171], v[144:147], v[16:31]
    v_exp_f32 v70, v70
    v_exp_f32 v71, v71
    v_exp_f32 v72, v72
    v_exp_f32 v73, v73
    v_mfma_f32_32x32x16_bf16 v[32:47], v[168:171], v[148:151], v[32:47]
    v_exp_f32 v74, v74
    v_exp_f32 v75, v75
    v_exp_f32 v76, v76
    v_exp_f32 v77, v77
    v_smfmac_f32_32x32x32_bf16 v[128:143], v[188:191], v[64:71], v2
    v_exp_f32 v78, v78
    v_exp_f32 v79, v79
    v_exp_f32 v16, v16
    v_exp_f32 v17, v17
    v_smfmac_f32_32x32x32_bf16 v[128:143], v[192:195], v[72:79], v2
    v_exp_f32 v18, v18
    v_exp_f32 v19, v19
    ds_read_b128 v[172:175], v212 offset:2752
    v_exp_f32 v20, v20
    v_mfma_f32_32x32x4bf16_1k v[48:79], v[176:177], v[164:165], 0
    v_exp_f32 v21, v21
    v_exp_f32 v22, v22
    v_exp_f32 v23, v23
    v_exp_f32 v24, v24
    v_exp_f32 v25, v25
    v_exp_f32 v26, v26
    v_exp_f32 v27, v27
    v_exp_f32 v28, v28
    v_smfmac_f32_32x32x32_bf16 v[80:95], v[180:183], v[16:23], v2
    v_exp_f32 v29, v29
    v_exp_f32 v30, v30
    ds_read_b128 v[188:191], v213 offset:3776
    v_exp_f32 v31, v31
    v_exp_f32 v32, v32
    ds_read2st64_b32 v[178:179], v216 offset0:0 offset1:1
    v_exp_f32 v33, v33
    v_smfmac_f32_32x32x32_bf16 v[80:95], v[184:187], v[24:31], v2
    v_exp_f32 v34, v34
    v_exp_f32 v35, v35
    ds_read_b128 v[192:195], v213 offset:4384
    v_exp_f32 v36, v36
    v_exp_f32 v37, v37
    v_mfma_f32_32x32x16_bf16 v[48:63], v[168:171], v[152:155], v[48:63]
    v_exp_f32 v38, v38
    v_exp_f32 v39, v39
    v_exp_f32 v40, v40
    v_exp_f32 v41, v41
    v_mfma_f32_32x32x16_bf16 v[64:79], v[168:171], v[156:159], v[64:79]
    v_exp_f32 v42, v42
    v_exp_f32 v43, v43
    v_exp_f32 v44, v44
    v_exp_f32 v45, v45
    v_smfmac_f32_32x32x32_bf16 v[96:111], v[180:183], v[32:39], v2
    v_exp_f32 v46, v46
    v_exp_f32 v47, v47
    v_exp_f32 v48, v48
    v_exp_f32 v49, v49
    v_smfmac_f32_32x32x32_bf16 v[96:111], v[184:187], v[40:47], v2
    v_exp_f32 v50, v50
    v_exp_f32 v51, v51
    v_exp_f32 v52, v52
    s_waitcnt lgkmcnt(0)
    v_mfma_f32_32x32x4bf16_1k v[16:47], v[176:177], v[162:163], 0
    v_exp_f32 v53, v53
    v_exp_f32 v54, v54
    v_exp_f32 v55, v55
    v_exp_f32 v56, v56
    v_exp_f32 v57, v57
    v_exp_f32 v58, v58
    v_exp_f32 v59, v59
    v_exp_f32 v60, v60
    v_smfmac_f32_32x32x32_bf16 v[112:127], v[180:183], v[48:55], v2
    v_exp_f32 v61, v61
    v_exp_f32 v62, v62
    v_exp_f32 v63, v63
    v_exp_f32 v64, v64
    v_exp_f32 v65, v65
    v_smfmac_f32_32x32x32_bf16 v[112:127], v[184:187], v[56:63], v2
    v_exp_f32 v66, v66
    v_exp_f32 v67, v67
    v_exp_f32 v68, v68
    v_exp_f32 v69, v69
    v_mfma_f32_32x32x16_bf16 v[16:31], v[172:175], v[144:147], v[16:31]
    v_exp_f32 v70, v70
    v_exp_f32 v71, v71
    v_exp_f32 v72, v72
    v_exp_f32 v73, v73
    v_mfma_f32_32x32x16_bf16 v[32:47], v[172:175], v[148:151], v[32:47]
    v_exp_f32 v74, v74
    v_exp_f32 v75, v75
    v_exp_f32 v76, v76
    v_exp_f32 v77, v77
    v_smfmac_f32_32x32x32_bf16 v[128:143], v[180:183], v[64:71], v2
    v_exp_f32 v78, v78
    v_exp_f32 v79, v79
    v_exp_f32 v16, v16
    v_exp_f32 v17, v17
    v_smfmac_f32_32x32x32_bf16 v[128:143], v[184:187], v[72:79], v2
    v_exp_f32 v18, v18
    v_exp_f32 v19, v19
    ds_read_b128 v[168:171], v212 offset:4992
    v_exp_f32 v20, v20
    v_mfma_f32_32x32x4bf16_1k v[48:79], v[176:177], v[166:167], 0
    v_exp_f32 v21, v21
    v_exp_f32 v22, v22
    v_exp_f32 v23, v23
    v_exp_f32 v24, v24
    v_exp_f32 v25, v25
    v_exp_f32 v26, v26
    v_exp_f32 v27, v27
    v_exp_f32 v28, v28
    v_smfmac_f32_32x32x32_bf16 v[80:95], v[188:191], v[16:23], v2
    v_exp_f32 v29, v29
    v_exp_f32 v30, v30
    ds_read_b128 v[180:183], v213 offset:6016
    v_exp_f32 v31, v31
    v_exp_f32 v32, v32
    v_exp_f32 v33, v33
    v_smfmac_f32_32x32x32_bf16 v[80:95], v[192:195], v[24:31], v2
    v_exp_f32 v34, v34
    v_exp_f32 v35, v35
    ds_read_b128 v[184:187], v213 offset:6624
    v_exp_f32 v36, v36
    v_exp_f32 v37, v37
    v_mfma_f32_32x32x16_bf16 v[48:63], v[172:175], v[152:155], v[48:63]
    v_exp_f32 v38, v38
    v_exp_f32 v39, v39
    v_exp_f32 v40, v40
    v_exp_f32 v41, v41
    v_mfma_f32_32x32x16_bf16 v[64:79], v[172:175], v[156:159], v[64:79]
    v_exp_f32 v42, v42
    v_exp_f32 v43, v43
    v_exp_f32 v44, v44
    v_exp_f32 v45, v45
    v_smfmac_f32_32x32x32_bf16 v[96:111], v[188:191], v[32:39], v2
    v_exp_f32 v46, v46
    v_exp_f32 v47, v47
    v_exp_f32 v48, v48
    v_exp_f32 v49, v49
    v_smfmac_f32_32x32x32_bf16 v[96:111], v[192:195], v[40:47], v2
    v_exp_f32 v50, v50
    v_exp_f32 v51, v51
    v_exp_f32 v52, v52
    s_waitcnt lgkmcnt(0)
    v_mfma_f32_32x32x4bf16_1k v[16:47], v[178:179], v[160:161], 0
    v_exp_f32 v53, v53
    v_exp_f32 v54, v54
    v_exp_f32 v55, v55
    v_exp_f32 v56, v56
    v_exp_f32 v57, v57
    v_exp_f32 v58, v58
    v_exp_f32 v59, v59
    v_exp_f32 v60, v60
    v_smfmac_f32_32x32x32_bf16 v[112:127], v[188:191], v[48:55], v2
    v_exp_f32 v61, v61
    v_exp_f32 v62, v62
    v_exp_f32 v63, v63
    v_exp_f32 v64, v64
    v_exp_f32 v65, v65
    v_smfmac_f32_32x32x32_bf16 v[112:127], v[192:195], v[56:63], v2
    v_exp_f32 v66, v66
    v_exp_f32 v67, v67
    v_exp_f32 v68, v68
    v_exp_f32 v69, v69
    v_mfma_f32_32x32x16_bf16 v[16:31], v[168:171], v[144:147], v[16:31]
    v_exp_f32 v70, v70
    v_exp_f32 v71, v71
    v_exp_f32 v72, v72
    v_exp_f32 v73, v73
    v_mfma_f32_32x32x16_bf16 v[32:47], v[168:171], v[148:151], v[32:47]
    v_exp_f32 v74, v74
    v_exp_f32 v75, v75
    v_exp_f32 v76, v76
    v_exp_f32 v77, v77
    v_smfmac_f32_32x32x32_bf16 v[128:143], v[188:191], v[64:71], v2
    v_exp_f32 v78, v78
    v_exp_f32 v79, v79
    v_exp_f32 v16, v16
    v_exp_f32 v17, v17
    v_smfmac_f32_32x32x32_bf16 v[128:143], v[192:195], v[72:79], v2
    v_exp_f32 v18, v18
    v_exp_f32 v19, v19
    ds_read_b128 v[172:175], v212 offset:7232
    v_exp_f32 v20, v20
    v_mfma_f32_32x32x4bf16_1k v[48:79], v[178:179], v[164:165], 0
    v_exp_f32 v21, v21
    v_exp_f32 v22, v22
    v_exp_f32 v23, v23
    v_exp_f32 v24, v24
    v_exp_f32 v25, v25
    v_exp_f32 v26, v26
    v_exp_f32 v27, v27
    v_exp_f32 v28, v28
    v_smfmac_f32_32x32x32_bf16 v[80:95], v[180:183], v[16:23], v2
    v_exp_f32 v29, v29
    v_exp_f32 v30, v30
    ds_read_b128 v[188:191], v213 offset:8256
    v_exp_f32 v31, v31
    v_exp_f32 v32, v32
    ds_read2st64_b32 v[176:177], v215 offset0:37 offset1:38
    v_exp_f32 v33, v33
    v_smfmac_f32_32x32x32_bf16 v[80:95], v[184:187], v[24:31], v2
    v_exp_f32 v34, v34
    v_exp_f32 v35, v35
    ds_read_b128 v[192:195], v213 offset:8864
    v_exp_f32 v36, v36
    v_exp_f32 v37, v37
    v_mfma_f32_32x32x16_bf16 v[48:63], v[168:171], v[152:155], v[48:63]
    v_exp_f32 v38, v38
    v_exp_f32 v39, v39
    v_exp_f32 v40, v40
    v_exp_f32 v41, v41
    v_mfma_f32_32x32x16_bf16 v[64:79], v[168:171], v[156:159], v[64:79]
    v_exp_f32 v42, v42
    v_exp_f32 v43, v43
    v_exp_f32 v44, v44
    v_exp_f32 v45, v45
    v_smfmac_f32_32x32x32_bf16 v[96:111], v[180:183], v[32:39], v2
    v_exp_f32 v46, v46
    v_exp_f32 v47, v47
    v_exp_f32 v48, v48
    v_exp_f32 v49, v49
    v_smfmac_f32_32x32x32_bf16 v[96:111], v[184:187], v[40:47], v2
    v_exp_f32 v50, v50
    v_exp_f32 v51, v51
    v_exp_f32 v52, v52
    s_waitcnt lgkmcnt(0)
    v_mfma_f32_32x32x4bf16_1k v[16:47], v[178:179], v[162:163], 0
    v_exp_f32 v53, v53
    v_exp_f32 v54, v54
    v_exp_f32 v55, v55
    v_exp_f32 v56, v56
    v_exp_f32 v57, v57
    v_exp_f32 v58, v58
    v_exp_f32 v59, v59
    v_exp_f32 v60, v60
    v_smfmac_f32_32x32x32_bf16 v[112:127], v[180:183], v[48:55], v2
    v_exp_f32 v61, v61
    v_exp_f32 v62, v62
    v_exp_f32 v63, v63
    v_exp_f32 v64, v64
    v_exp_f32 v65, v65
    v_smfmac_f32_32x32x32_bf16 v[112:127], v[184:187], v[56:63], v2
    v_exp_f32 v66, v66
    v_exp_f32 v67, v67
    v_exp_f32 v68, v68
    v_exp_f32 v69, v69
    v_mfma_f32_32x32x16_bf16 v[16:31], v[172:175], v[144:147], v[16:31]
    v_exp_f32 v70, v70
    v_exp_f32 v71, v71
    v_exp_f32 v72, v72
    v_exp_f32 v73, v73
    v_mfma_f32_32x32x16_bf16 v[32:47], v[172:175], v[148:151], v[32:47]
    v_exp_f32 v74, v74
    v_exp_f32 v75, v75
    v_exp_f32 v76, v76
    v_exp_f32 v77, v77
    v_smfmac_f32_32x32x32_bf16 v[128:143], v[180:183], v[64:71], v2
    v_exp_f32 v78, v78
    v_exp_f32 v79, v79
    v_exp_f32 v16, v16
    v_exp_f32 v17, v17
    v_smfmac_f32_32x32x32_bf16 v[128:143], v[184:187], v[72:79], v2
    v_exp_f32 v18, v18
    v_exp_f32 v19, v19
    ds_read_b128 v[168:171], v212 offset:9984
    v_exp_f32 v20, v20
    v_mfma_f32_32x32x4bf16_1k v[48:79], v[178:179], v[166:167], 0
    v_exp_f32 v21, v21
    v_exp_f32 v22, v22
    v_exp_f32 v23, v23
    v_exp_f32 v24, v24
    v_exp_f32 v25, v25
    v_exp_f32 v26, v26
    v_exp_f32 v27, v27
    v_exp_f32 v28, v28
    v_smfmac_f32_32x32x32_bf16 v[80:95], v[188:191], v[16:23], v2
    v_exp_f32 v29, v29
    v_exp_f32 v30, v30
    ds_read_b128 v[180:183], v213 offset:11008
    v_exp_f32 v31, v31
    v_exp_f32 v32, v32
    v_exp_f32 v33, v33
    v_smfmac_f32_32x32x32_bf16 v[80:95], v[192:195], v[24:31], v2
    v_exp_f32 v34, v34
    v_exp_f32 v35, v35
    ds_read_b128 v[184:187], v213 offset:11616
    v_exp_f32 v36, v36
    v_exp_f32 v37, v37
    v_mfma_f32_32x32x16_bf16 v[48:63], v[172:175], v[152:155], v[48:63]
    v_exp_f32 v38, v38
    v_exp_f32 v39, v39
    v_exp_f32 v40, v40
    v_exp_f32 v41, v41
    v_mfma_f32_32x32x16_bf16 v[64:79], v[172:175], v[156:159], v[64:79]
    v_exp_f32 v42, v42
    v_exp_f32 v43, v43
    v_exp_f32 v44, v44
    v_exp_f32 v45, v45
    v_smfmac_f32_32x32x32_bf16 v[96:111], v[188:191], v[32:39], v2
    v_exp_f32 v46, v46
    v_exp_f32 v47, v47
    v_exp_f32 v48, v48
    v_exp_f32 v49, v49
    v_smfmac_f32_32x32x32_bf16 v[96:111], v[192:195], v[40:47], v2
    v_exp_f32 v50, v50
    v_exp_f32 v51, v51
    v_exp_f32 v52, v52
    s_waitcnt lgkmcnt(0)
    v_mfma_f32_32x32x4bf16_1k v[16:47], v[176:177], v[160:161], 0
    v_exp_f32 v53, v53
    v_exp_f32 v54, v54
    v_exp_f32 v55, v55
    v_exp_f32 v56, v56
    v_exp_f32 v57, v57
    v_exp_f32 v58, v58
    v_exp_f32 v59, v59
    v_exp_f32 v60, v60
    v_smfmac_f32_32x32x32_bf16 v[112:127], v[188:191], v[48:55], v2
    v_exp_f32 v61, v61
    v_exp_f32 v62, v62
    v_exp_f32 v63, v63
    v_exp_f32 v64, v64
    v_exp_f32 v65, v65
    v_smfmac_f32_32x32x32_bf16 v[112:127], v[192:195], v[56:63], v2
    v_exp_f32 v66, v66
    v_exp_f32 v67, v67
    v_exp_f32 v68, v68
    v_exp_f32 v69, v69
    v_mfma_f32_32x32x16_bf16 v[16:31], v[168:171], v[144:147], v[16:31]
    v_exp_f32 v70, v70
    v_exp_f32 v71, v71
    v_exp_f32 v72, v72
    v_exp_f32 v73, v73
    v_mfma_f32_32x32x16_bf16 v[32:47], v[168:171], v[148:151], v[32:47]
    v_exp_f32 v74, v74
    v_exp_f32 v75, v75
    v_exp_f32 v76, v76
    v_exp_f32 v77, v77
    v_smfmac_f32_32x32x32_bf16 v[128:143], v[188:191], v[64:71], v2
    v_exp_f32 v78, v78
    v_exp_f32 v79, v79
    v_exp_f32 v16, v16
    v_exp_f32 v17, v17
    v_smfmac_f32_32x32x32_bf16 v[128:143], v[192:195], v[72:79], v2
    v_exp_f32 v18, v18
    v_exp_f32 v19, v19
    ds_read_b128 v[172:175], v212 offset:12224
    v_exp_f32 v20, v20
    v_mfma_f32_32x32x4bf16_1k v[48:79], v[176:177], v[164:165], 0
    v_exp_f32 v21, v21
    v_exp_f32 v22, v22
    v_exp_f32 v23, v23
    v_exp_f32 v24, v24
    v_exp_f32 v25, v25
    v_exp_f32 v26, v26
    v_exp_f32 v27, v27
    v_exp_f32 v28, v28
    v_smfmac_f32_32x32x32_bf16 v[80:95], v[180:183], v[16:23], v2
    v_exp_f32 v29, v29
    v_exp_f32 v30, v30
    ds_read_b128 v[188:191], v213 offset:13248
    v_exp_f32 v31, v31
    v_exp_f32 v32, v32
    ds_read2st64_b32 v[178:179], v216 offset0:37 offset1:38
    v_exp_f32 v33, v33
    v_smfmac_f32_32x32x32_bf16 v[80:95], v[184:187], v[24:31], v2
    v_exp_f32 v34, v34
    v_exp_f32 v35, v35
    ds_read_b128 v[192:195], v213 offset:13856
    v_exp_f32 v36, v36
    v_exp_f32 v37, v37
    v_mfma_f32_32x32x16_bf16 v[48:63], v[168:171], v[152:155], v[48:63]
    v_exp_f32 v38, v38
    v_exp_f32 v39, v39
    v_exp_f32 v40, v40
    v_exp_f32 v41, v41
    v_mfma_f32_32x32x16_bf16 v[64:79], v[168:171], v[156:159], v[64:79]
    v_exp_f32 v42, v42
    v_exp_f32 v43, v43
    v_exp_f32 v44, v44
    v_exp_f32 v45, v45
    v_smfmac_f32_32x32x32_bf16 v[96:111], v[180:183], v[32:39], v2
    v_exp_f32 v46, v46
    v_exp_f32 v47, v47
    v_exp_f32 v48, v48
    v_exp_f32 v49, v49
    v_smfmac_f32_32x32x32_bf16 v[96:111], v[184:187], v[40:47], v2
    v_exp_f32 v50, v50
    v_exp_f32 v51, v51
    v_exp_f32 v52, v52
    s_waitcnt lgkmcnt(0)
    v_mfma_f32_32x32x4bf16_1k v[16:47], v[176:177], v[162:163], 0
    v_exp_f32 v53, v53
    v_exp_f32 v54, v54
    v_exp_f32 v55, v55
    v_exp_f32 v56, v56
    v_exp_f32 v57, v57
    v_exp_f32 v58, v58
    v_exp_f32 v59, v59
    v_exp_f32 v60, v60
    v_smfmac_f32_32x32x32_bf16 v[112:127], v[180:183], v[48:55], v2
    v_exp_f32 v61, v61
    v_exp_f32 v62, v62
    v_exp_f32 v63, v63
    v_exp_f32 v64, v64
    v_exp_f32 v65, v65
    v_smfmac_f32_32x32x32_bf16 v[112:127], v[184:187], v[56:63], v2
    v_exp_f32 v66, v66
    v_exp_f32 v67, v67
    v_exp_f32 v68, v68
    v_exp_f32 v69, v69
    v_mfma_f32_32x32x16_bf16 v[16:31], v[172:175], v[144:147], v[16:31]
    v_exp_f32 v70, v70
    v_exp_f32 v71, v71
    v_exp_f32 v72, v72
    v_exp_f32 v73, v73
    v_mfma_f32_32x32x16_bf16 v[32:47], v[172:175], v[148:151], v[32:47]
    v_exp_f32 v74, v74
    v_exp_f32 v75, v75
    v_exp_f32 v76, v76
    v_exp_f32 v77, v77
    v_smfmac_f32_32x32x32_bf16 v[128:143], v[180:183], v[64:71], v2
    v_exp_f32 v78, v78
    v_exp_f32 v79, v79
    v_exp_f32 v16, v16
    v_exp_f32 v17, v17
    v_smfmac_f32_32x32x32_bf16 v[128:143], v[184:187], v[72:79], v2
    v_exp_f32 v18, v18
    v_exp_f32 v19, v19
    ds_read_b128 v[168:171], v212 offset:14464
    v_exp_f32 v20, v20
    v_mfma_f32_32x32x4bf16_1k v[48:79], v[176:177], v[166:167], 0
    v_exp_f32 v21, v21
    v_exp_f32 v22, v22
    v_exp_f32 v23, v23
    v_exp_f32 v24, v24
    v_exp_f32 v25, v25
    v_exp_f32 v26, v26
    v_exp_f32 v27, v27
    v_exp_f32 v28, v28
    v_smfmac_f32_32x32x32_bf16 v[80:95], v[188:191], v[16:23], v2
    v_exp_f32 v29, v29
    v_exp_f32 v30, v30
    ds_read_b128 v[180:183], v213 offset:15488
    v_exp_f32 v31, v31
    v_exp_f32 v32, v32
    v_exp_f32 v33, v33
    v_smfmac_f32_32x32x32_bf16 v[80:95], v[192:195], v[24:31], v2
    v_exp_f32 v34, v34
    v_exp_f32 v35, v35
    ds_read_b128 v[184:187], v213 offset:16096
    v_exp_f32 v36, v36
    v_exp_f32 v37, v37
    v_mfma_f32_32x32x16_bf16 v[48:63], v[172:175], v[152:155], v[48:63]
    v_exp_f32 v38, v38
    v_exp_f32 v39, v39
    v_exp_f32 v40, v40
    v_exp_f32 v41, v41
    v_mfma_f32_32x32x16_bf16 v[64:79], v[172:175], v[156:159], v[64:79]
    v_exp_f32 v42, v42
    v_exp_f32 v43, v43
    v_exp_f32 v44, v44
    v_exp_f32 v45, v45
    v_smfmac_f32_32x32x32_bf16 v[96:111], v[188:191], v[32:39], v2
    v_exp_f32 v46, v46
    v_exp_f32 v47, v47
    v_exp_f32 v48, v48
    v_exp_f32 v49, v49
    v_smfmac_f32_32x32x32_bf16 v[96:111], v[192:195], v[40:47], v2
    v_exp_f32 v50, v50
    v_exp_f32 v51, v51
    v_exp_f32 v52, v52
    s_waitcnt lgkmcnt(0)
    v_mfma_f32_32x32x4bf16_1k v[16:47], v[178:179], v[160:161], 0
    v_exp_f32 v53, v53
    v_exp_f32 v54, v54
    v_exp_f32 v55, v55
    v_exp_f32 v56, v56
    v_exp_f32 v57, v57
    v_exp_f32 v58, v58
    v_exp_f32 v59, v59
    v_exp_f32 v60, v60
    v_smfmac_f32_32x32x32_bf16 v[112:127], v[188:191], v[48:55], v2
    v_exp_f32 v61, v61
    v_exp_f32 v62, v62
    v_exp_f32 v63, v63
    v_exp_f32 v64, v64
    v_exp_f32 v65, v65
    v_smfmac_f32_32x32x32_bf16 v[112:127], v[192:195], v[56:63], v2
    v_exp_f32 v66, v66
    v_exp_f32 v67, v67
    v_exp_f32 v68, v68
    v_exp_f32 v69, v69
    v_mfma_f32_32x32x16_bf16 v[16:31], v[168:171], v[144:147], v[16:31]
    v_exp_f32 v70, v70
    v_exp_f32 v71, v71
    v_exp_f32 v72, v72
    v_exp_f32 v73, v73
    v_mfma_f32_32x32x16_bf16 v[32:47], v[168:171], v[148:151], v[32:47]
    v_exp_f32 v74, v74
    v_exp_f32 v75, v75
    v_exp_f32 v76, v76
    v_exp_f32 v77, v77
    v_smfmac_f32_32x32x32_bf16 v[128:143], v[188:191], v[64:71], v2
    v_exp_f32 v78, v78
    v_exp_f32 v79, v79
    v_exp_f32 v16, v16
    v_exp_f32 v17, v17
    v_smfmac_f32_32x32x32_bf16 v[128:143], v[192:195], v[72:79], v2
    v_exp_f32 v18, v18
    v_exp_f32 v19, v19
    ds_read_b128 v[172:175], v212 offset:16704
    v_exp_f32 v20, v20
    v_mfma_f32_32x32x4bf16_1k v[48:79], v[178:179], v[164:165], 0
    v_exp_f32 v21, v21
    v_exp_f32 v22, v22
    v_exp_f32 v23, v23
    v_exp_f32 v24, v24
    v_exp_f32 v25, v25
    v_exp_f32 v26, v26
    v_exp_f32 v27, v27
    v_exp_f32 v28, v28
    v_smfmac_f32_32x32x32_bf16 v[80:95], v[180:183], v[16:23], v2
    v_exp_f32 v29, v29
    v_exp_f32 v30, v30
    ds_read_b128 v[188:191], v213 offset:17728
    v_exp_f32 v31, v31
    v_exp_f32 v32, v32
    ds_read2st64_b32 v[176:177], v215 offset0:74 offset1:75
    v_exp_f32 v33, v33
    v_smfmac_f32_32x32x32_bf16 v[80:95], v[184:187], v[24:31], v2
    v_exp_f32 v34, v34
    v_exp_f32 v35, v35
    ds_read_b128 v[192:195], v213 offset:18336
    v_exp_f32 v36, v36
    v_exp_f32 v37, v37
    v_mfma_f32_32x32x16_bf16 v[48:63], v[168:171], v[152:155], v[48:63]
    v_exp_f32 v38, v38
    v_exp_f32 v39, v39
    v_exp_f32 v40, v40
    v_exp_f32 v41, v41
    v_mfma_f32_32x32x16_bf16 v[64:79], v[168:171], v[156:159], v[64:79]
    v_exp_f32 v42, v42
    v_exp_f32 v43, v43
    v_exp_f32 v44, v44
    v_exp_f32 v45, v45
    v_smfmac_f32_32x32x32_bf16 v[96:111], v[180:183], v[32:39], v2
    v_exp_f32 v46, v46
    v_exp_f32 v47, v47
    v_exp_f32 v48, v48
    v_exp_f32 v49, v49
    v_smfmac_f32_32x32x32_bf16 v[96:111], v[184:187], v[40:47], v2
    v_exp_f32 v50, v50
    v_exp_f32 v51, v51
    v_exp_f32 v52, v52
    s_waitcnt lgkmcnt(0)
    v_mfma_f32_32x32x4bf16_1k v[16:47], v[178:179], v[162:163], 0
    v_exp_f32 v53, v53
    v_exp_f32 v54, v54
    v_exp_f32 v55, v55
    v_exp_f32 v56, v56
    v_exp_f32 v57, v57
    v_exp_f32 v58, v58
    v_exp_f32 v59, v59
    v_exp_f32 v60, v60
    v_smfmac_f32_32x32x32_bf16 v[112:127], v[180:183], v[48:55], v2
    v_exp_f32 v61, v61
    v_exp_f32 v62, v62
    v_exp_f32 v63, v63
    v_exp_f32 v64, v64
    v_exp_f32 v65, v65
    v_smfmac_f32_32x32x32_bf16 v[112:127], v[184:187], v[56:63], v2
    v_exp_f32 v66, v66
    v_exp_f32 v67, v67
    v_exp_f32 v68, v68
    v_exp_f32 v69, v69
    v_mfma_f32_32x32x16_bf16 v[16:31], v[172:175], v[144:147], v[16:31]
    v_exp_f32 v70, v70
    v_exp_f32 v71, v71
    v_exp_f32 v72, v72
    v_exp_f32 v73, v73
    v_mfma_f32_32x32x16_bf16 v[32:47], v[172:175], v[148:151], v[32:47]
    v_exp_f32 v74, v74
    v_exp_f32 v75, v75
    v_exp_f32 v76, v76
    v_exp_f32 v77, v77
    v_smfmac_f32_32x32x32_bf16 v[128:143], v[180:183], v[64:71], v2
    v_exp_f32 v78, v78
    v_exp_f32 v79, v79
    v_exp_f32 v16, v16
    v_exp_f32 v17, v17
    v_smfmac_f32_32x32x32_bf16 v[128:143], v[184:187], v[72:79], v2
    v_exp_f32 v18, v18
    v_exp_f32 v19, v19
    ds_read_b128 v[168:171], v212 offset:19456
    v_exp_f32 v20, v20
    v_mfma_f32_32x32x4bf16_1k v[48:79], v[178:179], v[166:167], 0
    v_exp_f32 v21, v21
    v_exp_f32 v22, v22
    v_exp_f32 v23, v23
    v_exp_f32 v24, v24
    v_exp_f32 v25, v25
    v_exp_f32 v26, v26
    v_exp_f32 v27, v27
    v_exp_f32 v28, v28
    v_smfmac_f32_32x32x32_bf16 v[80:95], v[188:191], v[16:23], v2
    v_exp_f32 v29, v29
    v_exp_f32 v30, v30
    ds_read_b128 v[180:183], v213 offset:20480
    v_exp_f32 v31, v31
    v_exp_f32 v32, v32
    v_exp_f32 v33, v33
    v_smfmac_f32_32x32x32_bf16 v[80:95], v[192:195], v[24:31], v2
    v_exp_f32 v34, v34
    v_exp_f32 v35, v35
    ds_read_b128 v[184:187], v213 offset:21088
    v_exp_f32 v36, v36
    v_exp_f32 v37, v37
    v_mfma_f32_32x32x16_bf16 v[48:63], v[172:175], v[152:155], v[48:63]
    v_exp_f32 v38, v38
    v_exp_f32 v39, v39
    v_exp_f32 v40, v40
    v_exp_f32 v41, v41
    v_mfma_f32_32x32x16_bf16 v[64:79], v[172:175], v[156:159], v[64:79]
    v_exp_f32 v42, v42
    v_exp_f32 v43, v43
    v_exp_f32 v44, v44
    v_exp_f32 v45, v45
    v_smfmac_f32_32x32x32_bf16 v[96:111], v[188:191], v[32:39], v2
    v_exp_f32 v46, v46
    v_exp_f32 v47, v47
    v_exp_f32 v48, v48
    v_exp_f32 v49, v49
    v_smfmac_f32_32x32x32_bf16 v[96:111], v[192:195], v[40:47], v2
    v_exp_f32 v50, v50
    v_exp_f32 v51, v51
    v_exp_f32 v52, v52
    s_waitcnt lgkmcnt(0)
    v_mfma_f32_32x32x4bf16_1k v[16:47], v[176:177], v[160:161], 0
    v_exp_f32 v53, v53
    v_exp_f32 v54, v54
    v_exp_f32 v55, v55
    v_exp_f32 v56, v56
    v_exp_f32 v57, v57
    v_exp_f32 v58, v58
    v_exp_f32 v59, v59
    v_exp_f32 v60, v60
    v_smfmac_f32_32x32x32_bf16 v[112:127], v[188:191], v[48:55], v2
    v_exp_f32 v61, v61
    v_exp_f32 v62, v62
    v_exp_f32 v63, v63
    v_exp_f32 v64, v64
    v_exp_f32 v65, v65
    v_smfmac_f32_32x32x32_bf16 v[112:127], v[192:195], v[56:63], v2
    v_exp_f32 v66, v66
    v_exp_f32 v67, v67
    v_exp_f32 v68, v68
    v_exp_f32 v69, v69
    v_mfma_f32_32x32x16_bf16 v[16:31], v[168:171], v[144:147], v[16:31]
    v_exp_f32 v70, v70
    v_exp_f32 v71, v71
    v_exp_f32 v72, v72
    v_exp_f32 v73, v73
    v_mfma_f32_32x32x16_bf16 v[32:47], v[168:171], v[148:151], v[32:47]
    v_exp_f32 v74, v74
    v_exp_f32 v75, v75
    v_exp_f32 v76, v76
    v_exp_f32 v77, v77
    v_smfmac_f32_32x32x32_bf16 v[128:143], v[188:191], v[64:71], v2
    v_exp_f32 v78, v78
    v_exp_f32 v79, v79
    s_waitcnt vmcnt(0)
    s_barrier
    v_exp_f32 v16, v16
    v_exp_f32 v17, v17
    v_smfmac_f32_32x32x32_bf16 v[128:143], v[192:195], v[72:79], v2
    v_exp_f32 v18, v18
    v_exp_f32 v19, v19
    ds_read_b128 v[172:175], v212 offset:21696
    v_exp_f32 v20, v20
    v_mfma_f32_32x32x4bf16_1k v[48:79], v[176:177], v[164:165], 0
    v_exp_f32 v21, v21
    v_exp_f32 v22, v22
    v_exp_f32 v23, v23
    v_exp_f32 v24, v24
    v_exp_f32 v25, v25
    v_exp_f32 v26, v26
    v_exp_f32 v27, v27
    v_exp_f32 v28, v28
    v_smfmac_f32_32x32x32_bf16 v[80:95], v[180:183], v[16:23], v2
    s_lshr_b32 s38, s35, 1
    s_and_b32 s39, s35, 1
    s_mul_i32 s42, s38, 165888
    s_lshl_b32 s36, s52, 7
    s_add_u32 s43, s42, s36
    s_mul_i32 s36, s39, 9216
    s_add_u32 s36, s36, s43
    s_and_b32 s45, s38, 1
    s_mul_i32 s37, s45, 18432
    s_lshl_b32 s44, s39, 10
    s_add_u32 s37, s37, s44
    s_lshr_b32 s38, s38, 1
    s_mul_i32 s38, s38, 75776
    s_add_u32 s37, s37, s38
    s_mov_b32 m0, s37
    s_nop 0
    buffer_load_dwordx4 v217, s[8:11], s36 offen lds
    v_exp_f32 v29, v29
    v_exp_f32 v30, v30
    ds_read_b128 v[188:191], v213 offset:22720
    v_exp_f32 v31, v31
    s_add_u32 s36, s36, 20736
    s_add_u32 s37, s37, 2048
    s_mov_b32 m0, s37
    s_nop 0
    buffer_load_dwordx4 v217, s[8:11], s36 offen lds
    v_exp_f32 v32, v32
    ds_read2st64_b32 v[178:179], v216 offset0:74 offset1:75
    v_exp_f32 v33, v33
    v_smfmac_f32_32x32x32_bf16 v[80:95], v[184:187], v[24:31], v2
    v_exp_f32 v34, v34
    v_exp_f32 v35, v35
    ds_read_b128 v[192:195], v213 offset:23328
    v_exp_f32 v36, v36
    v_exp_f32 v37, v37
    v_mfma_f32_32x32x16_bf16 v[48:63], v[168:171], v[152:155], v[48:63]
    s_add_u32 s36, s36, 20736
    s_add_u32 s37, s37, 2048
    s_mov_b32 m0, s37
    s_nop 0
    buffer_load_dwordx4 v217, s[8:11], s36 offen lds
    v_exp_f32 v38, v38
    v_exp_f32 v39, v39
    v_exp_f32 v40, v40
    v_exp_f32 v41, v41
    v_mfma_f32_32x32x16_bf16 v[64:79], v[168:171], v[156:159], v[64:79]
    v_exp_f32 v42, v42
    v_exp_f32 v43, v43
    v_exp_f32 v44, v44
    v_exp_f32 v45, v45
    v_smfmac_f32_32x32x32_bf16 v[96:111], v[180:183], v[32:39], v2
    v_exp_f32 v46, v46
    v_exp_f32 v47, v47
    s_add_u32 s36, s36, 20736
    s_add_u32 s37, s37, 2048
    s_mov_b32 m0, s37
    s_nop 0
    buffer_load_dwordx4 v217, s[8:11], s36 offen lds
    v_exp_f32 v48, v48
    v_exp_f32 v49, v49
    v_smfmac_f32_32x32x32_bf16 v[96:111], v[184:187], v[40:47], v2
    v_exp_f32 v50, v50
    v_exp_f32 v51, v51
    v_exp_f32 v52, v52
    s_waitcnt lgkmcnt(0)
    v_mfma_f32_32x32x4bf16_1k v[16:47], v[176:177], v[162:163], 0
    v_exp_f32 v53, v53
    v_exp_f32 v54, v54
    v_exp_f32 v55, v55
    v_exp_f32 v56, v56
    v_exp_f32 v57, v57
    v_exp_f32 v58, v58
    v_exp_f32 v59, v59
    v_exp_f32 v60, v60
    v_smfmac_f32_32x32x32_bf16 v[112:127], v[180:183], v[48:55], v2
    s_add_u32 s36, s36, 20736
    s_add_u32 s37, s37, 2048
    s_mov_b32 m0, s37
    s_nop 0
    buffer_load_dwordx4 v217, s[8:11], s36 offen lds
    v_exp_f32 v61, v61
    v_exp_f32 v62, v62
    v_exp_f32 v63, v63
    s_add_u32 s36, s36, 20736
    s_add_u32 s37, s37, 2048
    s_mov_b32 m0, s37
    s_nop 0
    buffer_load_dwordx4 v217, s[8:11], s36 offen lds
    v_exp_f32 v64, v64
    v_exp_f32 v65, v65
    v_smfmac_f32_32x32x32_bf16 v[112:127], v[184:187], v[56:63], v2
    v_exp_f32 v66, v66
    v_exp_f32 v67, v67
    v_exp_f32 v68, v68
    v_exp_f32 v69, v69
    v_mfma_f32_32x32x16_bf16 v[16:31], v[172:175], v[144:147], v[16:31]
    s_add_u32 s36, s36, 20736
    s_add_u32 s37, s37, 2048
    s_mov_b32 m0, s37
    s_nop 0
    buffer_load_dwordx4 v217, s[8:11], s36 offen lds
    v_exp_f32 v70, v70
    v_exp_f32 v71, v71
    v_exp_f32 v72, v72
    v_exp_f32 v73, v73
    v_mfma_f32_32x32x16_bf16 v[32:47], v[172:175], v[148:151], v[32:47]
    v_exp_f32 v74, v74
    v_exp_f32 v75, v75
    v_exp_f32 v76, v76
    v_exp_f32 v77, v77
    v_smfmac_f32_32x32x32_bf16 v[128:143], v[180:183], v[64:71], v2
    v_exp_f32 v78, v78
    v_exp_f32 v79, v79
    s_add_u32 s36, s36, 20736
    s_add_u32 s37, s37, 2048
    s_mov_b32 m0, s37
    s_nop 0
    buffer_load_dwordx4 v217, s[8:11], s36 offen lds
    v_exp_f32 v16, v16
    v_exp_f32 v17, v17
    v_smfmac_f32_32x32x32_bf16 v[128:143], v[184:187], v[72:79], v2
    v_exp_f32 v18, v18
    v_exp_f32 v19, v19
    ds_read_b128 v[168:171], v212 offset:23936
    v_exp_f32 v20, v20
    v_mfma_f32_32x32x4bf16_1k v[48:79], v[176:177], v[166:167], 0
    v_exp_f32 v21, v21
    v_exp_f32 v22, v22
    v_exp_f32 v23, v23
    v_exp_f32 v24, v24
    v_exp_f32 v25, v25
    v_exp_f32 v26, v26
    v_exp_f32 v27, v27
    v_exp_f32 v28, v28
    v_smfmac_f32_32x32x32_bf16 v[80:95], v[188:191], v[16:23], v2
    s_add_u32 s36, s36, 20736
    s_add_u32 s37, s37, 2048
    s_mul_i32 s36, s39, 1152
    s_add_u32 s36, s36, s43
    s_add_u32 s36, s36, 18432
    s_mov_b32 m0, s37
    s_nop 0
    buffer_load_dwordx4 v218, s[8:11], s36 offen lds
    v_exp_f32 v29, v29
    v_exp_f32 v30, v30
    ds_read_b128 v[180:183], v213 offset:24960
    v_exp_f32 v31, v31
    s_lshr_b32 s36, s34, 1
    s_lshl_b32 s36, s36, 6
    s_add_u32 s42, s42, s36
    s_add_u32 s42, s42, 1024
    s_mul_i32 s36, s39, 20736
    s_add_u32 s36, s36, s42
    s_mul_i32 s43, s45, 9216
    s_add_u32 s43, s43, s38
    s_add_u32 s43, s43, 36864
    s_add_u32 s37, s43, s44
    s_mov_b32 m0, s37
    s_nop 0
    buffer_load_dwordx4 v219, s[8:11], s36 offen lds
    v_exp_f32 v32, v32
    v_exp_f32 v33, v33
    v_smfmac_f32_32x32x32_bf16 v[80:95], v[192:195], v[24:31], v2
    v_exp_f32 v34, v34
    v_exp_f32 v35, v35
    ds_read_b128 v[184:187], v213 offset:25568
    v_exp_f32 v36, v36
    v_exp_f32 v37, v37
    v_mfma_f32_32x32x16_bf16 v[48:63], v[172:175], v[152:155], v[48:63]
    s_add_u32 s36, s36, 41472
    s_add_u32 s37, s37, 2048
    s_mov_b32 m0, s37
    s_nop 0
    buffer_load_dwordx4 v219, s[8:11], s36 offen lds
    v_exp_f32 v38, v38
    v_exp_f32 v39, v39
    v_exp_f32 v40, v40
    v_exp_f32 v41, v41
    v_mfma_f32_32x32x16_bf16 v[64:79], v[172:175], v[156:159], v[64:79]
    v_exp_f32 v42, v42
    v_exp_f32 v43, v43
    v_exp_f32 v44, v44
    v_exp_f32 v45, v45
    v_smfmac_f32_32x32x32_bf16 v[96:111], v[188:191], v[32:39], v2
    v_exp_f32 v46, v46
    v_exp_f32 v47, v47
    s_add_u32 s36, s36, 41472
    s_add_u32 s37, s37, 2048
    s_mov_b32 m0, s37
    s_nop 0
    buffer_load_dwordx4 v219, s[8:11], s36 offen lds
    v_exp_f32 v48, v48
    v_exp_f32 v49, v49
    v_smfmac_f32_32x32x32_bf16 v[96:111], v[192:195], v[40:47], v2
    v_exp_f32 v50, v50
    v_exp_f32 v51, v51
    v_exp_f32 v52, v52
    s_waitcnt lgkmcnt(0)
    v_mfma_f32_32x32x4bf16_1k v[16:47], v[178:179], v[160:161], 0
    v_exp_f32 v53, v53
    v_exp_f32 v54, v54
    v_exp_f32 v55, v55
    v_exp_f32 v56, v56
    v_exp_f32 v57, v57
    v_exp_f32 v58, v58
    v_exp_f32 v59, v59
    v_exp_f32 v60, v60
    v_smfmac_f32_32x32x32_bf16 v[112:127], v[188:191], v[48:55], v2
    s_add_u32 s36, s36, 41472
    s_add_u32 s37, s37, 2048
    s_mov_b32 m0, s37
    s_nop 0
    buffer_load_dwordx4 v219, s[8:11], s36 offen lds
    v_exp_f32 v61, v61
    v_exp_f32 v62, v62
    v_exp_f32 v63, v63
    s_cmp_eq_u32 s39, 0
    s_cbranch_scc0 L_con_wox1
    s_add_u32 s36, s42, 18432
    s_add_u32 s37, s43, 8192
    s_mov_b32 m0, s37
    s_nop 0
    buffer_load_dwordx4 v220, s[8:11], s36 offen lds
L_con_wox1:
    v_exp_f32 v64, v64
    v_exp_f32 v65, v65
    v_smfmac_f32_32x32x32_bf16 v[112:127], v[192:195], v[56:63], v2
    v_exp_f32 v66, v66
    v_exp_f32 v67, v67
    v_exp_f32 v68, v68
    v_exp_f32 v69, v69
    v_mfma_f32_32x32x16_bf16 v[16:31], v[168:171], v[144:147], v[16:31]
    v_exp_f32 v70, v70
    v_exp_f32 v71, v71
    v_exp_f32 v72, v72
    v_exp_f32 v73, v73
    v_mfma_f32_32x32x16_bf16 v[32:47], v[168:171], v[148:151], v[32:47]
    v_exp_f32 v74, v74
    v_exp_f32 v75, v75
    v_exp_f32 v76, v76
    v_exp_f32 v77, v77
    v_smfmac_f32_32x32x32_bf16 v[128:143], v[188:191], v[64:71], v2
    v_exp_f32 v78, v78
    v_exp_f32 v79, v79
    v_exp_f32 v16, v16
    v_exp_f32 v17, v17
    v_smfmac_f32_32x32x32_bf16 v[128:143], v[192:195], v[72:79], v2
    v_exp_f32 v18, v18
    v_exp_f32 v19, v19
    ds_read_b128 v[172:175], v212 offset:26176
    v_exp_f32 v20, v20
    v_mfma_f32_32x32x4bf16_1k v[48:79], v[178:179], v[164:165], 0
    v_exp_f32 v21, v21
    v_exp_f32 v22, v22
    v_exp_f32 v23, v23
    v_exp_f32 v24, v24
    v_exp_f32 v25, v25
    v_exp_f32 v26, v26
    v_exp_f32 v27, v27
    v_exp_f32 v28, v28
    v_smfmac_f32_32x32x32_bf16 v[80:95], v[180:183], v[16:23], v2
    v_exp_f32 v29, v29
    v_exp_f32 v30, v30
    ds_read_b128 v[188:191], v213 offset:27200
    v_exp_f32 v31, v31
    v_exp_f32 v32, v32
    ds_read2st64_b32 v[176:177], v215 offset0:111 offset1:112
    v_exp_f32 v33, v33
    v_smfmac_f32_32x32x32_bf16 v[80:95], v[184:187], v[24:31], v2
    v_exp_f32 v34, v34
    v_exp_f32 v35, v35
    ds_read_b128 v[192:195], v213 offset:27808
    v_exp_f32 v36, v36
    v_exp_f32 v37, v37
    v_mfma_f32_32x32x16_bf16 v[48:63], v[168:171], v[152:155], v[48:63]
    v_exp_f32 v38, v38
    v_exp_f32 v39, v39
    v_exp_f32 v40, v40
    v_exp_f32 v41, v41
    v_mfma_f32_32x32x16_bf16 v[64:79], v[168:171], v[156:159], v[64:79]
    v_exp_f32 v42, v42
    v_exp_f32 v43, v43
    v_exp_f32 v44, v44
    v_exp_f32 v45, v45
    v_smfmac_f32_32x32x32_bf16 v[96:111], v[180:183], v[32:39], v2
    v_exp_f32 v46, v46
    v_exp_f32 v47, v47
    v_exp_f32 v48, v48
    v_exp_f32 v49, v49
    v_smfmac_f32_32x32x32_bf16 v[96:111], v[184:187], v[40:47], v2
    v_exp_f32 v50, v50
    v_exp_f32 v51, v51
    v_exp_f32 v52, v52
    s_waitcnt lgkmcnt(0)
    v_mfma_f32_32x32x4bf16_1k v[16:47], v[178:179], v[162:163], 0
    v_exp_f32 v53, v53
    v_exp_f32 v54, v54
    v_exp_f32 v55, v55
    v_exp_f32 v56, v56
    v_exp_f32 v57, v57
    v_exp_f32 v58, v58
    v_exp_f32 v59, v59
    v_exp_f32 v60, v60
    v_smfmac_f32_32x32x32_bf16 v[112:127], v[180:183], v[48:55], v2
    v_exp_f32 v61, v61
    v_exp_f32 v62, v62
    v_exp_f32 v63, v63
    v_exp_f32 v64, v64
    v_exp_f32 v65, v65
    v_smfmac_f32_32x32x32_bf16 v[112:127], v[184:187], v[56:63], v2
    v_exp_f32 v66, v66
    v_exp_f32 v67, v67
    v_exp_f32 v68, v68
    v_exp_f32 v69, v69
    v_mfma_f32_32x32x16_bf16 v[16:31], v[172:175], v[144:147], v[16:31]
    v_exp_f32 v70, v70
    v_exp_f32 v71, v71
    v_exp_f32 v72, v72
    v_exp_f32 v73, v73
    v_mfma_f32_32x32x16_bf16 v[32:47], v[172:175], v[148:151], v[32:47]
    v_exp_f32 v74, v74
    v_exp_f32 v75, v75
    v_exp_f32 v76, v76
    v_exp_f32 v77, v77
    v_smfmac_f32_32x32x32_bf16 v[128:143], v[180:183], v[64:71], v2
    v_exp_f32 v78, v78
    v_exp_f32 v79, v79
    s_and_b32 s44, s35, 3
    s_mul_i32 s3, s44, 5120
    s_cmp_ge_u32 s35, 4
    s_mov_b32 s45, 55296
    s_cselect_b32 s45, 131072, s45
    s_add_u32 s3, s3, s45
    s_cmp_ge_u32 s35, 4
    s_mov_b32 s45, 151552
    s_cselect_b32 s45, 156672, s45
    s_cmp_eq_u32 s44, 3
    s_cselect_b32 s3, s45, s3
    v_lshl_add_u32 v13, v1, 4, s3
    s_xor_b32 s37, s35, 4
    s_and_b32 s44, s37, 3
    s_mul_i32 s3, s44, 5120
    s_cmp_ge_u32 s37, 4
    s_mov_b32 s45, 55296
    s_cselect_b32 s45, 131072, s45
    s_add_u32 s3, s3, s45
    s_cmp_ge_u32 s37, 4
    s_mov_b32 s45, 151552
    s_cselect_b32 s45, 156672, s45
    s_cmp_eq_u32 s44, 3
    s_cselect_b32 s3, s45, s3
    v_lshl_add_u32 v14, v1, 4, s3
    v_lshl_add_u32 v9, v1, 2, s3
    v_lshlrev_b32 v12, 2, v1
    v_mov_b32 v10, 161792
    v_mov_b32 v11, 0
    ds_write_b32 v10, v11
    s_and_b32 s36, s33, 1
    s_lshl_b32 s36, s36, 1
    s_lshr_b32 s37, s35, 2
    s_add_u32 s36, s36, s37
    s_lshl_b32 s37, s53, 2
    s_add_u32 s36, s36, s37
    s_mul_i32 s36, s36, 36
    s_mul_i32 s37, s34, 9
    s_add_u32 s36, s36, s37
    s_lshl_b32 s36, s36, 10
    s_and_b32 s37, s35, 3
    s_lshl_b32 s61, s37, 8
    s_add_u32 s61, s61, s36
    s_add_u32 s61, s61, 8192
    s_lshl_b32 s37, s37, 11
    s_add_u32 s60, s36, s37
    s_and_b32 s36, s33, 1
    s_lshl_b32 s36, s36, 1
    s_and_b32 s43, s34, 1
    s_lshr_b32 s37, s35, 2
    s_and_b32 s40, s35, 1
    s_xor_b32 s38, s40, s37
    s_xor_b32 s38, s38, s43
    s_xor_b32 s38, s38, 1
    s_add_u32 s38, s38, s36
    s_lshr_b32 s39, s34, 1
    s_xor_b32 s39, s39, s37
    s_xor_b32 s37, s37, s43
    s_lshr_b32 s3, s34, 1
    s_xor_b32 s40, s40, s3
    s_xor_b32 s36, s36, 2
    s_add_u32 s40, s40, s36
    s_bitcmp1_b32 s35, 1
    s_cselect_b32 s38, s40, s38
    s_cselect_b32 s39, s37, s39
    s_and_b32 s3, s35, 6
    s_cmp_eq_u32 s3, 0
    s_cselect_b32 s37, s43, 0
    s_cselect_b32 s51, 1, 0
    s_lshl_b32 s36, s53, 2
    s_add_u32 s36, s36, s38
    s_lshl_b32 s36, s36, 1
    s_add_u32 s36, s36, s39
    s_lshl_b32 s36, s36, 1
    s_xor_b32 s3, s43, 1
    s_and_b32 s3, s3, s51
    s_add_u32 s36, s36, s3
    s_mul_i32 s57, s36, 9216
    s_mul_i32 s36, s39, 75776
    s_mul_i32 s40, s37, 9216
    s_add_u32 s41, s36, 36864
    s_add_u32 s65, s41, s40
    s_sub_u32 s66, s41, s40
    s_add_u32 s66, s66, 9216
    s_lshl_b32 s40, s40, 1
    s_add_u32 s63, s36, s40
    s_sub_u32 s64, s36, s40
    s_add_u32 s64, s64, 18432
    s_lshl_b32 s3, s38, 13
    s_cmp_ge_u32 s38, 2
    s_mov_b32 s36, 55296
    s_cselect_b32 s36, 114688, s36
    s_add_u32 s67, s3, s36
    s_and_b32 s36, s53, 15
    s_lshl_b32 s36, s36, 2
    s_add_u32 s36, s36, s38
    s_mul_i32 s36, s36, 73728
    s_mul_i32 s37, s32, 1152
    s_add_u32 s40, s36, s37
    s_lshr_b32 s36, s34, 1
    s_lshl_b32 s36, s36, 6
    s_add_u32 s41, s40, s36
    s_add_u32 s41, s41, 1024
    s_lshl_b32 s36, s52, 7
    s_add_u32 s40, s40, s36
    s_add_u32 s56, s40, 36864
    s_add_u32 s42, s41, 36864
    s_bitcmp1_b32 s38, 0
    s_mov_b32 s96, 131072
    s_cselect_b32 s96, 55296, s96
    s_mov_b32 s97, 156672
    s_cselect_b32 s97, 151552, s97
    s_lshl_b32 s37, s53, 10
    s_add_u32 s37, s37, 32768
    s_lshl_b32 s36, s52, 7
    s_add_u32 s36, s36, s37
    v_exp_f32 v16, v16
    v_exp_f32 v17, v17
    v_smfmac_f32_32x32x32_bf16 v[128:143], v[184:187], v[72:79], v2
    v_exp_f32 v18, v18
    v_exp_f32 v19, v19
    ds_read_b128 v[168:171], v212 offset:28928
    v_exp_f32 v20, v20
    v_mfma_f32_32x32x4bf16_1k v[48:79], v[178:179], v[166:167], 0
    v_exp_f32 v21, v21
    v_exp_f32 v22, v22
    v_exp_f32 v23, v23
    v_exp_f32 v24, v24
    v_exp_f32 v25, v25
    v_exp_f32 v26, v26
    v_exp_f32 v27, v27
    v_exp_f32 v28, v28
    v_smfmac_f32_32x32x32_bf16 v[80:95], v[188:191], v[16:23], v2
    v_exp_f32 v29, v29
    v_exp_f32 v30, v30
    ds_read_b128 v[180:183], v213 offset:29952
    v_exp_f32 v31, v31
    v_exp_f32 v32, v32
    v_exp_f32 v33, v33
    v_smfmac_f32_32x32x32_bf16 v[80:95], v[192:195], v[24:31], v2
    v_exp_f32 v34, v34
    v_exp_f32 v35, v35
    ds_read_b128 v[184:187], v213 offset:30560
    v_exp_f32 v36, v36
    v_exp_f32 v37, v37
    v_mfma_f32_32x32x16_bf16 v[48:63], v[172:175], v[152:155], v[48:63]
    v_exp_f32 v38, v38
    v_exp_f32 v39, v39
    v_exp_f32 v40, v40
    v_exp_f32 v41, v41
    v_mfma_f32_32x32x16_bf16 v[64:79], v[172:175], v[156:159], v[64:79]
    v_exp_f32 v42, v42
    v_exp_f32 v43, v43
    v_exp_f32 v44, v44
    v_exp_f32 v45, v45
    v_smfmac_f32_32x32x32_bf16 v[96:111], v[188:191], v[32:39], v2
    v_exp_f32 v46, v46
    v_exp_f32 v47, v47
    v_exp_f32 v48, v48
    v_exp_f32 v49, v49
    v_smfmac_f32_32x32x32_bf16 v[96:111], v[192:195], v[40:47], v2
    v_exp_f32 v50, v50
    v_exp_f32 v51, v51
    v_exp_f32 v52, v52
    s_waitcnt lgkmcnt(0)
    v_mfma_f32_32x32x4bf16_1k v[16:47], v[176:177], v[160:161], 0
    v_exp_f32 v53, v53
    v_exp_f32 v54, v54
    v_exp_f32 v55, v55
    v_exp_f32 v56, v56
    v_exp_f32 v57, v57
    v_exp_f32 v58, v58
    v_exp_f32 v59, v59
    v_exp_f32 v60, v60
    v_smfmac_f32_32x32x32_bf16 v[112:127], v[188:191], v[48:55], v2
    v_exp_f32 v61, v61
    v_exp_f32 v62, v62
    v_exp_f32 v63, v63
    v_exp_f32 v64, v64
    v_exp_f32 v65, v65
    v_smfmac_f32_32x32x32_bf16 v[112:127], v[192:195], v[56:63], v2
    v_exp_f32 v66, v66
    v_exp_f32 v67, v67
    v_exp_f32 v68, v68
    v_exp_f32 v69, v69
    v_mfma_f32_32x32x16_bf16 v[16:31], v[168:171], v[144:147], v[16:31]
    v_exp_f32 v70, v70
    v_exp_f32 v71, v71
    v_exp_f32 v72, v72
    v_exp_f32 v73, v73
    v_mfma_f32_32x32x16_bf16 v[32:47], v[168:171], v[148:151], v[32:47]
    v_exp_f32 v74, v74
    v_exp_f32 v75, v75
    v_exp_f32 v76, v76
    v_exp_f32 v77, v77
    v_smfmac_f32_32x32x32_bf16 v[128:143], v[188:191], v[64:71], v2
    v_exp_f32 v78, v78
    v_exp_f32 v79, v79
    v_exp_f32 v16, v16
    v_exp_f32 v17, v17
    v_smfmac_f32_32x32x32_bf16 v[128:143], v[192:195], v[72:79], v2
    v_exp_f32 v18, v18
    v_exp_f32 v19, v19
    ds_read_b128 v[172:175], v212 offset:31168
    v_exp_f32 v20, v20
    v_mfma_f32_32x32x4bf16_1k v[48:79], v[176:177], v[164:165], 0
    v_exp_f32 v21, v21
    v_exp_f32 v22, v22
    v_exp_f32 v23, v23
    v_exp_f32 v24, v24
    v_exp_f32 v25, v25
    v_exp_f32 v26, v26
    v_exp_f32 v27, v27
    v_exp_f32 v28, v28
    v_smfmac_f32_32x32x32_bf16 v[80:95], v[180:183], v[16:23], v2
    v_exp_f32 v29, v29
    v_exp_f32 v30, v30
    ds_read_b128 v[188:191], v213 offset:32192
    v_exp_f32 v31, v31
    v_exp_f32 v32, v32
    ds_read2st64_b32 v[178:179], v216 offset0:111 offset1:112
    v_exp_f32 v33, v33
    v_smfmac_f32_32x32x32_bf16 v[80:95], v[184:187], v[24:31], v2
    v_exp_f32 v34, v34
    v_exp_f32 v35, v35
    ds_read_b128 v[192:195], v213 offset:32800
    v_exp_f32 v36, v36
    v_exp_f32 v37, v37
    v_mfma_f32_32x32x16_bf16 v[48:63], v[168:171], v[152:155], v[48:63]
    v_exp_f32 v38, v38
    v_exp_f32 v39, v39
    v_exp_f32 v40, v40
    v_exp_f32 v41, v41
    v_mfma_f32_32x32x16_bf16 v[64:79], v[168:171], v[156:159], v[64:79]
    v_exp_f32 v42, v42
    v_exp_f32 v43, v43
    v_exp_f32 v44, v44
    v_exp_f32 v45, v45
    v_smfmac_f32_32x32x32_bf16 v[96:111], v[180:183], v[32:39], v2
    v_exp_f32 v46, v46
    v_exp_f32 v47, v47
    v_exp_f32 v48, v48
    v_exp_f32 v49, v49
    v_smfmac_f32_32x32x32_bf16 v[96:111], v[184:187], v[40:47], v2
    v_exp_f32 v50, v50
    v_exp_f32 v51, v51
    v_exp_f32 v52, v52
    s_waitcnt lgkmcnt(0)
    v_mfma_f32_32x32x4bf16_1k v[16:47], v[176:177], v[162:163], 0
    v_exp_f32 v53, v53
    v_exp_f32 v54, v54
    v_exp_f32 v55, v55
    v_exp_f32 v56, v56
    v_exp_f32 v57, v57
    v_exp_f32 v58, v58
    v_exp_f32 v59, v59
    v_exp_f32 v60, v60
    v_smfmac_f32_32x32x32_bf16 v[112:127], v[180:183], v[48:55], v2
    v_exp_f32 v61, v61
    v_exp_f32 v62, v62
    v_exp_f32 v63, v63
    v_exp_f32 v64, v64
    v_exp_f32 v65, v65
    v_smfmac_f32_32x32x32_bf16 v[112:127], v[184:187], v[56:63], v2
    v_exp_f32 v66, v66
    v_exp_f32 v67, v67
    v_exp_f32 v68, v68
    v_exp_f32 v69, v69
    v_mfma_f32_32x32x16_bf16 v[16:31], v[172:175], v[144:147], v[16:31]
    v_exp_f32 v70, v70
    v_exp_f32 v71, v71
    v_exp_f32 v72, v72
    v_exp_f32 v73, v73
    v_mfma_f32_32x32x16_bf16 v[32:47], v[172:175], v[148:151], v[32:47]
    v_exp_f32 v74, v74
    v_exp_f32 v75, v75
    v_exp_f32 v76, v76
    v_exp_f32 v77, v77
    v_smfmac_f32_32x32x32_bf16 v[128:143], v[180:183], v[64:71], v2
    v_exp_f32 v78, v78
    v_exp_f32 v79, v79
    v_exp_f32 v16, v16
    v_exp_f32 v17, v17
    v_smfmac_f32_32x32x32_bf16 v[128:143], v[184:187], v[72:79], v2
    v_exp_f32 v18, v18
    v_exp_f32 v19, v19
    ds_read_b128 v[168:171], v212 offset:33408
    v_exp_f32 v20, v20
    v_mfma_f32_32x32x4bf16_1k v[48:79], v[176:177], v[166:167], 0
    v_exp_f32 v21, v21
    v_exp_f32 v22, v22
    v_exp_f32 v23, v23
    v_exp_f32 v24, v24
    v_exp_f32 v25, v25
    v_exp_f32 v26, v26
    v_exp_f32 v27, v27
    v_exp_f32 v28, v28
    v_smfmac_f32_32x32x32_bf16 v[80:95], v[188:191], v[16:23], v2
    v_exp_f32 v29, v29
    v_exp_f32 v30, v30
    ds_read_b128 v[180:183], v213 offset:34432
    v_exp_f32 v31, v31
    v_exp_f32 v32, v32
    v_exp_f32 v33, v33
    v_smfmac_f32_32x32x32_bf16 v[80:95], v[192:195], v[24:31], v2
    v_exp_f32 v34, v34
    v_exp_f32 v35, v35
    ds_read_b128 v[184:187], v213 offset:35040
    v_exp_f32 v36, v36
    v_exp_f32 v37, v37
    v_mfma_f32_32x32x16_bf16 v[48:63], v[172:175], v[152:155], v[48:63]
    v_exp_f32 v38, v38
    v_exp_f32 v39, v39
    v_exp_f32 v40, v40
    v_exp_f32 v41, v41
    v_mfma_f32_32x32x16_bf16 v[64:79], v[172:175], v[156:159], v[64:79]
    v_exp_f32 v42, v42
    v_exp_f32 v43, v43
    v_exp_f32 v44, v44
    v_exp_f32 v45, v45
    v_smfmac_f32_32x32x32_bf16 v[96:111], v[188:191], v[32:39], v2
    v_exp_f32 v46, v46
    v_exp_f32 v47, v47
    v_exp_f32 v48, v48
    v_exp_f32 v49, v49
    v_smfmac_f32_32x32x32_bf16 v[96:111], v[192:195], v[40:47], v2
    v_exp_f32 v50, v50
    v_exp_f32 v51, v51
    v_exp_f32 v52, v52
    s_waitcnt lgkmcnt(0)
    v_mfma_f32_32x32x4bf16_1k v[16:47], v[178:179], v[160:161], 0
    v_exp_f32 v53, v53
    v_exp_f32 v54, v54
    v_exp_f32 v55, v55
    v_exp_f32 v56, v56
    v_exp_f32 v57, v57
    v_exp_f32 v58, v58
    v_exp_f32 v59, v59
    v_exp_f32 v60, v60
    v_smfmac_f32_32x32x32_bf16 v[112:127], v[188:191], v[48:55], v2
    v_exp_f32 v61, v61
    v_exp_f32 v62, v62
    v_exp_f32 v63, v63
    v_exp_f32 v64, v64
    v_exp_f32 v65, v65
    v_smfmac_f32_32x32x32_bf16 v[112:127], v[192:195], v[56:63], v2
    v_exp_f32 v66, v66
    v_exp_f32 v67, v67
    v_exp_f32 v68, v68
    v_exp_f32 v69, v69
    v_mfma_f32_32x32x16_bf16 v[16:31], v[168:171], v[144:147], v[16:31]
    v_exp_f32 v70, v70
    v_exp_f32 v71, v71
    v_exp_f32 v72, v72
    v_exp_f32 v73, v73
    v_mfma_f32_32x32x16_bf16 v[32:47], v[168:171], v[148:151], v[32:47]
    v_exp_f32 v74, v74
    v_exp_f32 v75, v75
    v_exp_f32 v76, v76
    v_exp_f32 v77, v77
    v_smfmac_f32_32x32x32_bf16 v[128:143], v[188:191], v[64:71], v2
    v_exp_f32 v78, v78
    v_exp_f32 v79, v79
    s_waitcnt vmcnt(0)
    s_barrier
    v_exp_f32 v16, v16
    v_exp_f32 v17, v17
    v_smfmac_f32_32x32x32_bf16 v[128:143], v[192:195], v[72:79], v2
    v_exp_f32 v18, v18
    v_exp_f32 v19, v19
    ds_read_b128 v[172:175], v212 offset:35648
    v_exp_f32 v20, v20
    v_mfma_f32_32x32x4bf16_1k v[48:79], v[178:179], v[164:165], 0
    v_exp_f32 v21, v21
    v_exp_f32 v22, v22
    v_exp_f32 v23, v23
    v_exp_f32 v24, v24
    v_exp_f32 v25, v25
    v_exp_f32 v26, v26
    v_exp_f32 v27, v27
    v_exp_f32 v28, v28
    v_smfmac_f32_32x32x32_bf16 v[80:95], v[180:183], v[16:23], v2
    v_exp_f32 v29, v29
    v_exp_f32 v30, v30
    ds_read_b128 v[188:191], v213 offset:36672
    v_exp_f32 v31, v31
    v_exp_f32 v32, v32
    v_exp_f32 v33, v33
    v_smfmac_f32_32x32x32_bf16 v[80:95], v[184:187], v[24:31], v2
    v_exp_f32 v34, v34
    v_exp_f32 v35, v35
    ds_read_b128 v[192:195], v213 offset:37280
    v_exp_f32 v36, v36
    v_exp_f32 v37, v37
    v_mfma_f32_32x32x16_bf16 v[48:63], v[168:171], v[152:155], v[48:63]
    v_exp_f32 v38, v38
    v_exp_f32 v39, v39
    v_exp_f32 v40, v40
    v_exp_f32 v41, v41
    v_mfma_f32_32x32x16_bf16 v[64:79], v[168:171], v[156:159], v[64:79]
    v_exp_f32 v42, v42
    v_exp_f32 v43, v43
    v_exp_f32 v44, v44
    v_exp_f32 v45, v45
    v_smfmac_f32_32x32x32_bf16 v[96:111], v[180:183], v[32:39], v2
    v_exp_f32 v46, v46
    v_exp_f32 v47, v47
    v_exp_f32 v48, v48
    v_exp_f32 v49, v49
    v_smfmac_f32_32x32x32_bf16 v[96:111], v[184:187], v[40:47], v2
    v_exp_f32 v50, v50
    v_exp_f32 v51, v51
    v_exp_f32 v52, v52
    s_waitcnt lgkmcnt(0)
    v_mfma_f32_32x32x4bf16_1k v[16:47], v[178:179], v[162:163], 0
    v_exp_f32 v53, v53
    v_exp_f32 v54, v54
    v_exp_f32 v55, v55
    v_exp_f32 v56, v56
    v_exp_f32 v57, v57
    v_exp_f32 v58, v58
    v_exp_f32 v59, v59
    v_exp_f32 v60, v60
    v_smfmac_f32_32x32x32_bf16 v[112:127], v[180:183], v[48:55], v2
    v_exp_f32 v61, v61
    v_exp_f32 v62, v62
    v_exp_f32 v63, v63
    v_exp_f32 v64, v64
    v_exp_f32 v65, v65
    v_smfmac_f32_32x32x32_bf16 v[112:127], v[184:187], v[56:63], v2
    v_exp_f32 v66, v66
    v_exp_f32 v67, v67
    v_exp_f32 v68, v68
    v_exp_f32 v69, v69
    v_mfma_f32_32x32x16_bf16 v[16:31], v[172:175], v[144:147], v[16:31]
    v_exp_f32 v70, v70
    v_exp_f32 v71, v71
    v_exp_f32 v72, v72
    v_exp_f32 v73, v73
    v_mfma_f32_32x32x16_bf16 v[32:47], v[172:175], v[148:151], v[32:47]
    v_exp_f32 v74, v74
    v_exp_f32 v75, v75
    v_exp_f32 v76, v76
    v_exp_f32 v77, v77
    v_smfmac_f32_32x32x32_bf16 v[128:143], v[180:183], v[64:71], v2
    v_exp_f32 v78, v78
    v_exp_f32 v79, v79
    v_exp_f32 v16, v16
    v_exp_f32 v17, v17
    v_smfmac_f32_32x32x32_bf16 v[128:143], v[184:187], v[72:79], v2
    v_exp_f32 v18, v18
    v_exp_f32 v19, v19
    v_exp_f32 v20, v20
    v_mfma_f32_32x32x4bf16_1k v[48:79], v[178:179], v[166:167], 0
    v_exp_f32 v21, v21
    v_exp_f32 v22, v22
    v_exp_f32 v23, v23
    v_exp_f32 v24, v24
    v_exp_f32 v25, v25
    v_exp_f32 v26, v26
    v_exp_f32 v27, v27
    v_exp_f32 v28, v28
    v_smfmac_f32_32x32x32_bf16 v[80:95], v[188:191], v[16:23], v2
    v_exp_f32 v29, v29
    v_exp_f32 v30, v30
    v_exp_f32 v31, v31
    v_exp_f32 v32, v32
    v_exp_f32 v33, v33
    v_smfmac_f32_32x32x32_bf16 v[80:95], v[192:195], v[24:31], v2
    v_exp_f32 v34, v34
    v_exp_f32 v35, v35
    v_exp_f32 v36, v36
    v_exp_f32 v37, v37
    v_mfma_f32_32x32x16_bf16 v[48:63], v[172:175], v[152:155], v[48:63]
    v_exp_f32 v38, v38
    v_exp_f32 v39, v39
    v_exp_f32 v40, v40
    v_exp_f32 v41, v41
    v_mfma_f32_32x32x16_bf16 v[64:79], v[172:175], v[156:159], v[64:79]
    v_exp_f32 v42, v42
    v_exp_f32 v43, v43
    v_exp_f32 v44, v44
    v_exp_f32 v45, v45
    v_smfmac_f32_32x32x32_bf16 v[96:111], v[188:191], v[32:39], v2
    v_exp_f32 v46, v46
    v_exp_f32 v47, v47
    ds_write_b128 v13, v[80:83] offset:0
    v_exp_f32 v48, v48
    v_exp_f32 v49, v49
    v_smfmac_f32_32x32x32_bf16 v[96:111], v[192:195], v[40:47], v2
    ds_write_b128 v13, v[84:87] offset:1024
    v_exp_f32 v50, v50
    v_exp_f32 v51, v51
    v_exp_f32 v52, v52
    ds_write_b64 v13, v[88:89] offset:4096
    v_exp_f32 v53, v53
    v_exp_f32 v54, v54
    v_exp_f32 v55, v55
    v_exp_f32 v56, v56
    v_exp_f32 v57, v57
    v_smfmac_f32_32x32x32_bf16 v[112:127], v[188:191], v[48:55], v2
    v_exp_f32 v58, v58
    ds_write_b128 v13, v[96:99] offset:2048
    v_exp_f32 v59, v59
    v_exp_f32 v60, v60
    ds_write_b128 v13, v[100:103] offset:3072
    v_exp_f32 v61, v61
    v_exp_f32 v62, v62
    ds_write_b64 v13, v[104:105] offset:4104
    v_exp_f32 v63, v63
    v_exp_f32 v64, v64
    v_exp_f32 v65, v65
    v_exp_f32 v66, v66
    v_smfmac_f32_32x32x32_bf16 v[112:127], v[192:195], v[56:63], v2
    s_waitcnt lgkmcnt(0)
    s_barrier
    ds_read_b64 v[24:25], v14 offset:4096
    ds_read_b128 v[16:19], v14 offset:0
    ds_read_b128 v[20:23], v14 offset:1024
    ds_read_b64 v[40:41], v14 offset:4104
    ds_read_b128 v[32:35], v14 offset:2048
    ds_read_b128 v[36:39], v14 offset:3072
    v_exp_f32 v67, v67
    v_exp_f32 v68, v68
    v_exp_f32 v69, v69
    v_exp_f32 v70, v70
    v_exp_f32 v71, v71
    v_exp_f32 v72, v72
    v_exp_f32 v73, v73
    v_smfmac_f32_32x32x32_bf16 v[128:143], v[188:191], v[64:71], v2
    v_exp_f32 v74, v74
    v_exp_f32 v75, v75
    v_exp_f32 v76, v76
    v_exp_f32 v77, v77
    v_exp_f32 v78, v78
    v_exp_f32 v79, v79
    s_nop 1
    v_smfmac_f32_32x32x32_bf16 v[128:143], v[192:195], v[72:79], v2
    s_setprio 2
L_con_attD:
    s_waitcnt lgkmcnt(5)
    v_add_f32 v121, v121, v25
    v_add_f32 v120, v120, v24
    v_rcp_f32 v121, v121
    s_waitcnt lgkmcnt(3)
    v_pk_add_f32 v[112:113], v[112:113], v[16:17]
    v_pk_add_f32 v[114:115], v[114:115], v[18:19]
    v_pk_add_f32 v[116:117], v[116:117], v[20:21]
    v_pk_add_f32 v[118:119], v[118:119], v[22:23]
    v_pk_mul_f32 v[112:113], v[112:113], v[120:121] op_sel:[0,1] op_sel_hi:[1,1]
    v_pk_mul_f32 v[114:115], v[114:115], v[120:121] op_sel:[0,1] op_sel_hi:[1,1]
    v_pk_mul_f32 v[116:117], v[116:117], v[120:121] op_sel:[0,1] op_sel_hi:[1,1]
    v_pk_mul_f32 v[118:119], v[118:119], v[120:121] op_sel:[0,1] op_sel_hi:[1,1]
    v_mul_f32 v120, v120, v121
    v_cvt_pk_bf16_f32 v48, v112, v113
    v_cvt_pk_bf16_f32 v49, v114, v115
    v_cvt_pk_bf16_f32 v50, v116, v117
    v_cvt_pk_bf16_f32 v51, v118, v119
    buffer_store_dwordx4 v[48:51], v15, s[20:23], s60 offen offset:0 sc1
    s_waitcnt lgkmcnt(2)
    v_add_f32 v137, v137, v41
    v_add_f32 v136, v136, v40
    v_rcp_f32 v137, v137
    s_waitcnt lgkmcnt(0)
    v_pk_add_f32 v[128:129], v[128:129], v[32:33]
    v_pk_add_f32 v[130:131], v[130:131], v[34:35]
    v_pk_add_f32 v[132:133], v[132:133], v[36:37]
    v_pk_add_f32 v[134:135], v[134:135], v[38:39]
    v_pk_mul_f32 v[128:129], v[128:129], v[136:137] op_sel:[0,1] op_sel_hi:[1,1]
    v_pk_mul_f32 v[130:131], v[130:131], v[136:137] op_sel:[0,1] op_sel_hi:[1,1]
    v_pk_mul_f32 v[132:133], v[132:133], v[136:137] op_sel:[0,1] op_sel_hi:[1,1]
    v_pk_mul_f32 v[134:135], v[134:135], v[136:137] op_sel:[0,1] op_sel_hi:[1,1]
    v_mul_f32 v136, v136, v137
    v_cvt_pk_bf16_f32 v52, v128, v129
    v_cvt_pk_bf16_f32 v53, v130, v131
    v_cvt_pk_bf16_f32 v54, v132, v133
    v_cvt_pk_bf16_f32 v55, v134, v135
    buffer_store_dwordx4 v[52:55], v15, s[20:23], s60 offen offset:1024 sc1
    v_cvt_pk_bf16_f32 v56, v120, v136
    buffer_store_dword v56, v12, s[20:23], s61 offen sc1
    s_setprio 0
    ds_write_b128 v14, v[48:51]
    ds_write_b128 v14, v[52:55] offset:1024
    ds_write_b32 v9, v56 offset:2048
    v_minimum3_f32 v11, v121, v137, v137
    v_maximum3_f32 v12, v121, v137, v137
    v_maximum3_f32 v13, abs(v112), abs(v113), abs(v114)
    v_cmp_nle_f32 vcc, 0x21800000, v11
    v_maximum3_f32 v13, abs(v115), abs(v116), v13
    s_mov_b64 s[48:49], vcc
    v_cmp_nge_f32 vcc, 0x5d800000, v12
    v_maximum3_f32 v13, abs(v117), abs(v118), v13
    s_or_b64 s[48:49], s[48:49], vcc
    v_maximum3_f32 v13, abs(v119), abs(v120), v13
    v_maximum3_f32 v13, abs(v128), abs(v129), v13
    v_maximum3_f32 v13, abs(v130), abs(v131), v13
    v_maximum3_f32 v13, abs(v132), abs(v133), v13
    v_maximum3_f32 v13, abs(v134), abs(v135), v13
    v_maximum3_f32 v13, abs(v136), abs(v136), v13
    v_cmp_nge_f32 vcc, 0x7f7fffff, v13
    v_mov_b32 v11, 1
    s_or_b64 vcc, vcc, s[48:49]
    s_cmp_eq_u64 vcc, 0
    s_cbranch_scc1 L_con_safe
    ds_write_b32 v10, v11
L_con_safe:
L_con_fin:
    v_lshlrev_b32 v5, 2, v1
    v_lshrrev_b32 v6, 5, v1
    v_bfe_u32 v7, v1, 4, 1
    v_bfe_u32 v8, v1, 2, 2
    v_and_b32 v11, 1, v1
    v_bfe_u32 v12, v1, 1, 1
    v_lshlrev_b32 v12, 3, v12
    v_lshl_add_u32 v14, v11, 4, v12
    v_lshl_add_u32 v14, v7, 6, v14
    v_lshl_add_u32 v11, v11, 5, v12
    v_lshl_add_u32 v11, v7, 4, v11
    v_lshl_add_u32 v12, v6, 3, v8
    v_lshl_add_u32 v13, v12, 6, v11
    v_add_u32 v4, s65, v13
    v_add_u32 v202, s66, v13
    v_lshl_add_u32 v13, v12, 7, v14
    v_lshrrev_b32 v12, 1, v8
    v_lshl_add_u32 v14, v12, 5, v13
    v_xor_b32 v13, 32, v14
    v_add_u32 v2, s63, v14
    v_add_u32 v3, s63, v13
    v_add_u32 v200, s64, v14
    v_add_u32 v201, s64, v13
    s_cmp_eq_u32 s35, 4
    s_cbranch_scc1 L_con_op100
    s_cmp_eq_u32 s35, 0
    s_cbranch_scc1 L_con_op011
    s_cmp_eq_u32 s35, 1
    s_cbranch_scc1 L_con_op111
    s_and_b32 s3, s35, 6
    s_cmp_eq_u32 s3, 2
    s_cbranch_scc1 L_con_op001
L_con_op000:
    ds_read_b64_tr_b16 v[88:89], v2 offset:0
    ds_read_b64_tr_b16 v[90:91], v2 offset:512
    ds_read_b64_tr_b16 v[92:93], v3 offset:0
    ds_read_b64_tr_b16 v[94:95], v3 offset:512
    ds_read_b64_tr_b16 v[96:97], v2 offset:2048
    ds_read_b64_tr_b16 v[98:99], v2 offset:2560
    ds_read_b64_tr_b16 v[100:101], v3 offset:2048
    ds_read_b64_tr_b16 v[102:103], v3 offset:2560
    s_waitcnt lgkmcnt(4)
    ds_read_b64_tr_b16 v[104:105], v2 offset:4096
    ds_read_b64_tr_b16 v[106:107], v2 offset:4608
    ds_read_b64_tr_b16 v[108:109], v3 offset:4096
    ds_read_b64_tr_b16 v[110:111], v3 offset:4608
    s_waitcnt lgkmcnt(4)
    ds_read_b64_tr_b16 v[112:113], v2 offset:6144
    ds_read_b64_tr_b16 v[114:115], v2 offset:6656
    ds_read_b64_tr_b16 v[116:117], v3 offset:6144
    ds_read_b64_tr_b16 v[118:119], v3 offset:6656
    s_waitcnt vmcnt(0) lgkmcnt(0)
    s_barrier
    ds_read_b32 v10, v10
    s_waitcnt lgkmcnt(0)
    v_readfirstlane_b32 s3, v10
    s_nop 0
    s_cmp_lg_u32 s3, 0
    s_cbranch_scc1 L_con_fallback
    s_waitcnt lgkmcnt(4)
    ds_read_b64_tr_b16 v[120:121], v2 offset:8192
    ds_read_b64_tr_b16 v[122:123], v2 offset:8704
    ds_read_b64_tr_b16 v[124:125], v3 offset:8192
    ds_read_b64_tr_b16 v[126:127], v3 offset:8704
    s_waitcnt lgkmcnt(4)
    ds_read_b64_tr_b16 v[128:129], v2 offset:10240
    ds_read_b64_tr_b16 v[130:131], v2 offset:10752
    ds_read_b64_tr_b16 v[132:133], v3 offset:10240
    ds_read_b64_tr_b16 v[134:135], v3 offset:10752
    s_waitcnt lgkmcnt(4)
    ds_read_b64_tr_b16 v[136:137], v2 offset:12288
    ds_read_b64_tr_b16 v[138:139], v2 offset:12800
    ds_read_b64_tr_b16 v[140:141], v3 offset:12288
    ds_read_b64_tr_b16 v[142:143], v3 offset:12800
    s_waitcnt lgkmcnt(4)
    ds_read_b64_tr_b16 v[144:145], v2 offset:14336
    ds_read_b64_tr_b16 v[146:147], v2 offset:14848
    ds_read_b64_tr_b16 v[148:149], v3 offset:14336
    ds_read_b64_tr_b16 v[150:151], v3 offset:14848
    s_waitcnt lgkmcnt(4)
    ds_read_b64_tr_b16 v[152:153], v2 offset:16384
    ds_read_b64_tr_b16 v[154:155], v2 offset:16896
    ds_read_b64_tr_b16 v[156:157], v3 offset:16384
    ds_read_b64_tr_b16 v[158:159], v3 offset:16896
    s_waitcnt lgkmcnt(4)
    ds_read_b64_tr_b16 v[160:161], v200 offset:0
    ds_read_b64_tr_b16 v[162:163], v200 offset:512
    ds_read_b64_tr_b16 v[164:165], v201 offset:0
    ds_read_b64_tr_b16 v[166:167], v201 offset:512
    s_waitcnt lgkmcnt(4)
    ds_read_b64_tr_b16 v[168:169], v200 offset:2048
    ds_read_b64_tr_b16 v[170:171], v200 offset:2560
    ds_read_b64_tr_b16 v[172:173], v201 offset:2048
    ds_read_b64_tr_b16 v[174:175], v201 offset:2560
    s_waitcnt lgkmcnt(4)
    ds_read_b64_tr_b16 v[176:177], v200 offset:4096
    ds_read_b64_tr_b16 v[178:179], v200 offset:4608
    ds_read_b64_tr_b16 v[180:181], v201 offset:4096
    ds_read_b64_tr_b16 v[182:183], v201 offset:4608
    s_waitcnt lgkmcnt(4)
    ds_read_b64_tr_b16 v[184:185], v200 offset:6144
    ds_read_b64_tr_b16 v[186:187], v200 offset:6656
    ds_read_b64_tr_b16 v[188:189], v201 offset:6144
    ds_read_b64_tr_b16 v[190:191], v201 offset:6656
    s_waitcnt lgkmcnt(4)
    ds_read_b64_tr_b16 v[192:193], v200 offset:8192
    ds_read_b64_tr_b16 v[194:195], v200 offset:8704
    ds_read_b64_tr_b16 v[196:197], v201 offset:8192
    ds_read_b64_tr_b16 v[198:199], v201 offset:8704
    s_setprio 0
    s_barrier
    buffer_load_dwordx4 v[16:19], v15, s[20:23], s57 offen offset:0 sc1
    buffer_load_dwordx4 v[20:23], v15, s[20:23], s57 offen offset:1024 sc1
    buffer_load_dwordx4 v[24:27], v15, s[20:23], s57 offen offset:2048 sc1
    buffer_load_dwordx4 v[28:31], v15, s[20:23], s57 offen offset:3072 sc1
    s_add_u32 s57, s57, 4096
    buffer_load_dwordx4 v[32:35], v15, s[20:23], s57 offen offset:0 sc1
    v_add_u32 v13, s67, v15
    v_and_b32 v14, 15, v1
    v_mul_u32_u24 v14, 0x900, v14
    v_lshrrev_b32 v9, 5, v1
    v_bfe_u32 v12, v1, 4, 1
    v_and_b32 v14, 7, v1
    v_mul_u32_u24 v14, 0x900, v14
    v_lshl_add_u32 v9, v9, 4, v14
    v_lshl_add_u32 v12, v12, 5, v9
    v_bfe_u32 v9, v1, 3, 1
    v_lshl_add_u32 v12, v9, 6, v12
    s_waitcnt vmcnt(4) lgkmcnt(12)
    v_mfma_f32_32x32x16_bf16 v[208:223], v[88:91], v[16:19], 0
    v_mfma_f32_32x32x16_bf16 v[224:239], v[92:95], v[16:19], 0
    buffer_load_dwordx4 v[36:39], v15, s[20:23], s57 offen offset:1024 sc1
    s_waitcnt lgkmcnt(4)
    ds_read_b64_tr_b16 v[88:89], v200 offset:10240
    ds_read_b64_tr_b16 v[90:91], v200 offset:10752
    ds_read_b64_tr_b16 v[92:93], v201 offset:10240
    ds_read_b64_tr_b16 v[94:95], v201 offset:10752
    s_waitcnt vmcnt(4) lgkmcnt(12)
    v_mfma_f32_32x32x16_bf16 v[208:223], v[96:99], v[20:23], v[208:223]
    v_mfma_f32_32x32x16_bf16 v[224:239], v[100:103], v[20:23], v[224:239]
    buffer_load_dwordx4 v[40:43], v15, s[20:23], s57 offen offset:2048 sc1
    s_waitcnt lgkmcnt(4)
    ds_read_b64_tr_b16 v[96:97], v200 offset:12288
    ds_read_b64_tr_b16 v[98:99], v200 offset:12800
    ds_read_b64_tr_b16 v[100:101], v201 offset:12288
    ds_read_b64_tr_b16 v[102:103], v201 offset:12800
    s_waitcnt vmcnt(4) lgkmcnt(12)
    v_mfma_f32_32x32x16_bf16 v[208:223], v[104:107], v[24:27], v[208:223]
    v_mfma_f32_32x32x16_bf16 v[224:239], v[108:111], v[24:27], v[224:239]
    buffer_load_dwordx4 v[44:47], v15, s[20:23], s57 offen offset:3072 sc1
    s_add_u32 s57, s57, 4096
    s_waitcnt lgkmcnt(4)
    ds_read_b64_tr_b16 v[104:105], v200 offset:14336
    ds_read_b64_tr_b16 v[106:107], v200 offset:14848
    ds_read_b64_tr_b16 v[108:109], v201 offset:14336
    ds_read_b64_tr_b16 v[110:111], v201 offset:14848
    s_waitcnt vmcnt(4) lgkmcnt(12)
    v_mfma_f32_32x32x16_bf16 v[208:223], v[112:115], v[28:31], v[208:223]
    v_mfma_f32_32x32x16_bf16 v[224:239], v[116:119], v[28:31], v[224:239]
    buffer_load_dword v48, v5, s[20:23], s57 offen offset:0 sc1
    buffer_load_dword v49, v5, s[20:23], s57 offen offset:256 sc1
    buffer_load_dword v50, v5, s[20:23], s57 offen offset:512 sc1
    buffer_load_dword v51, v5, s[20:23], s57 offen offset:768 sc1
    s_waitcnt lgkmcnt(4)
    ds_read_b64_tr_b16 v[112:113], v200 offset:16384
    ds_read_b64_tr_b16 v[114:115], v200 offset:16896
    ds_read_b64_tr_b16 v[116:117], v201 offset:16384
    ds_read_b64_tr_b16 v[118:119], v201 offset:16896
    s_waitcnt vmcnt(7) lgkmcnt(12)
    v_mfma_f32_32x32x16_bf16 v[208:223], v[120:123], v[32:35], v[208:223]
    v_mfma_f32_32x32x16_bf16 v[224:239], v[124:127], v[32:35], v[224:239]
    buffer_load_dwordx4 v[52:55], v15, s[20:23], s57 offen offset:1024 sc1
    s_waitcnt vmcnt(7) lgkmcnt(12)
    v_mfma_f32_32x32x16_bf16 v[208:223], v[128:131], v[36:39], v[208:223]
    v_mfma_f32_32x32x16_bf16 v[224:239], v[132:135], v[36:39], v[224:239]
    buffer_load_dwordx4 v[56:59], v15, s[20:23], s57 offen offset:2048 sc1
    s_waitcnt vmcnt(7) lgkmcnt(12)
    v_mfma_f32_32x32x16_bf16 v[208:223], v[136:139], v[40:43], v[208:223]
    v_mfma_f32_32x32x16_bf16 v[224:239], v[140:143], v[40:43], v[224:239]
    buffer_load_dwordx4 v[60:63], v15, s[20:23], s57 offen offset:3072 sc1
    s_add_u32 s57, s57, 4096
    s_waitcnt vmcnt(7) lgkmcnt(12)
    v_mfma_f32_32x32x16_bf16 v[208:223], v[144:147], v[44:47], v[208:223]
    v_mfma_f32_32x32x16_bf16 v[224:239], v[148:151], v[44:47], v[224:239]
    buffer_load_dwordx4 v[64:67], v15, s[20:23], s57 offen offset:0 sc1
    s_waitcnt vmcnt(4) lgkmcnt(12)
    v_mfma_f32_32x32x16_bf16 v[208:223], v[152:155], v[48:51], v[208:223]
    v_mfma_f32_32x32x16_bf16 v[224:239], v[156:159], v[48:51], v[224:239]
    buffer_load_dwordx4 v[68:71], v15, s[20:23], s57 offen offset:1024 sc1
    s_waitcnt vmcnt(4) lgkmcnt(12)
    v_mfma_f32_32x32x16_bf16 v[208:223], v[160:163], v[52:55], v[208:223]
    v_mfma_f32_32x32x16_bf16 v[224:239], v[164:167], v[52:55], v[224:239]
    buffer_load_dwordx4 v[72:75], v15, s[20:23], s57 offen offset:2048 sc1
    s_waitcnt vmcnt(4) lgkmcnt(12)
    v_mfma_f32_32x32x16_bf16 v[208:223], v[168:171], v[56:59], v[208:223]
    v_mfma_f32_32x32x16_bf16 v[224:239], v[172:175], v[56:59], v[224:239]
    buffer_load_dwordx4 v[76:79], v15, s[20:23], s57 offen offset:3072 sc1
    s_add_u32 s57, s57, 4096
    s_waitcnt vmcnt(4) lgkmcnt(12)
    v_mfma_f32_32x32x16_bf16 v[208:223], v[176:179], v[60:63], v[208:223]
    v_mfma_f32_32x32x16_bf16 v[224:239], v[180:183], v[60:63], v[224:239]
    buffer_load_dwordx4 v[80:83], v15, s[20:23], s57 offen offset:0 sc1
    s_waitcnt vmcnt(4) lgkmcnt(12)
    v_mfma_f32_32x32x16_bf16 v[208:223], v[184:187], v[64:67], v[208:223]
    v_mfma_f32_32x32x16_bf16 v[224:239], v[188:191], v[64:67], v[224:239]
    buffer_load_dword v84, v5, s[20:23], s57 offen offset:1024 sc1
    buffer_load_dword v85, v5, s[20:23], s57 offen offset:1280 sc1
    buffer_load_dword v86, v5, s[20:23], s57 offen offset:1536 sc1
    buffer_load_dword v87, v5, s[20:23], s57 offen offset:1792 sc1
    s_waitcnt vmcnt(7) lgkmcnt(12)
    v_mfma_f32_32x32x16_bf16 v[208:223], v[192:195], v[68:71], v[208:223]
    v_mfma_f32_32x32x16_bf16 v[224:239], v[196:199], v[68:71], v[224:239]
    s_waitcnt vmcnt(6) lgkmcnt(12)
    v_mfma_f32_32x32x16_bf16 v[208:223], v[88:91], v[72:75], v[208:223]
    v_mfma_f32_32x32x16_bf16 v[224:239], v[92:95], v[72:75], v[224:239]
    s_waitcnt vmcnt(5) lgkmcnt(8)
    v_mfma_f32_32x32x16_bf16 v[208:223], v[96:99], v[76:79], v[208:223]
    v_mfma_f32_32x32x16_bf16 v[224:239], v[100:103], v[76:79], v[224:239]
    s_barrier
    ds_read_b128 v[16:19], v13 offset:0
    ds_read_b128 v[20:23], v13 offset:1024
    ds_read_b128 v[24:27], v13 offset:2048
    ds_read_b128 v[28:31], v13 offset:3072
    ds_read_b128 v[32:35], v13 offset:4096
    ds_read_b128 v[36:39], v13 offset:5120
    ds_read_b128 v[40:43], v13 offset:6144
    ds_read_b128 v[44:47], v13 offset:7168
    s_waitcnt vmcnt(4) lgkmcnt(8)
    v_mfma_f32_32x32x16_bf16 v[208:223], v[104:107], v[80:83], v[208:223]
    v_mfma_f32_32x32x16_bf16 v[224:239], v[108:111], v[80:83], v[224:239]
    s_waitcnt vmcnt(0) lgkmcnt(8)
    v_mfma_f32_32x32x16_bf16 v[208:223], v[112:115], v[84:87], v[208:223]
    v_mfma_f32_32x32x16_bf16 v[224:239], v[116:119], v[84:87], v[224:239]
    s_waitcnt lgkmcnt(0)
    s_setprio 2
    s_nop 7
    s_nop 0
    v_pk_add_f32 v[208:209], v[208:209], v[16:17]
    v_pk_add_f32 v[210:211], v[210:211], v[18:19]
    v_pk_add_f32 v[212:213], v[212:213], v[20:21]
    v_pk_add_f32 v[214:215], v[214:215], v[22:23]
    v_pk_add_f32 v[216:217], v[216:217], v[24:25]
    v_pk_add_f32 v[218:219], v[218:219], v[26:27]
    v_pk_add_f32 v[220:221], v[220:221], v[28:29]
    v_pk_add_f32 v[222:223], v[222:223], v[30:31]
    v_cvt_pk_bf16_f32 v88, v208, v209
    v_cvt_pk_bf16_f32 v89, v210, v211
    v_cvt_pk_bf16_f32 v90, v212, v213
    v_cvt_pk_bf16_f32 v91, v214, v215
    v_cvt_pk_bf16_f32 v92, v216, v217
    v_cvt_pk_bf16_f32 v93, v218, v219
    v_cvt_pk_bf16_f32 v94, v220, v221
    v_cvt_pk_bf16_f32 v95, v222, v223
    v_pk_add_f32 v[224:225], v[224:225], v[32:33]
    v_pk_add_f32 v[226:227], v[226:227], v[34:35]
    v_pk_add_f32 v[228:229], v[228:229], v[36:37]
    v_pk_add_f32 v[230:231], v[230:231], v[38:39]
    v_pk_add_f32 v[232:233], v[232:233], v[40:41]
    v_pk_add_f32 v[234:235], v[234:235], v[42:43]
    v_pk_add_f32 v[236:237], v[236:237], v[44:45]
    v_pk_add_f32 v[238:239], v[238:239], v[46:47]
    v_cvt_pk_bf16_f32 v96, v224, v225
    v_cvt_pk_bf16_f32 v97, v226, v227
    v_cvt_pk_bf16_f32 v98, v228, v229
    v_cvt_pk_bf16_f32 v99, v230, v231
    v_cvt_pk_bf16_f32 v100, v232, v233
    v_cvt_pk_bf16_f32 v101, v234, v235
    v_cvt_pk_bf16_f32 v102, v236, v237
    v_cvt_pk_bf16_f32 v103, v238, v239
    s_add_u32 s36, s40, 18432
    s_add_u32 s37, s56, 18432
    v_permlane16_swap_b32 v88, v96
    v_permlane16_swap_b32 v89, v97
    v_permlane16_swap_b32 v90, v98
    v_permlane16_swap_b32 v91, v99
    v_permlane16_swap_b32 v92, v100
    v_permlane16_swap_b32 v93, v101
    v_permlane16_swap_b32 v94, v102
    v_permlane16_swap_b32 v95, v103
    v_mov_b32 v104, v88
    v_mov_b32 v105, v89
    v_mov_b32 v106, v90
    v_mov_b32 v107, v91
    v_mov_b32_dpp v88, v92 row_ror:8 row_mask:0xf bank_mask:0xc
    v_mov_b32_dpp v89, v93 row_ror:8 row_mask:0xf bank_mask:0xc
    v_mov_b32_dpp v90, v94 row_ror:8 row_mask:0xf bank_mask:0xc
    v_mov_b32_dpp v91, v95 row_ror:8 row_mask:0xf bank_mask:0xc
    buffer_store_dwordx4 v[88:91], v12, s[24:27], s40 offen sc0 sc1
    v_mov_b32_dpp v92, v104 row_ror:8 row_mask:0xf bank_mask:0x3
    v_mov_b32_dpp v93, v105 row_ror:8 row_mask:0xf bank_mask:0x3
    v_mov_b32_dpp v94, v106 row_ror:8 row_mask:0xf bank_mask:0x3
    v_mov_b32_dpp v95, v107 row_ror:8 row_mask:0xf bank_mask:0x3
    buffer_store_dwordx4 v[92:95], v12, s[24:27], s36 offen sc0 sc1
    v_mov_b32 v108, v96
    v_mov_b32 v109, v97
    v_mov_b32 v110, v98
    v_mov_b32 v111, v99
    v_mov_b32_dpp v96, v100 row_ror:8 row_mask:0xf bank_mask:0xc
    v_mov_b32_dpp v97, v101 row_ror:8 row_mask:0xf bank_mask:0xc
    v_mov_b32_dpp v98, v102 row_ror:8 row_mask:0xf bank_mask:0xc
    v_mov_b32_dpp v99, v103 row_ror:8 row_mask:0xf bank_mask:0xc
    buffer_store_dwordx4 v[96:99], v12, s[24:27], s56 offen sc0 sc1
    v_mov_b32_dpp v100, v108 row_ror:8 row_mask:0xf bank_mask:0x3
    v_mov_b32_dpp v101, v109 row_ror:8 row_mask:0xf bank_mask:0x3
    v_mov_b32_dpp v102, v110 row_ror:8 row_mask:0xf bank_mask:0x3
    v_mov_b32_dpp v103, v111 row_ror:8 row_mask:0xf bank_mask:0x3
    buffer_store_dwordx4 v[100:103], v12, s[24:27], s37 offen sc0 sc1
    s_endpgm
L_con_op001:
    ds_read_b64_tr_b16 v[88:89], v2 offset:0
    ds_read_b64_tr_b16 v[90:91], v2 offset:512
    ds_read_b64_tr_b16 v[92:93], v3 offset:0
    ds_read_b64_tr_b16 v[94:95], v3 offset:512
    ds_read_b64_tr_b16 v[96:97], v2 offset:2048
    ds_read_b64_tr_b16 v[98:99], v2 offset:2560
    ds_read_b64_tr_b16 v[100:101], v3 offset:2048
    ds_read_b64_tr_b16 v[102:103], v3 offset:2560
    s_waitcnt lgkmcnt(4)
    ds_read_b64_tr_b16 v[104:105], v2 offset:4096
    ds_read_b64_tr_b16 v[106:107], v2 offset:4608
    ds_read_b64_tr_b16 v[108:109], v3 offset:4096
    ds_read_b64_tr_b16 v[110:111], v3 offset:4608
    s_waitcnt lgkmcnt(4)
    ds_read_b64_tr_b16 v[112:113], v2 offset:6144
    ds_read_b64_tr_b16 v[114:115], v2 offset:6656
    ds_read_b64_tr_b16 v[116:117], v3 offset:6144
    ds_read_b64_tr_b16 v[118:119], v3 offset:6656
    v_lshlrev_b32 v203, 7, v1
    v_mov_b32 v204, s74
    s_waitcnt vmcnt(0) lgkmcnt(0)
    s_barrier
    ds_read_b32 v10, v10
    s_waitcnt lgkmcnt(0)
    v_readfirstlane_b32 s3, v10
    s_nop 0
    s_cmp_lg_u32 s3, 0
    s_cbranch_scc1 L_con_fallback
    s_cmp_eq_u32 s35, 3
    s_cbranch_scc0 L_con_noof
    s_mov_b32 exec_lo, 1
    s_mov_b32 exec_hi, 0
    buffer_store_dword v204, v203, s[28:31], s36 offen sc1
    s_mov_b64 exec, -1
L_con_noof:
    s_cmp_eq_u32 s35, 2
    s_cbranch_scc0 L_con_onp
    s_waitcnt lgkmcnt(4)
    ds_read_b64_tr_b16 v[120:121], v2 offset:8192
    ds_read_b64_tr_b16 v[122:123], v2 offset:8704
    ds_read_b64_tr_b16 v[124:125], v3 offset:8192
    ds_read_b64_tr_b16 v[126:127], v3 offset:8704
    s_waitcnt lgkmcnt(4)
    ds_read_b64_tr_b16 v[128:129], v2 offset:10240
    ds_read_b64_tr_b16 v[130:131], v2 offset:10752
    ds_read_b64_tr_b16 v[132:133], v3 offset:10240
    ds_read_b64_tr_b16 v[134:135], v3 offset:10752
    s_waitcnt lgkmcnt(4)
    ds_read_b64_tr_b16 v[136:137], v2 offset:12288
    ds_read_b64_tr_b16 v[138:139], v2 offset:12800
    ds_read_b64_tr_b16 v[140:141], v3 offset:12288
    ds_read_b64_tr_b16 v[142:143], v3 offset:12800
    s_mov_b32 exec_lo, 0xff
    s_mov_b32 exec_hi, 0
    buffer_load_dword v204, v203, s[28:31], s37 offen sc1
    s_mov_b64 exec, -1
    s_waitcnt lgkmcnt(4)
    ds_read_b64_tr_b16 v[144:145], v2 offset:14336
    ds_read_b64_tr_b16 v[146:147], v2 offset:14848
    ds_read_b64_tr_b16 v[148:149], v3 offset:14336
    ds_read_b64_tr_b16 v[150:151], v3 offset:14848
    s_waitcnt lgkmcnt(4)
    ds_read_b64_tr_b16 v[152:153], v2 offset:16384
    ds_read_b64_tr_b16 v[154:155], v2 offset:16896
    ds_read_b64_tr_b16 v[156:157], v3 offset:16384
    ds_read_b64_tr_b16 v[158:159], v3 offset:16896
    s_waitcnt lgkmcnt(4)
    ds_read_b64_tr_b16 v[160:161], v200 offset:0
    ds_read_b64_tr_b16 v[162:163], v200 offset:512
    ds_read_b64_tr_b16 v[164:165], v201 offset:0
    ds_read_b64_tr_b16 v[166:167], v201 offset:512
    s_mov_b32 exec_lo, 0xff
    s_mov_b32 exec_hi, 0
    buffer_load_dword v205, v203, s[28:31], s37 offen sc1
    s_mov_b64 exec, -1
    s_waitcnt lgkmcnt(4)
    ds_read_b64_tr_b16 v[168:169], v200 offset:2048
    ds_read_b64_tr_b16 v[170:171], v200 offset:2560
    ds_read_b64_tr_b16 v[172:173], v201 offset:2048
    ds_read_b64_tr_b16 v[174:175], v201 offset:2560
    s_waitcnt lgkmcnt(4)
    ds_read_b64_tr_b16 v[176:177], v200 offset:4096
    ds_read_b64_tr_b16 v[178:179], v200 offset:4608
    ds_read_b64_tr_b16 v[180:181], v201 offset:4096
    ds_read_b64_tr_b16 v[182:183], v201 offset:4608
    s_waitcnt lgkmcnt(4)
    ds_read_b64_tr_b16 v[184:185], v200 offset:6144
    ds_read_b64_tr_b16 v[186:187], v200 offset:6656
    ds_read_b64_tr_b16 v[188:189], v201 offset:6144
    ds_read_b64_tr_b16 v[190:191], v201 offset:6656
    s_waitcnt lgkmcnt(4)
    ds_read_b64_tr_b16 v[192:193], v200 offset:8192
    ds_read_b64_tr_b16 v[194:195], v200 offset:8704
    ds_read_b64_tr_b16 v[196:197], v201 offset:8192
    ds_read_b64_tr_b16 v[198:199], v201 offset:8704
    s_mov_b32 exec_lo, 0xff
    s_mov_b32 exec_hi, 0
    buffer_load_dword v206, v203, s[28:31], s37 offen sc1
    s_mov_b64 exec, -1
    s_mov_b32 s50, 0
    s_mov_b32 exec_lo, 0xff
    s_mov_b32 exec_hi, 0
L_con_pollo:
    s_waitcnt vmcnt(2)
    v_cmp_ne_u32 vcc, s74, v204
    s_add_u32 s50, s50, 1
    s_cmp_eq_u64 vcc, 0
    s_cbranch_scc1 L_con_polldo
    buffer_load_dword v204, v203, s[28:31], s37 offen sc1
    s_waitcnt vmcnt(2)
    v_cmp_ne_u32 vcc, s74, v205
    s_add_u32 s50, s50, 1
    s_cmp_eq_u64 vcc, 0
    s_cbranch_scc1 L_con_polldo
    buffer_load_dword v205, v203, s[28:31], s37 offen sc1
    s_waitcnt vmcnt(2)
    v_cmp_ne_u32 vcc, s74, v206
    s_add_u32 s50, s50, 1
    s_cmp_eq_u64 vcc, 0
    s_cbranch_scc1 L_con_polldo
    buffer_load_dword v206, v203, s[28:31], s37 offen sc1
    s_cmp_lt_u32 s50, 1048576
    s_cbranch_scc1 L_con_pollo
L_con_polldo:
    s_mov_b64 exec, -1
    s_branch L_con_oseen
L_con_onp:
    s_waitcnt lgkmcnt(4)
    ds_read_b64_tr_b16 v[120:121], v2 offset:8192
    ds_read_b64_tr_b16 v[122:123], v2 offset:8704
    ds_read_b64_tr_b16 v[124:125], v3 offset:8192
    ds_read_b64_tr_b16 v[126:127], v3 offset:8704
    s_waitcnt lgkmcnt(4)
    ds_read_b64_tr_b16 v[128:129], v2 offset:10240
    ds_read_b64_tr_b16 v[130:131], v2 offset:10752
    ds_read_b64_tr_b16 v[132:133], v3 offset:10240
    ds_read_b64_tr_b16 v[134:135], v3 offset:10752
    s_waitcnt lgkmcnt(4)
    ds_read_b64_tr_b16 v[136:137], v2 offset:12288
    ds_read_b64_tr_b16 v[138:139], v2 offset:12800
    ds_read_b64_tr_b16 v[140:141], v3 offset:12288
    ds_read_b64_tr_b16 v[142:143], v3 offset:12800
    s_waitcnt lgkmcnt(4)
    ds_read_b64_tr_b16 v[144:145], v2 offset:14336
    ds_read_b64_tr_b16 v[146:147], v2 offset:14848
    ds_read_b64_tr_b16 v[148:149], v3 offset:14336
    ds_read_b64_tr_b16 v[150:151], v3 offset:14848
    s_waitcnt lgkmcnt(4)
    ds_read_b64_tr_b16 v[152:153], v2 offset:16384
    ds_read_b64_tr_b16 v[154:155], v2 offset:16896
    ds_read_b64_tr_b16 v[156:157], v3 offset:16384
    ds_read_b64_tr_b16 v[158:159], v3 offset:16896
    s_waitcnt lgkmcnt(4)
    ds_read_b64_tr_b16 v[160:161], v200 offset:0
    ds_read_b64_tr_b16 v[162:163], v200 offset:512
    ds_read_b64_tr_b16 v[164:165], v201 offset:0
    ds_read_b64_tr_b16 v[166:167], v201 offset:512
    s_waitcnt lgkmcnt(4)
    ds_read_b64_tr_b16 v[168:169], v200 offset:2048
    ds_read_b64_tr_b16 v[170:171], v200 offset:2560
    ds_read_b64_tr_b16 v[172:173], v201 offset:2048
    ds_read_b64_tr_b16 v[174:175], v201 offset:2560
    s_waitcnt lgkmcnt(4)
    ds_read_b64_tr_b16 v[176:177], v200 offset:4096
    ds_read_b64_tr_b16 v[178:179], v200 offset:4608
    ds_read_b64_tr_b16 v[180:181], v201 offset:4096
    ds_read_b64_tr_b16 v[182:183], v201 offset:4608
    s_waitcnt lgkmcnt(4)
    ds_read_b64_tr_b16 v[184:185], v200 offset:6144
    ds_read_b64_tr_b16 v[186:187], v200 offset:6656
    ds_read_b64_tr_b16 v[188:189], v201 offset:6144
    ds_read_b64_tr_b16 v[190:191], v201 offset:6656
    s_waitcnt lgkmcnt(4)
    ds_read_b64_tr_b16 v[192:193], v200 offset:8192
    ds_read_b64_tr_b16 v[194:195], v200 offset:8704
    ds_read_b64_tr_b16 v[196:197], v201 offset:8192
    ds_read_b64_tr_b16 v[198:199], v201 offset:8704
L_con_oseen:
    s_setprio 1
    s_barrier
    buffer_load_dwordx4 v[16:19], v15, s[20:23], s57 offen offset:0 sc1
    buffer_load_dwordx4 v[20:23], v15, s[20:23], s57 offen offset:1024 sc1
    buffer_load_dwordx4 v[24:27], v15, s[20:23], s57 offen offset:2048 sc1
    buffer_load_dwordx4 v[28:31], v15, s[20:23], s57 offen offset:3072 sc1
    s_add_u32 s57, s57, 4096
    buffer_load_dwordx4 v[32:35], v15, s[20:23], s57 offen offset:0 sc1
    v_add_u32 v13, s67, v15
    s_waitcnt vmcnt(4) lgkmcnt(12)
    v_mfma_f32_32x32x16_bf16 v[208:223], v[88:91], v[16:19], 0
    v_mfma_f32_32x32x16_bf16 v[224:239], v[92:95], v[16:19], 0
    buffer_load_dwordx4 v[36:39], v15, s[20:23], s57 offen offset:1024 sc1
    s_waitcnt lgkmcnt(4)
    ds_read_b64_tr_b16 v[88:89], v200 offset:10240
    ds_read_b64_tr_b16 v[90:91], v200 offset:10752
    ds_read_b64_tr_b16 v[92:93], v201 offset:10240
    ds_read_b64_tr_b16 v[94:95], v201 offset:10752
    s_waitcnt vmcnt(4) lgkmcnt(12)
    v_mfma_f32_32x32x16_bf16 v[208:223], v[96:99], v[20:23], v[208:223]
    v_mfma_f32_32x32x16_bf16 v[224:239], v[100:103], v[20:23], v[224:239]
    buffer_load_dwordx4 v[40:43], v15, s[20:23], s57 offen offset:2048 sc1
    s_waitcnt lgkmcnt(4)
    ds_read_b64_tr_b16 v[96:97], v200 offset:12288
    ds_read_b64_tr_b16 v[98:99], v200 offset:12800
    ds_read_b64_tr_b16 v[100:101], v201 offset:12288
    ds_read_b64_tr_b16 v[102:103], v201 offset:12800
    s_waitcnt vmcnt(4) lgkmcnt(12)
    v_mfma_f32_32x32x16_bf16 v[208:223], v[104:107], v[24:27], v[208:223]
    v_mfma_f32_32x32x16_bf16 v[224:239], v[108:111], v[24:27], v[224:239]
    buffer_load_dwordx4 v[44:47], v15, s[20:23], s57 offen offset:3072 sc1
    s_add_u32 s57, s57, 4096
    s_waitcnt lgkmcnt(4)
    ds_read_b64_tr_b16 v[104:105], v200 offset:14336
    ds_read_b64_tr_b16 v[106:107], v200 offset:14848
    ds_read_b64_tr_b16 v[108:109], v201 offset:14336
    ds_read_b64_tr_b16 v[110:111], v201 offset:14848
    s_waitcnt vmcnt(4) lgkmcnt(12)
    v_mfma_f32_32x32x16_bf16 v[208:223], v[112:115], v[28:31], v[208:223]
    v_mfma_f32_32x32x16_bf16 v[224:239], v[116:119], v[28:31], v[224:239]
    buffer_load_dword v48, v5, s[20:23], s57 offen offset:0 sc1
    buffer_load_dword v49, v5, s[20:23], s57 offen offset:256 sc1
    buffer_load_dword v50, v5, s[20:23], s57 offen offset:512 sc1
    buffer_load_dword v51, v5, s[20:23], s57 offen offset:768 sc1
    s_waitcnt lgkmcnt(4)
    ds_read_b64_tr_b16 v[112:113], v200 offset:16384
    ds_read_b64_tr_b16 v[114:115], v200 offset:16896
    ds_read_b64_tr_b16 v[116:117], v201 offset:16384
    ds_read_b64_tr_b16 v[118:119], v201 offset:16896
    s_waitcnt vmcnt(7) lgkmcnt(12)
    v_mfma_f32_32x32x16_bf16 v[208:223], v[120:123], v[32:35], v[208:223]
    v_mfma_f32_32x32x16_bf16 v[224:239], v[124:127], v[32:35], v[224:239]
    buffer_load_dwordx4 v[52:55], v15, s[20:23], s57 offen offset:1024 sc1
    s_waitcnt vmcnt(7) lgkmcnt(12)
    v_mfma_f32_32x32x16_bf16 v[208:223], v[128:131], v[36:39], v[208:223]
    v_mfma_f32_32x32x16_bf16 v[224:239], v[132:135], v[36:39], v[224:239]
    buffer_load_dwordx4 v[56:59], v15, s[20:23], s57 offen offset:2048 sc1
    s_waitcnt vmcnt(7) lgkmcnt(12)
    v_mfma_f32_32x32x16_bf16 v[208:223], v[136:139], v[40:43], v[208:223]
    v_mfma_f32_32x32x16_bf16 v[224:239], v[140:143], v[40:43], v[224:239]
    buffer_load_dwordx4 v[60:63], v15, s[20:23], s57 offen offset:3072 sc1
    s_add_u32 s57, s57, 4096
    s_waitcnt vmcnt(7) lgkmcnt(12)
    v_mfma_f32_32x32x16_bf16 v[208:223], v[144:147], v[44:47], v[208:223]
    v_mfma_f32_32x32x16_bf16 v[224:239], v[148:151], v[44:47], v[224:239]
    buffer_load_dwordx4 v[64:67], v15, s[20:23], s57 offen offset:0 sc1
    s_waitcnt vmcnt(4) lgkmcnt(12)
    v_mfma_f32_32x32x16_bf16 v[208:223], v[152:155], v[48:51], v[208:223]
    v_mfma_f32_32x32x16_bf16 v[224:239], v[156:159], v[48:51], v[224:239]
    buffer_load_dwordx4 v[68:71], v15, s[20:23], s57 offen offset:1024 sc1
    s_waitcnt vmcnt(4) lgkmcnt(12)
    v_mfma_f32_32x32x16_bf16 v[208:223], v[160:163], v[52:55], v[208:223]
    v_mfma_f32_32x32x16_bf16 v[224:239], v[164:167], v[52:55], v[224:239]
    buffer_load_dwordx4 v[72:75], v15, s[20:23], s57 offen offset:2048 sc1
    s_waitcnt vmcnt(4) lgkmcnt(12)
    v_mfma_f32_32x32x16_bf16 v[208:223], v[168:171], v[56:59], v[208:223]
    v_mfma_f32_32x32x16_bf16 v[224:239], v[172:175], v[56:59], v[224:239]
    buffer_load_dwordx4 v[76:79], v15, s[20:23], s57 offen offset:3072 sc1
    s_add_u32 s57, s57, 4096
    s_waitcnt vmcnt(4) lgkmcnt(12)
    v_mfma_f32_32x32x16_bf16 v[208:223], v[176:179], v[60:63], v[208:223]
    v_mfma_f32_32x32x16_bf16 v[224:239], v[180:183], v[60:63], v[224:239]
    buffer_load_dwordx4 v[80:83], v15, s[20:23], s57 offen offset:0 sc1
    s_waitcnt vmcnt(4) lgkmcnt(12)
    v_mfma_f32_32x32x16_bf16 v[208:223], v[184:187], v[64:67], v[208:223]
    v_mfma_f32_32x32x16_bf16 v[224:239], v[188:191], v[64:67], v[224:239]
    buffer_load_dword v84, v5, s[20:23], s57 offen offset:1024 sc1
    buffer_load_dword v85, v5, s[20:23], s57 offen offset:1280 sc1
    buffer_load_dword v86, v5, s[20:23], s57 offen offset:1536 sc1
    buffer_load_dword v87, v5, s[20:23], s57 offen offset:1792 sc1
    s_waitcnt vmcnt(7) lgkmcnt(12)
    v_mfma_f32_32x32x16_bf16 v[208:223], v[192:195], v[68:71], v[208:223]
    v_mfma_f32_32x32x16_bf16 v[224:239], v[196:199], v[68:71], v[224:239]
    s_waitcnt vmcnt(6) lgkmcnt(12)
    v_mfma_f32_32x32x16_bf16 v[208:223], v[88:91], v[72:75], v[208:223]
    v_mfma_f32_32x32x16_bf16 v[224:239], v[92:95], v[72:75], v[224:239]
    s_waitcnt vmcnt(5) lgkmcnt(8)
    v_mfma_f32_32x32x16_bf16 v[208:223], v[96:99], v[76:79], v[208:223]
    v_mfma_f32_32x32x16_bf16 v[224:239], v[100:103], v[76:79], v[224:239]
    s_waitcnt vmcnt(4) lgkmcnt(4)
    v_mfma_f32_32x32x16_bf16 v[208:223], v[104:107], v[80:83], v[208:223]
    v_mfma_f32_32x32x16_bf16 v[224:239], v[108:111], v[80:83], v[224:239]
    s_waitcnt vmcnt(0) lgkmcnt(0)
    v_mfma_f32_32x32x16_bf16 v[208:223], v[112:115], v[84:87], v[208:223]
    v_mfma_f32_32x32x16_bf16 v[224:239], v[116:119], v[84:87], v[224:239]
    s_nop 7
    s_nop 2
    ds_write_b128 v13, v[208:211] offset:0
    ds_write_b128 v13, v[212:215] offset:1024
    ds_write_b128 v13, v[216:219] offset:2048
    ds_write_b128 v13, v[220:223] offset:3072
    ds_write_b128 v13, v[224:227] offset:4096
    ds_write_b128 v13, v[228:231] offset:5120
    ds_write_b128 v13, v[232:235] offset:6144
    ds_write_b128 v13, v[236:239] offset:7168
    s_waitcnt lgkmcnt(0)
    s_barrier
    s_endpgm
L_con_op100:
    ds_read_b64_tr_b16 v[88:89], v2 offset:0
    ds_read_b64_tr_b16 v[90:91], v2 offset:512
    ds_read_b64_tr_b16 v[92:93], v3 offset:0
    ds_read_b64_tr_b16 v[94:95], v3 offset:512
    ds_read_b64_tr_b16 v[96:97], v4 offset:0
    ds_read_b64_tr_b16 v[98:99], v4 offset:256
    ds_read_b64_tr_b16 v[100:101], v2 offset:2048
    ds_read_b64_tr_b16 v[102:103], v2 offset:2560
    ds_read_b64_tr_b16 v[104:105], v3 offset:2048
    ds_read_b64_tr_b16 v[106:107], v3 offset:2560
    ds_read_b64_tr_b16 v[108:109], v4 offset:1024
    ds_read_b64_tr_b16 v[110:111], v4 offset:1280
    s_waitcnt lgkmcnt(6)
    ds_read_b64_tr_b16 v[112:113], v2 offset:4096
    ds_read_b64_tr_b16 v[114:115], v2 offset:4608
    ds_read_b64_tr_b16 v[116:117], v3 offset:4096
    ds_read_b64_tr_b16 v[118:119], v3 offset:4608
    ds_read_b64_tr_b16 v[120:121], v4 offset:2048
    ds_read_b64_tr_b16 v[122:123], v4 offset:2304
    s_waitcnt lgkmcnt(6)
    ds_read_b64_tr_b16 v[124:125], v2 offset:6144
    ds_read_b64_tr_b16 v[126:127], v2 offset:6656
    ds_read_b64_tr_b16 v[128:129], v3 offset:6144
    ds_read_b64_tr_b16 v[130:131], v3 offset:6656
    ds_read_b64_tr_b16 v[132:133], v4 offset:3072
    ds_read_b64_tr_b16 v[134:135], v4 offset:3328
    s_waitcnt vmcnt(0) lgkmcnt(0)
    s_barrier
    ds_read_b32 v10, v10
    s_waitcnt lgkmcnt(0)
    v_readfirstlane_b32 s3, v10
    s_nop 0
    s_cmp_lg_u32 s3, 0
    s_cbranch_scc1 L_con_fallback
    s_waitcnt lgkmcnt(6)
    ds_read_b64_tr_b16 v[136:137], v2 offset:8192
    ds_read_b64_tr_b16 v[138:139], v2 offset:8704
    ds_read_b64_tr_b16 v[140:141], v3 offset:8192
    ds_read_b64_tr_b16 v[142:143], v3 offset:8704
    ds_read_b64_tr_b16 v[144:145], v4 offset:4096
    ds_read_b64_tr_b16 v[146:147], v4 offset:4352
    s_waitcnt lgkmcnt(6)
    ds_read_b64_tr_b16 v[148:149], v2 offset:10240
    ds_read_b64_tr_b16 v[150:151], v2 offset:10752
    ds_read_b64_tr_b16 v[152:153], v3 offset:10240
    ds_read_b64_tr_b16 v[154:155], v3 offset:10752
    ds_read_b64_tr_b16 v[156:157], v4 offset:5120
    ds_read_b64_tr_b16 v[158:159], v4 offset:5376
    s_waitcnt lgkmcnt(6)
    ds_read_b64_tr_b16 v[160:161], v2 offset:12288
    ds_read_b64_tr_b16 v[162:163], v2 offset:12800
    ds_read_b64_tr_b16 v[164:165], v3 offset:12288
    ds_read_b64_tr_b16 v[166:167], v3 offset:12800
    ds_read_b64_tr_b16 v[168:169], v4 offset:6144
    ds_read_b64_tr_b16 v[170:171], v4 offset:6400
    s_waitcnt lgkmcnt(6)
    ds_read_b64_tr_b16 v[172:173], v2 offset:14336
    ds_read_b64_tr_b16 v[174:175], v2 offset:14848
    ds_read_b64_tr_b16 v[176:177], v3 offset:14336
    ds_read_b64_tr_b16 v[178:179], v3 offset:14848
    ds_read_b64_tr_b16 v[180:181], v4 offset:7168
    ds_read_b64_tr_b16 v[182:183], v4 offset:7424
    s_waitcnt lgkmcnt(6)
    ds_read_b64_tr_b16 v[184:185], v2 offset:16384
    ds_read_b64_tr_b16 v[186:187], v2 offset:16896
    ds_read_b64_tr_b16 v[188:189], v3 offset:16384
    ds_read_b64_tr_b16 v[190:191], v3 offset:16896
    ds_read_b64_tr_b16 v[192:193], v4 offset:8192
    ds_read_b64_tr_b16 v[194:195], v4 offset:8448
    s_setprio 3
    s_barrier
    buffer_load_dwordx4 v[16:19], v15, s[20:23], s57 offen offset:0 sc1
    buffer_load_dwordx4 v[20:23], v15, s[20:23], s57 offen offset:1024 sc1
    buffer_load_dwordx4 v[24:27], v15, s[20:23], s57 offen offset:2048 sc1
    buffer_load_dwordx4 v[28:31], v15, s[20:23], s57 offen offset:3072 sc1
    s_add_u32 s57, s57, 4096
    buffer_load_dwordx4 v[32:35], v15, s[20:23], s57 offen offset:0 sc1
    buffer_load_dwordx4 v[36:39], v15, s[20:23], s57 offen offset:1024 sc1
    buffer_load_dwordx4 v[40:43], v15, s[20:23], s57 offen offset:2048 sc1
    s_setprio 1
    v_add_u32 v13, s67, v15
    v_add_u32 v11, 71680, v15
    v_and_b32 v14, 15, v1
    v_mul_u32_u24 v14, 0x900, v14
    v_lshrrev_b32 v9, 5, v1
    v_bfe_u32 v12, v1, 4, 1
    v_and_b32 v14, 7, v1
    v_mul_u32_u24 v14, 0x900, v14
    v_lshl_add_u32 v9, v9, 4, v14
    v_lshl_add_u32 v12, v12, 5, v9
    v_bfe_u32 v9, v1, 3, 1
    v_lshl_add_u32 v12, v9, 6, v12
    s_waitcnt vmcnt(6) lgkmcnt(12)
    v_mfma_f32_32x32x16_bf16 v[208:223], v[88:91], v[16:19], 0
    v_mfma_f32_32x32x16_bf16 v[224:239], v[92:95], v[16:19], 0
    v_mfma_f32_32x32x16_bf16 v[240:255], v[96:99], v[16:19], 0
    buffer_load_dwordx4 v[44:47], v15, s[20:23], s57 offen offset:3072 sc1
    s_add_u32 s57, s57, 4096
    s_waitcnt lgkmcnt(6)
    ds_read_b64_tr_b16 v[88:89], v200 offset:0
    ds_read_b64_tr_b16 v[90:91], v200 offset:512
    ds_read_b64_tr_b16 v[92:93], v201 offset:0
    ds_read_b64_tr_b16 v[94:95], v201 offset:512
    ds_read_b64_tr_b16 v[96:97], v202 offset:0
    ds_read_b64_tr_b16 v[98:99], v202 offset:256
    s_waitcnt vmcnt(6) lgkmcnt(12)
    v_mfma_f32_32x32x16_bf16 v[208:223], v[100:103], v[20:23], v[208:223]
    v_mfma_f32_32x32x16_bf16 v[224:239], v[104:107], v[20:23], v[224:239]
    v_mfma_f32_32x32x16_bf16 v[240:255], v[108:111], v[20:23], v[240:255]
    buffer_load_dword v48, v5, s[20:23], s57 offen offset:0 sc1
    buffer_load_dword v49, v5, s[20:23], s57 offen offset:256 sc1
    buffer_load_dword v50, v5, s[20:23], s57 offen offset:512 sc1
    buffer_load_dword v51, v5, s[20:23], s57 offen offset:768 sc1
    s_waitcnt lgkmcnt(6)
    ds_read_b64_tr_b16 v[100:101], v200 offset:2048
    ds_read_b64_tr_b16 v[102:103], v200 offset:2560
    ds_read_b64_tr_b16 v[104:105], v201 offset:2048
    ds_read_b64_tr_b16 v[106:107], v201 offset:2560
    ds_read_b64_tr_b16 v[108:109], v202 offset:1024
    ds_read_b64_tr_b16 v[110:111], v202 offset:1280
    s_waitcnt vmcnt(9) lgkmcnt(12)
    v_mfma_f32_32x32x16_bf16 v[208:223], v[112:115], v[24:27], v[208:223]
    v_mfma_f32_32x32x16_bf16 v[224:239], v[116:119], v[24:27], v[224:239]
    v_mfma_f32_32x32x16_bf16 v[240:255], v[120:123], v[24:27], v[240:255]
    buffer_load_dwordx4 v[52:55], v15, s[20:23], s57 offen offset:1024 sc1
    s_waitcnt lgkmcnt(6)
    ds_read_b64_tr_b16 v[112:113], v200 offset:4096
    ds_read_b64_tr_b16 v[114:115], v200 offset:4608
    ds_read_b64_tr_b16 v[116:117], v201 offset:4096
    ds_read_b64_tr_b16 v[118:119], v201 offset:4608
    ds_read_b64_tr_b16 v[120:121], v202 offset:2048
    ds_read_b64_tr_b16 v[122:123], v202 offset:2304
    s_waitcnt vmcnt(9) lgkmcnt(12)
    v_mfma_f32_32x32x16_bf16 v[208:223], v[124:127], v[28:31], v[208:223]
    v_mfma_f32_32x32x16_bf16 v[224:239], v[128:131], v[28:31], v[224:239]
    v_mfma_f32_32x32x16_bf16 v[240:255], v[132:135], v[28:31], v[240:255]
    buffer_load_dwordx4 v[56:59], v15, s[20:23], s57 offen offset:2048 sc1
    s_waitcnt lgkmcnt(6)
    ds_read_b64_tr_b16 v[124:125], v200 offset:6144
    ds_read_b64_tr_b16 v[126:127], v200 offset:6656
    ds_read_b64_tr_b16 v[128:129], v201 offset:6144
    ds_read_b64_tr_b16 v[130:131], v201 offset:6656
    ds_read_b64_tr_b16 v[132:133], v202 offset:3072
    ds_read_b64_tr_b16 v[134:135], v202 offset:3328
    s_waitcnt vmcnt(9) lgkmcnt(12)
    v_mfma_f32_32x32x16_bf16 v[208:223], v[136:139], v[32:35], v[208:223]
    v_mfma_f32_32x32x16_bf16 v[224:239], v[140:143], v[32:35], v[224:239]
    v_mfma_f32_32x32x16_bf16 v[240:255], v[144:147], v[32:35], v[240:255]
    buffer_load_dwordx4 v[60:63], v15, s[20:23], s57 offen offset:3072 sc1
    s_add_u32 s57, s57, 4096
    s_waitcnt lgkmcnt(6)
    ds_read_b64_tr_b16 v[136:137], v200 offset:8192
    ds_read_b64_tr_b16 v[138:139], v200 offset:8704
    ds_read_b64_tr_b16 v[140:141], v201 offset:8192
    ds_read_b64_tr_b16 v[142:143], v201 offset:8704
    ds_read_b64_tr_b16 v[144:145], v202 offset:4096
    ds_read_b64_tr_b16 v[146:147], v202 offset:4352
    s_waitcnt vmcnt(9) lgkmcnt(12)
    v_mfma_f32_32x32x16_bf16 v[208:223], v[148:151], v[36:39], v[208:223]
    v_mfma_f32_32x32x16_bf16 v[224:239], v[152:155], v[36:39], v[224:239]
    v_mfma_f32_32x32x16_bf16 v[240:255], v[156:159], v[36:39], v[240:255]
    buffer_load_dwordx4 v[64:67], v15, s[20:23], s57 offen offset:0 sc1
    s_waitcnt lgkmcnt(6)
    ds_read_b64_tr_b16 v[148:149], v200 offset:10240
    ds_read_b64_tr_b16 v[150:151], v200 offset:10752
    ds_read_b64_tr_b16 v[152:153], v201 offset:10240
    ds_read_b64_tr_b16 v[154:155], v201 offset:10752
    ds_read_b64_tr_b16 v[156:157], v202 offset:5120
    ds_read_b64_tr_b16 v[158:159], v202 offset:5376
    s_waitcnt vmcnt(9) lgkmcnt(12)
    v_mfma_f32_32x32x16_bf16 v[208:223], v[160:163], v[40:43], v[208:223]
    v_mfma_f32_32x32x16_bf16 v[224:239], v[164:167], v[40:43], v[224:239]
    v_mfma_f32_32x32x16_bf16 v[240:255], v[168:171], v[40:43], v[240:255]
    buffer_load_dwordx4 v[68:71], v15, s[20:23], s57 offen offset:1024 sc1
    s_waitcnt lgkmcnt(6)
    ds_read_b64_tr_b16 v[160:161], v200 offset:12288
    ds_read_b64_tr_b16 v[162:163], v200 offset:12800
    ds_read_b64_tr_b16 v[164:165], v201 offset:12288
    ds_read_b64_tr_b16 v[166:167], v201 offset:12800
    ds_read_b64_tr_b16 v[168:169], v202 offset:6144
    ds_read_b64_tr_b16 v[170:171], v202 offset:6400
    s_waitcnt vmcnt(9) lgkmcnt(12)
    v_mfma_f32_32x32x16_bf16 v[208:223], v[172:175], v[44:47], v[208:223]
    v_mfma_f32_32x32x16_bf16 v[224:239], v[176:179], v[44:47], v[224:239]
    v_mfma_f32_32x32x16_bf16 v[240:255], v[180:183], v[44:47], v[240:255]
    buffer_load_dwordx4 v[72:75], v15, s[20:23], s57 offen offset:2048 sc1
    s_waitcnt lgkmcnt(6)
    ds_read_b64_tr_b16 v[172:173], v200 offset:14336
    ds_read_b64_tr_b16 v[174:175], v200 offset:14848
    ds_read_b64_tr_b16 v[176:177], v201 offset:14336
    ds_read_b64_tr_b16 v[178:179], v201 offset:14848
    ds_read_b64_tr_b16 v[180:181], v202 offset:7168
    ds_read_b64_tr_b16 v[182:183], v202 offset:7424
    s_waitcnt vmcnt(6) lgkmcnt(12)
    v_mfma_f32_32x32x16_bf16 v[208:223], v[184:187], v[48:51], v[208:223]
    v_mfma_f32_32x32x16_bf16 v[224:239], v[188:191], v[48:51], v[224:239]
    v_mfma_f32_32x32x16_bf16 v[240:255], v[192:195], v[48:51], v[240:255]
    buffer_load_dwordx4 v[76:79], v15, s[20:23], s57 offen offset:3072 sc1
    s_add_u32 s57, s57, 4096
    s_waitcnt lgkmcnt(6)
    ds_read_b64_tr_b16 v[184:185], v200 offset:16384
    ds_read_b64_tr_b16 v[186:187], v200 offset:16896
    ds_read_b64_tr_b16 v[188:189], v201 offset:16384
    ds_read_b64_tr_b16 v[190:191], v201 offset:16896
    ds_read_b64_tr_b16 v[192:193], v202 offset:8192
    ds_read_b64_tr_b16 v[194:195], v202 offset:8448
    s_waitcnt vmcnt(6) lgkmcnt(12)
    v_mfma_f32_32x32x16_bf16 v[208:223], v[88:91], v[52:55], v[208:223]
    v_mfma_f32_32x32x16_bf16 v[224:239], v[92:95], v[52:55], v[224:239]
    v_mfma_f32_32x32x16_bf16 v[240:255], v[96:99], v[52:55], v[240:255]
    buffer_load_dwordx4 v[80:83], v15, s[20:23], s57 offen offset:0 sc1
    s_waitcnt vmcnt(6) lgkmcnt(12)
    v_mfma_f32_32x32x16_bf16 v[208:223], v[100:103], v[56:59], v[208:223]
    v_mfma_f32_32x32x16_bf16 v[224:239], v[104:107], v[56:59], v[224:239]
    v_mfma_f32_32x32x16_bf16 v[240:255], v[108:111], v[56:59], v[240:255]
    buffer_load_dword v84, v5, s[20:23], s57 offen offset:1024 sc1
    buffer_load_dword v85, v5, s[20:23], s57 offen offset:1280 sc1
    buffer_load_dword v86, v5, s[20:23], s57 offen offset:1536 sc1
    buffer_load_dword v87, v5, s[20:23], s57 offen offset:1792 sc1
    s_waitcnt vmcnt(9) lgkmcnt(12)
    v_mfma_f32_32x32x16_bf16 v[208:223], v[112:115], v[60:63], v[208:223]
    v_mfma_f32_32x32x16_bf16 v[224:239], v[116:119], v[60:63], v[224:239]
    v_mfma_f32_32x32x16_bf16 v[240:255], v[120:123], v[60:63], v[240:255]
    s_waitcnt vmcnt(8) lgkmcnt(0)
    v_mfma_f32_32x32x16_bf16 v[240:255], v[132:135], v[64:67], v[240:255]
    s_waitcnt vmcnt(7) lgkmcnt(0)
    v_mfma_f32_32x32x16_bf16 v[240:255], v[144:147], v[68:71], v[240:255]
    s_waitcnt vmcnt(6) lgkmcnt(0)
    v_mfma_f32_32x32x16_bf16 v[240:255], v[156:159], v[72:75], v[240:255]
    s_waitcnt vmcnt(5) lgkmcnt(0)
    v_mfma_f32_32x32x16_bf16 v[240:255], v[168:171], v[76:79], v[240:255]
    s_waitcnt vmcnt(4) lgkmcnt(0)
    v_mfma_f32_32x32x16_bf16 v[240:255], v[180:183], v[80:83], v[240:255]
    s_waitcnt vmcnt(0) lgkmcnt(0)
    v_mfma_f32_32x32x16_bf16 v[240:255], v[192:195], v[84:87], v[240:255]
    v_mfma_f32_32x32x16_bf16 v[208:223], v[124:127], v[64:67], v[208:223]
    v_mfma_f32_32x32x16_bf16 v[224:239], v[128:131], v[64:67], v[224:239]
    v_mfma_f32_32x32x16_bf16 v[208:223], v[136:139], v[68:71], v[208:223]
    v_mfma_f32_32x32x16_bf16 v[224:239], v[140:143], v[68:71], v[224:239]
    s_nop 7
    ds_write_b128 v11, v[240:243] offset:0
    ds_write_b128 v11, v[244:247] offset:1024
    ds_write_b128 v11, v[248:251] offset:2048
    ds_write_b128 v11, v[252:255] offset:3072
    s_waitcnt lgkmcnt(0)
    s_barrier
    ds_read_b128 v[16:19], v13 offset:0
    ds_read_b128 v[20:23], v13 offset:1024
    ds_read_b128 v[24:27], v13 offset:2048
    ds_read_b128 v[28:31], v13 offset:3072
    ds_read_b128 v[32:35], v13 offset:4096
    ds_read_b128 v[36:39], v13 offset:5120
    ds_read_b128 v[40:43], v13 offset:6144
    ds_read_b128 v[44:47], v13 offset:7168
    v_mfma_f32_32x32x16_bf16 v[208:223], v[148:151], v[72:75], v[208:223]
    v_mfma_f32_32x32x16_bf16 v[224:239], v[152:155], v[72:75], v[224:239]
    v_mfma_f32_32x32x16_bf16 v[208:223], v[160:163], v[76:79], v[208:223]
    v_mfma_f32_32x32x16_bf16 v[224:239], v[164:167], v[76:79], v[224:239]
    v_mfma_f32_32x32x16_bf16 v[208:223], v[172:175], v[80:83], v[208:223]
    v_mfma_f32_32x32x16_bf16 v[224:239], v[176:179], v[80:83], v[224:239]
    v_mfma_f32_32x32x16_bf16 v[208:223], v[184:187], v[84:87], v[208:223]
    v_mfma_f32_32x32x16_bf16 v[224:239], v[188:191], v[84:87], v[224:239]
    s_waitcnt lgkmcnt(0)
    s_setprio 3
    s_nop 7
    s_nop 0
    v_pk_add_f32 v[208:209], v[208:209], v[16:17]
    v_pk_add_f32 v[210:211], v[210:211], v[18:19]
    v_pk_add_f32 v[212:213], v[212:213], v[20:21]
    v_pk_add_f32 v[214:215], v[214:215], v[22:23]
    v_pk_add_f32 v[216:217], v[216:217], v[24:25]
    v_pk_add_f32 v[218:219], v[218:219], v[26:27]
    v_pk_add_f32 v[220:221], v[220:221], v[28:29]
    v_pk_add_f32 v[222:223], v[222:223], v[30:31]
    v_cvt_pk_bf16_f32 v88, v208, v209
    v_cvt_pk_bf16_f32 v89, v210, v211
    v_cvt_pk_bf16_f32 v90, v212, v213
    v_cvt_pk_bf16_f32 v91, v214, v215
    v_cvt_pk_bf16_f32 v92, v216, v217
    v_cvt_pk_bf16_f32 v93, v218, v219
    v_cvt_pk_bf16_f32 v94, v220, v221
    v_cvt_pk_bf16_f32 v95, v222, v223
    v_pk_add_f32 v[224:225], v[224:225], v[32:33]
    v_pk_add_f32 v[226:227], v[226:227], v[34:35]
    v_pk_add_f32 v[228:229], v[228:229], v[36:37]
    v_pk_add_f32 v[230:231], v[230:231], v[38:39]
    v_pk_add_f32 v[232:233], v[232:233], v[40:41]
    v_pk_add_f32 v[234:235], v[234:235], v[42:43]
    v_pk_add_f32 v[236:237], v[236:237], v[44:45]
    v_pk_add_f32 v[238:239], v[238:239], v[46:47]
    v_cvt_pk_bf16_f32 v96, v224, v225
    v_cvt_pk_bf16_f32 v97, v226, v227
    v_cvt_pk_bf16_f32 v98, v228, v229
    v_cvt_pk_bf16_f32 v99, v230, v231
    v_cvt_pk_bf16_f32 v100, v232, v233
    v_cvt_pk_bf16_f32 v101, v234, v235
    v_cvt_pk_bf16_f32 v102, v236, v237
    v_cvt_pk_bf16_f32 v103, v238, v239
    s_add_u32 s36, s40, 18432
    s_add_u32 s37, s56, 18432
    v_permlane16_swap_b32 v88, v96
    v_permlane16_swap_b32 v89, v97
    v_permlane16_swap_b32 v90, v98
    v_permlane16_swap_b32 v91, v99
    v_permlane16_swap_b32 v92, v100
    v_permlane16_swap_b32 v93, v101
    v_permlane16_swap_b32 v94, v102
    v_permlane16_swap_b32 v95, v103
    v_mov_b32 v104, v88
    v_mov_b32 v105, v89
    v_mov_b32 v106, v90
    v_mov_b32 v107, v91
    v_mov_b32_dpp v88, v92 row_ror:8 row_mask:0xf bank_mask:0xc
    v_mov_b32_dpp v89, v93 row_ror:8 row_mask:0xf bank_mask:0xc
    v_mov_b32_dpp v90, v94 row_ror:8 row_mask:0xf bank_mask:0xc
    v_mov_b32_dpp v91, v95 row_ror:8 row_mask:0xf bank_mask:0xc
    buffer_store_dwordx4 v[88:91], v12, s[24:27], s40 offen sc0 sc1
    v_mov_b32_dpp v92, v104 row_ror:8 row_mask:0xf bank_mask:0x3
    v_mov_b32_dpp v93, v105 row_ror:8 row_mask:0xf bank_mask:0x3
    v_mov_b32_dpp v94, v106 row_ror:8 row_mask:0xf bank_mask:0x3
    v_mov_b32_dpp v95, v107 row_ror:8 row_mask:0xf bank_mask:0x3
    buffer_store_dwordx4 v[92:95], v12, s[24:27], s36 offen sc0 sc1
    v_mov_b32 v108, v96
    v_mov_b32 v109, v97
    v_mov_b32 v110, v98
    v_mov_b32 v111, v99
    v_mov_b32_dpp v96, v100 row_ror:8 row_mask:0xf bank_mask:0xc
    v_mov_b32_dpp v97, v101 row_ror:8 row_mask:0xf bank_mask:0xc
    v_mov_b32_dpp v98, v102 row_ror:8 row_mask:0xf bank_mask:0xc
    v_mov_b32_dpp v99, v103 row_ror:8 row_mask:0xf bank_mask:0xc
    buffer_store_dwordx4 v[96:99], v12, s[24:27], s56 offen sc0 sc1
    v_mov_b32_dpp v100, v108 row_ror:8 row_mask:0xf bank_mask:0x3
    v_mov_b32_dpp v101, v109 row_ror:8 row_mask:0xf bank_mask:0x3
    v_mov_b32_dpp v102, v110 row_ror:8 row_mask:0xf bank_mask:0x3
    v_mov_b32_dpp v103, v111 row_ror:8 row_mask:0xf bank_mask:0x3
    buffer_store_dwordx4 v[100:103], v12, s[24:27], s37 offen sc0 sc1
    s_endpgm
L_con_op011:
    ds_read_b64_tr_b16 v[88:89], v2 offset:0
    ds_read_b64_tr_b16 v[90:91], v2 offset:512
    ds_read_b64_tr_b16 v[92:93], v3 offset:0
    ds_read_b64_tr_b16 v[94:95], v3 offset:512
    ds_read_b64_tr_b16 v[96:97], v2 offset:2048
    ds_read_b64_tr_b16 v[98:99], v2 offset:2560
    ds_read_b64_tr_b16 v[100:101], v3 offset:2048
    ds_read_b64_tr_b16 v[102:103], v3 offset:2560
    s_waitcnt lgkmcnt(4)
    ds_read_b64_tr_b16 v[104:105], v2 offset:4096
    ds_read_b64_tr_b16 v[106:107], v2 offset:4608
    ds_read_b64_tr_b16 v[108:109], v3 offset:4096
    ds_read_b64_tr_b16 v[110:111], v3 offset:4608
    s_waitcnt lgkmcnt(4)
    ds_read_b64_tr_b16 v[112:113], v2 offset:6144
    ds_read_b64_tr_b16 v[114:115], v2 offset:6656
    ds_read_b64_tr_b16 v[116:117], v3 offset:6144
    ds_read_b64_tr_b16 v[118:119], v3 offset:6656
    v_add_u32 v6, s96, v15
    v_add_u32 v7, s96, v5
    v_add_u32 v8, s97, v15
    v_add_u32 v207, s97, v5
    s_waitcnt vmcnt(0) lgkmcnt(0)
    s_barrier
    ds_read_b32 v10, v10
    s_waitcnt lgkmcnt(0)
    v_readfirstlane_b32 s3, v10
    s_nop 0
    s_cmp_lg_u32 s3, 0
    s_cbranch_scc1 L_con_fallback
    ds_read_b128 v[16:19], v6 offset:0
    ds_read_b128 v[20:23], v6 offset:1024
    ds_read_b32 v48, v7 offset:2048
    ds_read_b128 v[24:27], v6 offset:5120
    ds_read_b128 v[28:31], v6 offset:6144
    ds_read_b32 v49, v7 offset:7168
    ds_read_b128 v[32:35], v6 offset:10240
    ds_read_b128 v[36:39], v6 offset:11264
    ds_read_b32 v50, v7 offset:12288
    ds_read_b128 v[40:43], v8 offset:0
    ds_read_b128 v[44:47], v8 offset:1024
    ds_read_b32 v51, v207 offset:2048
    s_waitcnt lgkmcnt(0)
    v_mfma_f32_32x32x16_bf16 v[208:223], v[88:91], v[16:19], 0
    v_mfma_f32_32x32x16_bf16 v[224:239], v[92:95], v[16:19], 0
    v_mfma_f32_32x32x16_bf16 v[208:223], v[96:99], v[20:23], v[208:223]
    v_mfma_f32_32x32x16_bf16 v[224:239], v[100:103], v[20:23], v[224:239]
    ds_read_b64_tr_b16 v[120:121], v2 offset:8192
    ds_read_b64_tr_b16 v[122:123], v2 offset:8704
    ds_read_b64_tr_b16 v[124:125], v3 offset:8192
    ds_read_b64_tr_b16 v[126:127], v3 offset:8704
    v_mfma_f32_32x32x16_bf16 v[208:223], v[104:107], v[24:27], v[208:223]
    v_mfma_f32_32x32x16_bf16 v[224:239], v[108:111], v[24:27], v[224:239]
    ds_read_b64_tr_b16 v[128:129], v2 offset:10240
    ds_read_b64_tr_b16 v[130:131], v2 offset:10752
    ds_read_b64_tr_b16 v[132:133], v3 offset:10240
    ds_read_b64_tr_b16 v[134:135], v3 offset:10752
    v_mfma_f32_32x32x16_bf16 v[208:223], v[112:115], v[28:31], v[208:223]
    v_mfma_f32_32x32x16_bf16 v[224:239], v[116:119], v[28:31], v[224:239]
    s_waitcnt lgkmcnt(4)
    ds_read_b64_tr_b16 v[136:137], v2 offset:12288
    ds_read_b64_tr_b16 v[138:139], v2 offset:12800
    ds_read_b64_tr_b16 v[140:141], v3 offset:12288
    ds_read_b64_tr_b16 v[142:143], v3 offset:12800
    v_mfma_f32_32x32x16_bf16 v[208:223], v[120:123], v[32:35], v[208:223]
    v_mfma_f32_32x32x16_bf16 v[224:239], v[124:127], v[32:35], v[224:239]
    s_waitcnt lgkmcnt(4)
    ds_read_b64_tr_b16 v[144:145], v2 offset:14336
    ds_read_b64_tr_b16 v[146:147], v2 offset:14848
    ds_read_b64_tr_b16 v[148:149], v3 offset:14336
    ds_read_b64_tr_b16 v[150:151], v3 offset:14848
    v_mfma_f32_32x32x16_bf16 v[208:223], v[128:131], v[36:39], v[208:223]
    v_mfma_f32_32x32x16_bf16 v[224:239], v[132:135], v[36:39], v[224:239]
    s_waitcnt lgkmcnt(4)
    ds_read_b64_tr_b16 v[152:153], v2 offset:16384
    ds_read_b64_tr_b16 v[154:155], v2 offset:16896
    ds_read_b64_tr_b16 v[156:157], v3 offset:16384
    ds_read_b64_tr_b16 v[158:159], v3 offset:16896
    v_mfma_f32_32x32x16_bf16 v[208:223], v[136:139], v[40:43], v[208:223]
    v_mfma_f32_32x32x16_bf16 v[224:239], v[140:143], v[40:43], v[224:239]
    s_waitcnt lgkmcnt(4)
    ds_read_b64_tr_b16 v[88:89], v200 offset:0
    ds_read_b64_tr_b16 v[90:91], v200 offset:512
    ds_read_b64_tr_b16 v[92:93], v201 offset:0
    ds_read_b64_tr_b16 v[94:95], v201 offset:512
    v_mfma_f32_32x32x16_bf16 v[208:223], v[144:147], v[44:47], v[208:223]
    v_mfma_f32_32x32x16_bf16 v[224:239], v[148:151], v[44:47], v[224:239]
    s_waitcnt lgkmcnt(4)
    ds_read_b64_tr_b16 v[96:97], v200 offset:2048
    ds_read_b64_tr_b16 v[98:99], v200 offset:2560
    ds_read_b64_tr_b16 v[100:101], v201 offset:2048
    ds_read_b64_tr_b16 v[102:103], v201 offset:2560
    v_mfma_f32_32x32x16_bf16 v[208:223], v[152:155], v[48:51], v[208:223]
    v_mfma_f32_32x32x16_bf16 v[224:239], v[156:159], v[48:51], v[224:239]
    s_setprio 1
    s_barrier
    buffer_load_dwordx4 v[52:55], v15, s[20:23], s57 offen offset:0 sc1
    buffer_load_dwordx4 v[56:59], v15, s[20:23], s57 offen offset:1024 sc1
    buffer_load_dwordx4 v[60:63], v15, s[20:23], s57 offen offset:2048 sc1
    buffer_load_dwordx4 v[64:67], v15, s[20:23], s57 offen offset:3072 sc1
    s_add_u32 s57, s57, 4096
    buffer_load_dwordx4 v[68:71], v15, s[20:23], s57 offen offset:0 sc1
    v_add_u32 v13, s67, v15
    s_waitcnt vmcnt(4) lgkmcnt(4)
    v_mfma_f32_32x32x16_bf16 v[208:223], v[88:91], v[52:55], v[208:223]
    v_mfma_f32_32x32x16_bf16 v[224:239], v[92:95], v[52:55], v[224:239]
    buffer_load_dwordx4 v[72:75], v15, s[20:23], s57 offen offset:1024 sc1
    s_waitcnt lgkmcnt(4)
    ds_read_b64_tr_b16 v[104:105], v200 offset:4096
    ds_read_b64_tr_b16 v[106:107], v200 offset:4608
    ds_read_b64_tr_b16 v[108:109], v201 offset:4096
    ds_read_b64_tr_b16 v[110:111], v201 offset:4608
    s_waitcnt vmcnt(4) lgkmcnt(4)
    v_mfma_f32_32x32x16_bf16 v[208:223], v[96:99], v[56:59], v[208:223]
    v_mfma_f32_32x32x16_bf16 v[224:239], v[100:103], v[56:59], v[224:239]
    buffer_load_dwordx4 v[76:79], v15, s[20:23], s57 offen offset:2048 sc1
    s_waitcnt lgkmcnt(4)
    ds_read_b64_tr_b16 v[112:113], v200 offset:6144
    ds_read_b64_tr_b16 v[114:115], v200 offset:6656
    ds_read_b64_tr_b16 v[116:117], v201 offset:6144
    ds_read_b64_tr_b16 v[118:119], v201 offset:6656
    s_waitcnt vmcnt(4) lgkmcnt(4)
    v_mfma_f32_32x32x16_bf16 v[208:223], v[104:107], v[60:63], v[208:223]
    v_mfma_f32_32x32x16_bf16 v[224:239], v[108:111], v[60:63], v[224:239]
    buffer_load_dwordx4 v[80:83], v15, s[20:23], s57 offen offset:3072 sc1
    s_add_u32 s57, s57, 4096
    s_waitcnt lgkmcnt(4)
    ds_read_b64_tr_b16 v[120:121], v200 offset:8192
    ds_read_b64_tr_b16 v[122:123], v200 offset:8704
    ds_read_b64_tr_b16 v[124:125], v201 offset:8192
    ds_read_b64_tr_b16 v[126:127], v201 offset:8704
    s_waitcnt vmcnt(4) lgkmcnt(4)
    v_mfma_f32_32x32x16_bf16 v[208:223], v[112:115], v[64:67], v[208:223]
    v_mfma_f32_32x32x16_bf16 v[224:239], v[116:119], v[64:67], v[224:239]
    buffer_load_dword v84, v5, s[20:23], s57 offen offset:0 sc1
    buffer_load_dword v85, v5, s[20:23], s57 offen offset:256 sc1
    buffer_load_dword v86, v5, s[20:23], s57 offen offset:512 sc1
    buffer_load_dword v87, v5, s[20:23], s57 offen offset:768 sc1
    s_waitcnt lgkmcnt(4)
    ds_read_b64_tr_b16 v[128:129], v200 offset:10240
    ds_read_b64_tr_b16 v[130:131], v200 offset:10752
    ds_read_b64_tr_b16 v[132:133], v201 offset:10240
    ds_read_b64_tr_b16 v[134:135], v201 offset:10752
    s_waitcnt vmcnt(7) lgkmcnt(4)
    v_mfma_f32_32x32x16_bf16 v[208:223], v[120:123], v[68:71], v[208:223]
    v_mfma_f32_32x32x16_bf16 v[224:239], v[124:127], v[68:71], v[224:239]
    s_waitcnt lgkmcnt(4)
    ds_read_b64_tr_b16 v[136:137], v200 offset:12288
    ds_read_b64_tr_b16 v[138:139], v200 offset:12800
    ds_read_b64_tr_b16 v[140:141], v201 offset:12288
    ds_read_b64_tr_b16 v[142:143], v201 offset:12800
    s_waitcnt vmcnt(6) lgkmcnt(4)
    v_mfma_f32_32x32x16_bf16 v[208:223], v[128:131], v[72:75], v[208:223]
    v_mfma_f32_32x32x16_bf16 v[224:239], v[132:135], v[72:75], v[224:239]
    s_waitcnt lgkmcnt(4)
    ds_read_b64_tr_b16 v[144:145], v200 offset:14336
    ds_read_b64_tr_b16 v[146:147], v200 offset:14848
    ds_read_b64_tr_b16 v[148:149], v201 offset:14336
    ds_read_b64_tr_b16 v[150:151], v201 offset:14848
    s_waitcnt vmcnt(5) lgkmcnt(4)
    v_mfma_f32_32x32x16_bf16 v[208:223], v[136:139], v[76:79], v[208:223]
    v_mfma_f32_32x32x16_bf16 v[224:239], v[140:143], v[76:79], v[224:239]
    s_waitcnt lgkmcnt(4)
    ds_read_b64_tr_b16 v[152:153], v200 offset:16384
    ds_read_b64_tr_b16 v[154:155], v200 offset:16896
    ds_read_b64_tr_b16 v[156:157], v201 offset:16384
    ds_read_b64_tr_b16 v[158:159], v201 offset:16896
    s_waitcnt vmcnt(4) lgkmcnt(4)
    v_mfma_f32_32x32x16_bf16 v[208:223], v[144:147], v[80:83], v[208:223]
    v_mfma_f32_32x32x16_bf16 v[224:239], v[148:151], v[80:83], v[224:239]
    s_waitcnt vmcnt(0) lgkmcnt(0)
    v_mfma_f32_32x32x16_bf16 v[208:223], v[152:155], v[84:87], v[208:223]
    v_mfma_f32_32x32x16_bf16 v[224:239], v[156:159], v[84:87], v[224:239]
    s_nop 7
    s_nop 2
    ds_write_b128 v13, v[208:211] offset:0
    ds_write_b128 v13, v[212:215] offset:1024
    ds_write_b128 v13, v[216:219] offset:2048
    ds_write_b128 v13, v[220:223] offset:3072
    ds_write_b128 v13, v[224:227] offset:4096
    ds_write_b128 v13, v[228:231] offset:5120
    ds_write_b128 v13, v[232:235] offset:6144
    ds_write_b128 v13, v[236:239] offset:7168
    s_waitcnt lgkmcnt(0)
    s_barrier
    s_endpgm
L_con_op111:
    ds_read_b64_tr_b16 v[88:89], v2 offset:0
    ds_read_b64_tr_b16 v[90:91], v2 offset:512
    ds_read_b64_tr_b16 v[92:93], v3 offset:0
    ds_read_b64_tr_b16 v[94:95], v3 offset:512
    ds_read_b64_tr_b16 v[96:97], v4 offset:0
    ds_read_b64_tr_b16 v[98:99], v4 offset:256
    ds_read_b64_tr_b16 v[100:101], v2 offset:2048
    ds_read_b64_tr_b16 v[102:103], v2 offset:2560
    ds_read_b64_tr_b16 v[104:105], v3 offset:2048
    ds_read_b64_tr_b16 v[106:107], v3 offset:2560
    ds_read_b64_tr_b16 v[108:109], v4 offset:1024
    ds_read_b64_tr_b16 v[110:111], v4 offset:1280
    s_waitcnt lgkmcnt(6)
    ds_read_b64_tr_b16 v[112:113], v2 offset:4096
    ds_read_b64_tr_b16 v[114:115], v2 offset:4608
    ds_read_b64_tr_b16 v[116:117], v3 offset:4096
    ds_read_b64_tr_b16 v[118:119], v3 offset:4608
    ds_read_b64_tr_b16 v[120:121], v4 offset:2048
    ds_read_b64_tr_b16 v[122:123], v4 offset:2304
    s_waitcnt lgkmcnt(6)
    ds_read_b64_tr_b16 v[124:125], v2 offset:6144
    ds_read_b64_tr_b16 v[126:127], v2 offset:6656
    ds_read_b64_tr_b16 v[128:129], v3 offset:6144
    ds_read_b64_tr_b16 v[130:131], v3 offset:6656
    ds_read_b64_tr_b16 v[132:133], v4 offset:3072
    ds_read_b64_tr_b16 v[134:135], v4 offset:3328
    v_add_u32 v6, s96, v15
    v_add_u32 v7, s96, v5
    v_add_u32 v8, s97, v15
    v_add_u32 v207, s97, v5
    s_waitcnt vmcnt(0) lgkmcnt(0)
    s_barrier
    ds_read_b32 v10, v10
    s_waitcnt lgkmcnt(0)
    v_readfirstlane_b32 s3, v10
    s_nop 0
    s_cmp_lg_u32 s3, 0
    s_cbranch_scc1 L_con_fallback
    ds_read_b128 v[16:19], v6 offset:0
    ds_read_b128 v[20:23], v6 offset:1024
    ds_read_b32 v48, v7 offset:2048
    ds_read_b128 v[24:27], v6 offset:5120
    ds_read_b128 v[28:31], v6 offset:6144
    ds_read_b32 v49, v7 offset:7168
    ds_read_b128 v[32:35], v6 offset:10240
    ds_read_b128 v[36:39], v6 offset:11264
    ds_read_b32 v50, v7 offset:12288
    ds_read_b128 v[40:43], v8 offset:0
    ds_read_b128 v[44:47], v8 offset:1024
    ds_read_b32 v51, v207 offset:2048
    s_waitcnt lgkmcnt(0)
    v_mfma_f32_32x32x16_bf16 v[208:223], v[88:91], v[16:19], 0
    v_mfma_f32_32x32x16_bf16 v[224:239], v[92:95], v[16:19], 0
    v_mfma_f32_32x32x16_bf16 v[240:255], v[96:99], v[16:19], 0
    v_mfma_f32_32x32x16_bf16 v[208:223], v[100:103], v[20:23], v[208:223]
    v_mfma_f32_32x32x16_bf16 v[224:239], v[104:107], v[20:23], v[224:239]
    v_mfma_f32_32x32x16_bf16 v[240:255], v[108:111], v[20:23], v[240:255]
    ds_read_b64_tr_b16 v[136:137], v2 offset:8192
    ds_read_b64_tr_b16 v[138:139], v2 offset:8704
    ds_read_b64_tr_b16 v[140:141], v3 offset:8192
    ds_read_b64_tr_b16 v[142:143], v3 offset:8704
    ds_read_b64_tr_b16 v[144:145], v4 offset:4096
    ds_read_b64_tr_b16 v[146:147], v4 offset:4352
    v_mfma_f32_32x32x16_bf16 v[208:223], v[112:115], v[24:27], v[208:223]
    v_mfma_f32_32x32x16_bf16 v[224:239], v[116:119], v[24:27], v[224:239]
    v_mfma_f32_32x32x16_bf16 v[240:255], v[120:123], v[24:27], v[240:255]
    ds_read_b64_tr_b16 v[148:149], v2 offset:10240
    ds_read_b64_tr_b16 v[150:151], v2 offset:10752
    ds_read_b64_tr_b16 v[152:153], v3 offset:10240
    ds_read_b64_tr_b16 v[154:155], v3 offset:10752
    ds_read_b64_tr_b16 v[156:157], v4 offset:5120
    ds_read_b64_tr_b16 v[158:159], v4 offset:5376
    v_mfma_f32_32x32x16_bf16 v[208:223], v[124:127], v[28:31], v[208:223]
    v_mfma_f32_32x32x16_bf16 v[224:239], v[128:131], v[28:31], v[224:239]
    v_mfma_f32_32x32x16_bf16 v[240:255], v[132:135], v[28:31], v[240:255]
    s_waitcnt lgkmcnt(6)
    ds_read_b64_tr_b16 v[160:161], v2 offset:12288
    ds_read_b64_tr_b16 v[162:163], v2 offset:12800
    ds_read_b64_tr_b16 v[164:165], v3 offset:12288
    ds_read_b64_tr_b16 v[166:167], v3 offset:12800
    ds_read_b64_tr_b16 v[168:169], v4 offset:6144
    ds_read_b64_tr_b16 v[170:171], v4 offset:6400
    v_mfma_f32_32x32x16_bf16 v[208:223], v[136:139], v[32:35], v[208:223]
    v_mfma_f32_32x32x16_bf16 v[224:239], v[140:143], v[32:35], v[224:239]
    v_mfma_f32_32x32x16_bf16 v[240:255], v[144:147], v[32:35], v[240:255]
    s_setprio 1
    s_barrier
    buffer_load_dwordx4 v[52:55], v15, s[20:23], s57 offen offset:0 sc1
    buffer_load_dwordx4 v[56:59], v15, s[20:23], s57 offen offset:1024 sc1
    buffer_load_dwordx4 v[60:63], v15, s[20:23], s57 offen offset:2048 sc1
    buffer_load_dwordx4 v[64:67], v15, s[20:23], s57 offen offset:3072 sc1
    s_add_u32 s57, s57, 4096
    buffer_load_dwordx4 v[68:71], v15, s[20:23], s57 offen offset:0 sc1
    v_add_u32 v13, s67, v15
    v_add_u32 v11, 71680, v15
    v_and_b32 v14, 15, v1
    v_mul_u32_u24 v14, 0x900, v14
    v_lshrrev_b32 v9, 5, v1
    v_bfe_u32 v12, v1, 4, 1
    v_lshl_add_u32 v9, v9, 5, v14
    v_lshl_add_u32 v9, v12, 4, v9
    s_waitcnt lgkmcnt(6)
    ds_read_b64_tr_b16 v[172:173], v2 offset:14336
    ds_read_b64_tr_b16 v[174:175], v2 offset:14848
    ds_read_b64_tr_b16 v[176:177], v3 offset:14336
    ds_read_b64_tr_b16 v[178:179], v3 offset:14848
    ds_read_b64_tr_b16 v[180:181], v4 offset:7168
    ds_read_b64_tr_b16 v[182:183], v4 offset:7424
    v_mfma_f32_32x32x16_bf16 v[208:223], v[148:151], v[36:39], v[208:223]
    v_mfma_f32_32x32x16_bf16 v[224:239], v[152:155], v[36:39], v[224:239]
    v_mfma_f32_32x32x16_bf16 v[240:255], v[156:159], v[36:39], v[240:255]
    s_waitcnt lgkmcnt(6)
    ds_read_b64_tr_b16 v[184:185], v2 offset:16384
    ds_read_b64_tr_b16 v[186:187], v2 offset:16896
    ds_read_b64_tr_b16 v[188:189], v3 offset:16384
    ds_read_b64_tr_b16 v[190:191], v3 offset:16896
    ds_read_b64_tr_b16 v[192:193], v4 offset:8192
    ds_read_b64_tr_b16 v[194:195], v4 offset:8448
    v_mfma_f32_32x32x16_bf16 v[208:223], v[160:163], v[40:43], v[208:223]
    v_mfma_f32_32x32x16_bf16 v[224:239], v[164:167], v[40:43], v[224:239]
    v_mfma_f32_32x32x16_bf16 v[240:255], v[168:171], v[40:43], v[240:255]
    s_waitcnt lgkmcnt(6)
    ds_read_b64_tr_b16 v[88:89], v200 offset:0
    ds_read_b64_tr_b16 v[90:91], v200 offset:512
    ds_read_b64_tr_b16 v[92:93], v201 offset:0
    ds_read_b64_tr_b16 v[94:95], v201 offset:512
    ds_read_b64_tr_b16 v[96:97], v202 offset:0
    ds_read_b64_tr_b16 v[98:99], v202 offset:256
    v_mfma_f32_32x32x16_bf16 v[208:223], v[172:175], v[44:47], v[208:223]
    v_mfma_f32_32x32x16_bf16 v[224:239], v[176:179], v[44:47], v[224:239]
    v_mfma_f32_32x32x16_bf16 v[240:255], v[180:183], v[44:47], v[240:255]
    s_waitcnt lgkmcnt(6)
    ds_read_b64_tr_b16 v[100:101], v200 offset:2048
    ds_read_b64_tr_b16 v[102:103], v200 offset:2560
    ds_read_b64_tr_b16 v[104:105], v201 offset:2048
    ds_read_b64_tr_b16 v[106:107], v201 offset:2560
    ds_read_b64_tr_b16 v[108:109], v202 offset:1024
    ds_read_b64_tr_b16 v[110:111], v202 offset:1280
    v_mfma_f32_32x32x16_bf16 v[208:223], v[184:187], v[48:51], v[208:223]
    v_mfma_f32_32x32x16_bf16 v[224:239], v[188:191], v[48:51], v[224:239]
    v_mfma_f32_32x32x16_bf16 v[240:255], v[192:195], v[48:51], v[240:255]
    s_waitcnt vmcnt(4) lgkmcnt(6)
    v_mfma_f32_32x32x16_bf16 v[208:223], v[88:91], v[52:55], v[208:223]
    v_mfma_f32_32x32x16_bf16 v[224:239], v[92:95], v[52:55], v[224:239]
    v_mfma_f32_32x32x16_bf16 v[240:255], v[96:99], v[52:55], v[240:255]
    buffer_load_dwordx4 v[72:75], v15, s[20:23], s57 offen offset:1024 sc1
    s_waitcnt lgkmcnt(6)
    ds_read_b64_tr_b16 v[112:113], v200 offset:4096
    ds_read_b64_tr_b16 v[114:115], v200 offset:4608
    ds_read_b64_tr_b16 v[116:117], v201 offset:4096
    ds_read_b64_tr_b16 v[118:119], v201 offset:4608
    ds_read_b64_tr_b16 v[120:121], v202 offset:2048
    ds_read_b64_tr_b16 v[122:123], v202 offset:2304
    s_waitcnt vmcnt(4) lgkmcnt(6)
    v_mfma_f32_32x32x16_bf16 v[208:223], v[100:103], v[56:59], v[208:223]
    v_mfma_f32_32x32x16_bf16 v[224:239], v[104:107], v[56:59], v[224:239]
    v_mfma_f32_32x32x16_bf16 v[240:255], v[108:111], v[56:59], v[240:255]
    buffer_load_dwordx4 v[76:79], v15, s[20:23], s57 offen offset:2048 sc1
    s_waitcnt lgkmcnt(6)
    ds_read_b64_tr_b16 v[124:125], v200 offset:6144
    ds_read_b64_tr_b16 v[126:127], v200 offset:6656
    ds_read_b64_tr_b16 v[128:129], v201 offset:6144
    ds_read_b64_tr_b16 v[130:131], v201 offset:6656
    ds_read_b64_tr_b16 v[132:133], v202 offset:3072
    ds_read_b64_tr_b16 v[134:135], v202 offset:3328
    s_waitcnt vmcnt(4) lgkmcnt(6)
    v_mfma_f32_32x32x16_bf16 v[208:223], v[112:115], v[60:63], v[208:223]
    v_mfma_f32_32x32x16_bf16 v[224:239], v[116:119], v[60:63], v[224:239]
    v_mfma_f32_32x32x16_bf16 v[240:255], v[120:123], v[60:63], v[240:255]
    buffer_load_dwordx4 v[80:83], v15, s[20:23], s57 offen offset:3072 sc1
    s_add_u32 s57, s57, 4096
    s_waitcnt lgkmcnt(6)
    ds_read_b64_tr_b16 v[136:137], v200 offset:8192
    ds_read_b64_tr_b16 v[138:139], v200 offset:8704
    ds_read_b64_tr_b16 v[140:141], v201 offset:8192
    ds_read_b64_tr_b16 v[142:143], v201 offset:8704
    ds_read_b64_tr_b16 v[144:145], v202 offset:4096
    ds_read_b64_tr_b16 v[146:147], v202 offset:4352
    s_waitcnt vmcnt(4) lgkmcnt(6)
    v_mfma_f32_32x32x16_bf16 v[208:223], v[124:127], v[64:67], v[208:223]
    v_mfma_f32_32x32x16_bf16 v[224:239], v[128:131], v[64:67], v[224:239]
    v_mfma_f32_32x32x16_bf16 v[240:255], v[132:135], v[64:67], v[240:255]
    buffer_load_dword v84, v5, s[20:23], s57 offen offset:0 sc1
    buffer_load_dword v85, v5, s[20:23], s57 offen offset:256 sc1
    buffer_load_dword v86, v5, s[20:23], s57 offen offset:512 sc1
    buffer_load_dword v87, v5, s[20:23], s57 offen offset:768 sc1
    s_waitcnt lgkmcnt(6)
    ds_read_b64_tr_b16 v[148:149], v200 offset:10240
    ds_read_b64_tr_b16 v[150:151], v200 offset:10752
    ds_read_b64_tr_b16 v[152:153], v201 offset:10240
    ds_read_b64_tr_b16 v[154:155], v201 offset:10752
    ds_read_b64_tr_b16 v[156:157], v202 offset:5120
    ds_read_b64_tr_b16 v[158:159], v202 offset:5376
    s_waitcnt vmcnt(7) lgkmcnt(6)
    v_mfma_f32_32x32x16_bf16 v[208:223], v[136:139], v[68:71], v[208:223]
    v_mfma_f32_32x32x16_bf16 v[224:239], v[140:143], v[68:71], v[224:239]
    v_mfma_f32_32x32x16_bf16 v[240:255], v[144:147], v[68:71], v[240:255]
    s_waitcnt lgkmcnt(6)
    ds_read_b64_tr_b16 v[160:161], v200 offset:12288
    ds_read_b64_tr_b16 v[162:163], v200 offset:12800
    ds_read_b64_tr_b16 v[164:165], v201 offset:12288
    ds_read_b64_tr_b16 v[166:167], v201 offset:12800
    ds_read_b64_tr_b16 v[168:169], v202 offset:6144
    ds_read_b64_tr_b16 v[170:171], v202 offset:6400
    s_waitcnt vmcnt(6) lgkmcnt(6)
    v_mfma_f32_32x32x16_bf16 v[208:223], v[148:151], v[72:75], v[208:223]
    v_mfma_f32_32x32x16_bf16 v[224:239], v[152:155], v[72:75], v[224:239]
    v_mfma_f32_32x32x16_bf16 v[240:255], v[156:159], v[72:75], v[240:255]
    s_waitcnt lgkmcnt(6)
    ds_read_b64_tr_b16 v[172:173], v200 offset:14336
    ds_read_b64_tr_b16 v[174:175], v200 offset:14848
    ds_read_b64_tr_b16 v[176:177], v201 offset:14336
    ds_read_b64_tr_b16 v[178:179], v201 offset:14848
    ds_read_b64_tr_b16 v[180:181], v202 offset:7168
    ds_read_b64_tr_b16 v[182:183], v202 offset:7424
    s_waitcnt vmcnt(5) lgkmcnt(6)
    v_mfma_f32_32x32x16_bf16 v[208:223], v[160:163], v[76:79], v[208:223]
    v_mfma_f32_32x32x16_bf16 v[224:239], v[164:167], v[76:79], v[224:239]
    v_mfma_f32_32x32x16_bf16 v[240:255], v[168:171], v[76:79], v[240:255]
    s_waitcnt lgkmcnt(6)
    ds_read_b64_tr_b16 v[184:185], v200 offset:16384
    ds_read_b64_tr_b16 v[186:187], v200 offset:16896
    ds_read_b64_tr_b16 v[188:189], v201 offset:16384
    ds_read_b64_tr_b16 v[190:191], v201 offset:16896
    ds_read_b64_tr_b16 v[192:193], v202 offset:8192
    ds_read_b64_tr_b16 v[194:195], v202 offset:8448
    s_waitcnt vmcnt(4) lgkmcnt(6)
    v_mfma_f32_32x32x16_bf16 v[208:223], v[172:175], v[80:83], v[208:223]
    v_mfma_f32_32x32x16_bf16 v[224:239], v[176:179], v[80:83], v[224:239]
    v_mfma_f32_32x32x16_bf16 v[240:255], v[180:183], v[80:83], v[240:255]
    s_waitcnt vmcnt(0) lgkmcnt(0)
    v_mfma_f32_32x32x16_bf16 v[208:223], v[184:187], v[84:87], v[208:223]
    v_mfma_f32_32x32x16_bf16 v[224:239], v[188:191], v[84:87], v[224:239]
    v_mfma_f32_32x32x16_bf16 v[240:255], v[192:195], v[84:87], v[240:255]
    s_nop 7
    s_nop 1
    ds_write_b128 v13, v[208:211] offset:0
    ds_write_b128 v13, v[212:215] offset:1024
    ds_write_b128 v13, v[216:219] offset:2048
    ds_write_b128 v13, v[220:223] offset:3072
    ds_write_b128 v13, v[224:227] offset:4096
    ds_write_b128 v13, v[228:231] offset:5120
    ds_write_b128 v13, v[232:235] offset:6144
    ds_write_b128 v13, v[236:239] offset:7168
    s_waitcnt lgkmcnt(0)
    s_barrier
    ds_read_b128 v[16:19], v11 offset:0
    ds_read_b128 v[20:23], v11 offset:1024
    ds_read_b128 v[24:27], v11 offset:2048
    ds_read_b128 v[28:31], v11 offset:3072
    s_waitcnt lgkmcnt(3)
    v_pk_add_f32 v[240:241], v[240:241], v[16:17]
    v_pk_add_f32 v[242:243], v[242:243], v[18:19]
    v_cvt_pk_bf16_f32 v88, v240, v241
    v_cvt_pk_bf16_f32 v89, v242, v243
    s_waitcnt lgkmcnt(2)
    v_pk_add_f32 v[244:245], v[244:245], v[20:21]
    v_pk_add_f32 v[246:247], v[246:247], v[22:23]
    v_cvt_pk_bf16_f32 v90, v244, v245
    v_cvt_pk_bf16_f32 v91, v246, v247
    s_waitcnt lgkmcnt(1)
    v_pk_add_f32 v[248:249], v[248:249], v[24:25]
    v_pk_add_f32 v[250:251], v[250:251], v[26:27]
    v_cvt_pk_bf16_f32 v92, v248, v249
    v_cvt_pk_bf16_f32 v93, v250, v251
    s_waitcnt lgkmcnt(0)
    v_pk_add_f32 v[252:253], v[252:253], v[28:29]
    v_pk_add_f32 v[254:255], v[254:255], v[30:31]
    v_cvt_pk_bf16_f32 v94, v252, v253
    v_cvt_pk_bf16_f32 v95, v254, v255
    s_nop 1
    v_permlane16_swap_b32 v88, v92
    v_permlane16_swap_b32 v89, v93
    v_permlane16_swap_b32 v90, v94
    v_permlane16_swap_b32 v91, v95
    buffer_store_dwordx4 v[88:91], v9, s[24:27], s41 offen sc0 sc1
    buffer_store_dwordx4 v[92:95], v9, s[24:27], s42 offen sc0 sc1
    s_endpgm
L_con_fallback:
    v_lshrrev_b32 v6, 5, v1
    v_bfe_u32 v7, v1, 4, 1
    v_bfe_u32 v8, v1, 2, 2
    v_and_b32 v9, 3, v1
    v_and_b32 v10, 31, v1
    s_lshr_b32 s38, s35, 2
    s_mul_i32 s38, s38, 75776
    v_lshl_add_u32 v3, v1, 4, s38
    v_lshl_add_u32 v4, v10, 2, s38
    v_and_b32 v206, 0x13, v10
    v_bfe_u32 v207, v10, 2, 1
    v_lshl_or_b32 v206, v207, 3, v206
    v_bfe_u32 v207, v10, 3, 1
    v_lshl_or_b32 v206, v207, 2, v206
    v_mov_b32 v207, 0x4000
    v_cmp_lt_u32 vcc, 16, v10
    s_nop 1
    v_cndmask_b32 v206, v206, v207, vcc
    v_cmp_eq_u32 vcc, 20, v10
    s_nop 1
    v_cndmask_b32 v206, v206, 17, vcc
    v_and_b32 v207, 0x1b, v10
    v_cmp_eq_u32 vcc, 17, v207
    s_nop 1
    v_cndmask_b32 v206, v206, 18, vcc
    s_movk_i32 s39, 304
    v_lshl_add_u32 v206, v206, 4, s38
    v_mad_u32_u24 v5, v6, s39, v206
    v_mov_b32 v2, 0xdddddddd
    v_lshlrev_b32 v15, 4, v1
    v_add_u32 v212, 37888, v3
    v_add_u32 v213, 37888, v5
    v_add_u32 v214, 128, v4
    v_add_u32 v215, 37888, v4
    v_add_u32 v216, 38016, v4
    s_lshr_b32 s36, s35, 2
    s_mul_i32 s36, s36, 75776
    s_and_b32 s3, s35, 3
    s_lshl_b32 s3, s3, 10
    s_add_u32 s36, s36, s3
    s_waitcnt vmcnt(0) lgkmcnt(0)
    s_barrier
    s_add_u32 s3, s36, 0
    s_mov_b32 m0, s3
    s_nop 0
    buffer_load_dwordx4 v15, s[16:19], s3 offen sc1 lds
    s_add_u32 s3, s36, 4096
    s_mov_b32 m0, s3
    s_nop 0
    buffer_load_dwordx4 v15, s[16:19], s3 offen sc1 lds
    s_add_u32 s3, s36, 8192
    s_mov_b32 m0, s3
    s_nop 0
    buffer_load_dwordx4 v15, s[16:19], s3 offen sc1 lds
    s_add_u32 s3, s36, 12288
    s_mov_b32 m0, s3
    s_nop 0
    buffer_load_dwordx4 v15, s[16:19], s3 offen sc1 lds
    s_add_u32 s3, s36, 16384
    s_mov_b32 m0, s3
    s_nop 0
    buffer_load_dwordx4 v15, s[16:19], s3 offen sc1 lds
    s_add_u32 s3, s36, 20480
    s_mov_b32 m0, s3
    s_nop 0
    buffer_load_dwordx4 v15, s[16:19], s3 offen sc1 lds
    s_add_u32 s3, s36, 24576
    s_mov_b32 m0, s3
    s_nop 0
    buffer_load_dwordx4 v15, s[16:19], s3 offen sc1 lds
    s_add_u32 s3, s36, 28672
    s_mov_b32 m0, s3
    s_nop 0
    buffer_load_dwordx4 v15, s[16:19], s3 offen sc1 lds
    s_add_u32 s3, s36, 32768
    s_mov_b32 m0, s3
    s_nop 0
    buffer_load_dwordx4 v15, s[16:19], s3 offen sc1 lds
    s_add_u32 s3, s36, 36864
    s_mov_b32 m0, s3
    s_nop 0
    buffer_load_dwordx4 v15, s[16:19], s3 offen sc1 lds
    s_add_u32 s3, s36, 40960
    s_mov_b32 m0, s3
    s_nop 0
    buffer_load_dwordx4 v15, s[16:19], s3 offen sc1 lds
    s_add_u32 s3, s36, 45056
    s_mov_b32 m0, s3
    s_nop 0
    buffer_load_dwordx4 v15, s[16:19], s3 offen sc1 lds
    s_add_u32 s3, s36, 49152
    s_mov_b32 m0, s3
    s_nop 0
    buffer_load_dwordx4 v15, s[16:19], s3 offen sc1 lds
    s_add_u32 s3, s36, 53248
    s_mov_b32 m0, s3
    s_nop 0
    buffer_load_dwordx4 v15, s[16:19], s3 offen sc1 lds
    s_add_u32 s3, s36, 57344
    s_mov_b32 m0, s3
    s_nop 0
    buffer_load_dwordx4 v15, s[16:19], s3 offen sc1 lds
    s_add_u32 s3, s36, 61440
    s_mov_b32 m0, s3
    s_nop 0
    buffer_load_dwordx4 v15, s[16:19], s3 offen sc1 lds
    s_add_u32 s3, s36, 65536
    s_mov_b32 m0, s3
    s_nop 0
    buffer_load_dwordx4 v15, s[16:19], s3 offen sc1 lds
    s_add_u32 s3, s36, 69632
    s_mov_b32 m0, s3
    s_nop 0
    buffer_load_dwordx4 v15, s[16:19], s3 offen sc1 lds
    s_add_u32 s3, s36, 73728
    s_mov_b32 m0, s3
    s_nop 0
    buffer_load_dwordx4 v15, s[16:19], s3 offen sc1 lds
    s_waitcnt vmcnt(0)
    s_barrier
    v_mov_b32 v196, 0xff800000
    v_mov_b32 v197, 0xff800000
    v_mov_b32 v198, 0xff800000
    v_mov_b32 v199, 0xff800000
    s_mov_b32 s50, 0
L_con_mx:
    ds_read2st64_b32 v[176:177], v4 offset0:0 offset1:1
    ds_read2st64_b32 v[178:179], v214 offset0:0 offset1:1
    ds_read_b128 v[168:171], v3 offset:512
    s_waitcnt lgkmcnt(0)
    v_mfma_f32_32x32x16_bf16 v[16:31], v[168:171], v[144:147], 0
    v_mfma_f32_32x32x16_bf16 v[32:47], v[168:171], v[148:151], 0
    v_mfma_f32_32x32x16_bf16 v[48:63], v[168:171], v[152:155], 0
    v_mfma_f32_32x32x16_bf16 v[64:79], v[168:171], v[156:159], 0
    s_nop 9
    v_mfma_f32_32x32x4bf16_1k v[16:47], v[176:177], v[160:161], v[16:47]
    v_mfma_f32_32x32x4bf16_1k v[48:79], v[176:177], v[164:165], v[48:79]
    s_nop 15
    s_nop 3
    v_max3_f32 v196, v16, v17, v196
    v_max3_f32 v196, v18, v19, v196
    v_max3_f32 v196, v20, v21, v196
    v_max3_f32 v196, v22, v23, v196
    v_max3_f32 v196, v24, v25, v196
    v_max3_f32 v196, v26, v27, v196
    v_max3_f32 v196, v28, v29, v196
    v_max3_f32 v196, v30, v31, v196
    v_max3_f32 v197, v32, v33, v197
    v_max3_f32 v197, v34, v35, v197
    v_max3_f32 v197, v36, v37, v197
    v_max3_f32 v197, v38, v39, v197
    v_max3_f32 v197, v40, v41, v197
    v_max3_f32 v197, v42, v43, v197
    v_max3_f32 v197, v44, v45, v197
    v_max3_f32 v197, v46, v47, v197
    v_max3_f32 v198, v48, v49, v198
    v_max3_f32 v198, v50, v51, v198
    v_max3_f32 v198, v52, v53, v198
    v_max3_f32 v198, v54, v55, v198
    v_max3_f32 v198, v56, v57, v198
    v_max3_f32 v198, v58, v59, v198
    v_max3_f32 v198, v60, v61, v198
    v_max3_f32 v198, v62, v63, v198
    v_max3_f32 v199, v64, v65, v199
    v_max3_f32 v199, v66, v67, v199
    v_max3_f32 v199, v68, v69, v199
    v_max3_f32 v199, v70, v71, v199
    v_max3_f32 v199, v72, v73, v199
    v_max3_f32 v199, v74, v75, v199
    v_max3_f32 v199, v76, v77, v199
    v_max3_f32 v199, v78, v79, v199
    ds_read_b128 v[168:171], v3 offset:2752
    s_waitcnt lgkmcnt(0)
    v_mfma_f32_32x32x16_bf16 v[16:31], v[168:171], v[144:147], 0
    v_mfma_f32_32x32x16_bf16 v[32:47], v[168:171], v[148:151], 0
    v_mfma_f32_32x32x16_bf16 v[48:63], v[168:171], v[152:155], 0
    v_mfma_f32_32x32x16_bf16 v[64:79], v[168:171], v[156:159], 0
    s_nop 9
    v_mfma_f32_32x32x4bf16_1k v[16:47], v[176:177], v[162:163], v[16:47]
    v_mfma_f32_32x32x4bf16_1k v[48:79], v[176:177], v[166:167], v[48:79]
    s_nop 15
    s_nop 3
    v_max3_f32 v196, v16, v17, v196
    v_max3_f32 v196, v18, v19, v196
    v_max3_f32 v196, v20, v21, v196
    v_max3_f32 v196, v22, v23, v196
    v_max3_f32 v196, v24, v25, v196
    v_max3_f32 v196, v26, v27, v196
    v_max3_f32 v196, v28, v29, v196
    v_max3_f32 v196, v30, v31, v196
    v_max3_f32 v197, v32, v33, v197
    v_max3_f32 v197, v34, v35, v197
    v_max3_f32 v197, v36, v37, v197
    v_max3_f32 v197, v38, v39, v197
    v_max3_f32 v197, v40, v41, v197
    v_max3_f32 v197, v42, v43, v197
    v_max3_f32 v197, v44, v45, v197
    v_max3_f32 v197, v46, v47, v197
    v_max3_f32 v198, v48, v49, v198
    v_max3_f32 v198, v50, v51, v198
    v_max3_f32 v198, v52, v53, v198
    v_max3_f32 v198, v54, v55, v198
    v_max3_f32 v198, v56, v57, v198
    v_max3_f32 v198, v58, v59, v198
    v_max3_f32 v198, v60, v61, v198
    v_max3_f32 v198, v62, v63, v198
    v_max3_f32 v199, v64, v65, v199
    v_max3_f32 v199, v66, v67, v199
    v_max3_f32 v199, v68, v69, v199
    v_max3_f32 v199, v70, v71, v199
    v_max3_f32 v199, v72, v73, v199
    v_max3_f32 v199, v74, v75, v199
    v_max3_f32 v199, v76, v77, v199
    v_max3_f32 v199, v78, v79, v199
    ds_read_b128 v[168:171], v3 offset:4992
    s_waitcnt lgkmcnt(0)
    v_mfma_f32_32x32x16_bf16 v[16:31], v[168:171], v[144:147], 0
    v_mfma_f32_32x32x16_bf16 v[32:47], v[168:171], v[148:151], 0
    v_mfma_f32_32x32x16_bf16 v[48:63], v[168:171], v[152:155], 0
    v_mfma_f32_32x32x16_bf16 v[64:79], v[168:171], v[156:159], 0
    s_nop 9
    v_mfma_f32_32x32x4bf16_1k v[16:47], v[178:179], v[160:161], v[16:47]
    v_mfma_f32_32x32x4bf16_1k v[48:79], v[178:179], v[164:165], v[48:79]
    s_nop 15
    s_nop 3
    v_max3_f32 v196, v16, v17, v196
    v_max3_f32 v196, v18, v19, v196
    v_max3_f32 v196, v20, v21, v196
    v_max3_f32 v196, v22, v23, v196
    v_max3_f32 v196, v24, v25, v196
    v_max3_f32 v196, v26, v27, v196
    v_max3_f32 v196, v28, v29, v196
    v_max3_f32 v196, v30, v31, v196
    v_max3_f32 v197, v32, v33, v197
    v_max3_f32 v197, v34, v35, v197
    v_max3_f32 v197, v36, v37, v197
    v_max3_f32 v197, v38, v39, v197
    v_max3_f32 v197, v40, v41, v197
    v_max3_f32 v197, v42, v43, v197
    v_max3_f32 v197, v44, v45, v197
    v_max3_f32 v197, v46, v47, v197
    v_max3_f32 v198, v48, v49, v198
    v_max3_f32 v198, v50, v51, v198
    v_max3_f32 v198, v52, v53, v198
    v_max3_f32 v198, v54, v55, v198
    v_max3_f32 v198, v56, v57, v198
    v_max3_f32 v198, v58, v59, v198
    v_max3_f32 v198, v60, v61, v198
    v_max3_f32 v198, v62, v63, v198
    v_max3_f32 v199, v64, v65, v199
    v_max3_f32 v199, v66, v67, v199
    v_max3_f32 v199, v68, v69, v199
    v_max3_f32 v199, v70, v71, v199
    v_max3_f32 v199, v72, v73, v199
    v_max3_f32 v199, v74, v75, v199
    v_max3_f32 v199, v76, v77, v199
    v_max3_f32 v199, v78, v79, v199
    ds_read_b128 v[168:171], v3 offset:7232
    s_waitcnt lgkmcnt(0)
    v_mfma_f32_32x32x16_bf16 v[16:31], v[168:171], v[144:147], 0
    v_mfma_f32_32x32x16_bf16 v[32:47], v[168:171], v[148:151], 0
    v_mfma_f32_32x32x16_bf16 v[48:63], v[168:171], v[152:155], 0
    v_mfma_f32_32x32x16_bf16 v[64:79], v[168:171], v[156:159], 0
    s_nop 9
    v_mfma_f32_32x32x4bf16_1k v[16:47], v[178:179], v[162:163], v[16:47]
    v_mfma_f32_32x32x4bf16_1k v[48:79], v[178:179], v[166:167], v[48:79]
    s_nop 15
    s_nop 3
    v_max3_f32 v196, v16, v17, v196
    v_max3_f32 v196, v18, v19, v196
    v_max3_f32 v196, v20, v21, v196
    v_max3_f32 v196, v22, v23, v196
    v_max3_f32 v196, v24, v25, v196
    v_max3_f32 v196, v26, v27, v196
    v_max3_f32 v196, v28, v29, v196
    v_max3_f32 v196, v30, v31, v196
    v_max3_f32 v197, v32, v33, v197
    v_max3_f32 v197, v34, v35, v197
    v_max3_f32 v197, v36, v37, v197
    v_max3_f32 v197, v38, v39, v197
    v_max3_f32 v197, v40, v41, v197
    v_max3_f32 v197, v42, v43, v197
    v_max3_f32 v197, v44, v45, v197
    v_max3_f32 v197, v46, v47, v197
    v_max3_f32 v198, v48, v49, v198
    v_max3_f32 v198, v50, v51, v198
    v_max3_f32 v198, v52, v53, v198
    v_max3_f32 v198, v54, v55, v198
    v_max3_f32 v198, v56, v57, v198
    v_max3_f32 v198, v58, v59, v198
    v_max3_f32 v198, v60, v61, v198
    v_max3_f32 v198, v62, v63, v198
    v_max3_f32 v199, v64, v65, v199
    v_max3_f32 v199, v66, v67, v199
    v_max3_f32 v199, v68, v69, v199
    v_max3_f32 v199, v70, v71, v199
    v_max3_f32 v199, v72, v73, v199
    v_max3_f32 v199, v74, v75, v199
    v_max3_f32 v199, v76, v77, v199
    v_max3_f32 v199, v78, v79, v199
    v_add_u32 v3, 9472, v3
    v_add_u32 v4, 9472, v4
    v_add_u32 v214, 9472, v214
    s_add_u32 s50, s50, 1
    s_cmp_lt_u32 s50, 8
    s_cbranch_scc1 L_con_mx
    v_subrev_u32 v3, 75776, v3
    v_subrev_u32 v4, 75776, v4
    v_subrev_u32 v214, 75776, v214
    v_lshlrev_b32 v11, 4, v0
    v_add_u32 v11, 153600, v11
    ds_write_b128 v11, v[196:199]
    s_waitcnt lgkmcnt(0)
    s_barrier
    v_xor_b32 v12, 32, v0
    v_xor_b32 v13, 0x100, v0
    v_xor_b32 v14, 0x120, v0
    v_lshlrev_b32 v12, 4, v12
    v_add_u32 v12, 153600, v12
    ds_read_b128 v[16:19], v12
    v_lshlrev_b32 v13, 4, v13
    v_add_u32 v13, 153600, v13
    ds_read_b128 v[20:23], v13
    v_lshlrev_b32 v14, 4, v14
    v_add_u32 v14, 153600, v14
    ds_read_b128 v[24:27], v14
    s_waitcnt lgkmcnt(0)
    v_max3_f32 v196, v196, v16, v22
    v_max_f32 v196, v196, v26
    v_max3_f32 v197, v197, v17, v23
    v_max_f32 v197, v197, v27
    v_max3_f32 v198, v198, v18, v20
    v_max_f32 v198, v198, v24
    v_max3_f32 v199, v199, v19, v21
    v_max_f32 v199, v199, v25
    v_mov_b32 v192, 0
    v_mov_b32 v193, 0
    s_nop 1
    v_mfma_f32_32x32x4bf16_1k v[80:111], v[192:193], v[192:193], 0
    v_mfma_f32_32x32x4bf16_1k v[112:143], v[192:193], v[192:193], 0
    v_mov_b32 v194, 0
    v_mov_b32 v195, 0
    v_mov_b32 v72, 0
    v_mov_b32 v73, 0
    v_mov_b32 v74, 0
    v_mov_b32 v75, 0
    v_mov_b32 v76, 0
    v_mov_b32 v77, 0
    v_mov_b32 v78, 0
    v_mov_b32 v79, 0
    ds_read_b128 v[168:171], v3 offset:512
    ds_read2st64_b32 v[176:177], v4 offset0:0 offset1:1
    ds_read_b128 v[180:183], v5 offset:1536
    ds_read_b128 v[184:187], v5 offset:2144
    s_waitcnt lgkmcnt(0)
    v_mfma_f32_32x32x16_bf16 v[16:31], v[168:171], v[144:147], 0
    v_mfma_f32_32x32x16_bf16 v[32:47], v[168:171], v[148:151], 0
    v_mfma_f32_32x32x16_bf16 v[48:63], v[168:171], v[152:155], 0
    s_nop 7
    s_nop 0
    v_mfma_f32_32x32x4bf16_1k v[16:47], v[176:177], v[160:161], v[16:47]
    s_mov_b32 s50, 0
    s_nop 15
    s_nop 2
L_con_attS:
    v_sub_f32 v16, v16, v196
    v_exp_f32 v16, v16
    v_sub_f32 v17, v17, v196
    v_exp_f32 v17, v17
    v_smfmac_f32_32x32x32_bf16 v[128:143], v[192:195], v[72:79], v2
    v_sub_f32 v18, v18, v196
    v_exp_f32 v18, v18
    v_sub_f32 v19, v19, v196
    v_exp_f32 v19, v19
    ds_read_b128 v[172:175], v3 offset:2752
    v_sub_f32 v20, v20, v196
    v_exp_f32 v20, v20
    v_mfma_f32_32x32x16_bf16 v[64:79], v[168:171], v[156:159], 0
    v_sub_f32 v21, v21, v196
    v_exp_f32 v21, v21
    v_sub_f32 v22, v22, v196
    v_exp_f32 v22, v22
    v_sub_f32 v23, v23, v196
    v_exp_f32 v23, v23
    ds_read_b128 v[188:191], v5 offset:3776
    v_sub_f32 v24, v24, v196
    v_exp_f32 v24, v24
    v_sub_f32 v25, v25, v196
    v_exp_f32 v25, v25
    v_smfmac_f32_32x32x32_bf16 v[80:95], v[180:183], v[16:23], v2
    v_sub_f32 v26, v26, v196
    v_exp_f32 v26, v26
    v_sub_f32 v27, v27, v196
    v_exp_f32 v27, v27
    ds_read_b128 v[192:195], v5 offset:4384
    v_sub_f32 v28, v28, v196
    v_exp_f32 v28, v28
    v_sub_f32 v29, v29, v196
    v_exp_f32 v29, v29
    v_mfma_f32_32x32x4bf16_1k v[48:79], v[176:177], v[164:165], v[48:79]
    v_sub_f32 v30, v30, v196
    v_exp_f32 v30, v30
    v_sub_f32 v31, v31, v196
    v_exp_f32 v31, v31
    ds_read2st64_b32 v[178:179], v214 offset0:0 offset1:1
    v_sub_f32 v32, v32, v197
    v_exp_f32 v32, v32
    v_sub_f32 v33, v33, v197
    v_exp_f32 v33, v33
    v_sub_f32 v34, v34, v197
    v_exp_f32 v34, v34
    v_sub_f32 v35, v35, v197
    v_exp_f32 v35, v35
    v_sub_f32 v36, v36, v197
    v_exp_f32 v36, v36
    v_sub_f32 v37, v37, v197
    v_exp_f32 v37, v37
    v_smfmac_f32_32x32x32_bf16 v[80:95], v[184:187], v[24:31], v2
    v_sub_f32 v38, v38, v197
    v_exp_f32 v38, v38
    v_sub_f32 v39, v39, v197
    v_exp_f32 v39, v39
    v_sub_f32 v40, v40, v197
    v_exp_f32 v40, v40
    s_waitcnt lgkmcnt(0)
    v_mfma_f32_32x32x16_bf16 v[16:31], v[172:175], v[144:147], 0
    v_sub_f32 v41, v41, v197
    v_exp_f32 v41, v41
    v_sub_f32 v42, v42, v197
    v_exp_f32 v42, v42
    v_sub_f32 v43, v43, v197
    v_exp_f32 v43, v43
    v_smfmac_f32_32x32x32_bf16 v[96:111], v[180:183], v[32:39], v2
    v_sub_f32 v44, v44, v197
    v_exp_f32 v44, v44
    v_sub_f32 v45, v45, v197
    v_exp_f32 v45, v45
    v_sub_f32 v46, v46, v197
    v_exp_f32 v46, v46
    v_sub_f32 v47, v47, v197
    v_exp_f32 v47, v47
    v_sub_f32 v48, v48, v198
    v_exp_f32 v48, v48
    v_sub_f32 v49, v49, v198
    v_exp_f32 v49, v49
    v_smfmac_f32_32x32x32_bf16 v[96:111], v[184:187], v[40:47], v2
    v_sub_f32 v50, v50, v198
    v_exp_f32 v50, v50
    v_sub_f32 v51, v51, v198
    v_exp_f32 v51, v51
    v_sub_f32 v52, v52, v198
    v_exp_f32 v52, v52
    v_mfma_f32_32x32x16_bf16 v[32:47], v[172:175], v[148:151], 0
    v_sub_f32 v53, v53, v198
    v_exp_f32 v53, v53
    v_sub_f32 v54, v54, v198
    v_exp_f32 v54, v54
    v_sub_f32 v55, v55, v198
    v_exp_f32 v55, v55
    v_sub_f32 v56, v56, v198
    v_exp_f32 v56, v56
    v_sub_f32 v57, v57, v198
    v_exp_f32 v57, v57
    v_smfmac_f32_32x32x32_bf16 v[112:127], v[180:183], v[48:55], v2
    v_sub_f32 v58, v58, v198
    v_exp_f32 v58, v58
    v_sub_f32 v59, v59, v198
    v_exp_f32 v59, v59
    v_sub_f32 v60, v60, v198
    v_exp_f32 v60, v60
    v_sub_f32 v61, v61, v198
    v_exp_f32 v61, v61
    v_mfma_f32_32x32x4bf16_1k v[16:47], v[176:177], v[162:163], v[16:47]
    v_sub_f32 v62, v62, v198
    v_exp_f32 v62, v62
    v_sub_f32 v63, v63, v198
    v_exp_f32 v63, v63
    v_sub_f32 v64, v64, v199
    v_exp_f32 v64, v64
    v_sub_f32 v65, v65, v199
    v_exp_f32 v65, v65
    v_sub_f32 v66, v66, v199
    v_exp_f32 v66, v66
    v_sub_f32 v67, v67, v199
    v_exp_f32 v67, v67
    v_sub_f32 v68, v68, v199
    v_exp_f32 v68, v68
    v_sub_f32 v69, v69, v199
    v_exp_f32 v69, v69
    v_smfmac_f32_32x32x32_bf16 v[112:127], v[184:187], v[56:63], v2
    v_sub_f32 v70, v70, v199
    v_exp_f32 v70, v70
    v_sub_f32 v71, v71, v199
    v_exp_f32 v71, v71
    v_sub_f32 v72, v72, v199
    v_exp_f32 v72, v72
    v_mfma_f32_32x32x16_bf16 v[48:63], v[172:175], v[152:155], 0
    v_sub_f32 v73, v73, v199
    v_exp_f32 v73, v73
    v_sub_f32 v74, v74, v199
    v_exp_f32 v74, v74
    v_sub_f32 v75, v75, v199
    v_exp_f32 v75, v75
    v_smfmac_f32_32x32x32_bf16 v[128:143], v[180:183], v[64:71], v2
    v_sub_f32 v76, v76, v199
    v_exp_f32 v76, v76
    v_sub_f32 v77, v77, v199
    v_exp_f32 v77, v77
    v_sub_f32 v78, v78, v199
    v_exp_f32 v78, v78
    v_sub_f32 v79, v79, v199
    v_exp_f32 v79, v79
    v_sub_f32 v16, v16, v196
    v_exp_f32 v16, v16
    v_sub_f32 v17, v17, v196
    v_exp_f32 v17, v17
    v_smfmac_f32_32x32x32_bf16 v[128:143], v[184:187], v[72:79], v2
    v_sub_f32 v18, v18, v196
    v_exp_f32 v18, v18
    v_sub_f32 v19, v19, v196
    v_exp_f32 v19, v19
    ds_read_b128 v[168:171], v3 offset:4992
    v_sub_f32 v20, v20, v196
    v_exp_f32 v20, v20
    v_mfma_f32_32x32x16_bf16 v[64:79], v[172:175], v[156:159], 0
    v_sub_f32 v21, v21, v196
    v_exp_f32 v21, v21
    v_sub_f32 v22, v22, v196
    v_exp_f32 v22, v22
    v_sub_f32 v23, v23, v196
    v_exp_f32 v23, v23
    ds_read_b128 v[180:183], v5 offset:6016
    v_sub_f32 v24, v24, v196
    v_exp_f32 v24, v24
    v_sub_f32 v25, v25, v196
    v_exp_f32 v25, v25
    v_smfmac_f32_32x32x32_bf16 v[80:95], v[188:191], v[16:23], v2
    v_sub_f32 v26, v26, v196
    v_exp_f32 v26, v26
    v_sub_f32 v27, v27, v196
    v_exp_f32 v27, v27
    ds_read_b128 v[184:187], v5 offset:6624
    v_sub_f32 v28, v28, v196
    v_exp_f32 v28, v28
    v_sub_f32 v29, v29, v196
    v_exp_f32 v29, v29
    v_mfma_f32_32x32x4bf16_1k v[48:79], v[176:177], v[166:167], v[48:79]
    v_sub_f32 v30, v30, v196
    v_exp_f32 v30, v30
    v_sub_f32 v31, v31, v196
    v_exp_f32 v31, v31
    v_sub_f32 v32, v32, v197
    v_exp_f32 v32, v32
    v_sub_f32 v33, v33, v197
    v_exp_f32 v33, v33
    v_sub_f32 v34, v34, v197
    v_exp_f32 v34, v34
    v_sub_f32 v35, v35, v197
    v_exp_f32 v35, v35
    v_sub_f32 v36, v36, v197
    v_exp_f32 v36, v36
    v_sub_f32 v37, v37, v197
    v_exp_f32 v37, v37
    v_smfmac_f32_32x32x32_bf16 v[80:95], v[192:195], v[24:31], v2
    v_sub_f32 v38, v38, v197
    v_exp_f32 v38, v38
    v_sub_f32 v39, v39, v197
    v_exp_f32 v39, v39
    v_sub_f32 v40, v40, v197
    v_exp_f32 v40, v40
    s_waitcnt lgkmcnt(0)
    v_mfma_f32_32x32x16_bf16 v[16:31], v[168:171], v[144:147], 0
    v_sub_f32 v41, v41, v197
    v_exp_f32 v41, v41
    v_sub_f32 v42, v42, v197
    v_exp_f32 v42, v42
    v_sub_f32 v43, v43, v197
    v_exp_f32 v43, v43
    v_smfmac_f32_32x32x32_bf16 v[96:111], v[188:191], v[32:39], v2
    v_sub_f32 v44, v44, v197
    v_exp_f32 v44, v44
    v_sub_f32 v45, v45, v197
    v_exp_f32 v45, v45
    v_sub_f32 v46, v46, v197
    v_exp_f32 v46, v46
    v_sub_f32 v47, v47, v197
    v_exp_f32 v47, v47
    v_sub_f32 v48, v48, v198
    v_exp_f32 v48, v48
    v_sub_f32 v49, v49, v198
    v_exp_f32 v49, v49
    v_smfmac_f32_32x32x32_bf16 v[96:111], v[192:195], v[40:47], v2
    v_sub_f32 v50, v50, v198
    v_exp_f32 v50, v50
    v_sub_f32 v51, v51, v198
    v_exp_f32 v51, v51
    v_sub_f32 v52, v52, v198
    v_exp_f32 v52, v52
    v_mfma_f32_32x32x16_bf16 v[32:47], v[168:171], v[148:151], 0
    v_sub_f32 v53, v53, v198
    v_exp_f32 v53, v53
    v_sub_f32 v54, v54, v198
    v_exp_f32 v54, v54
    v_sub_f32 v55, v55, v198
    v_exp_f32 v55, v55
    v_sub_f32 v56, v56, v198
    v_exp_f32 v56, v56
    v_sub_f32 v57, v57, v198
    v_exp_f32 v57, v57
    v_smfmac_f32_32x32x32_bf16 v[112:127], v[188:191], v[48:55], v2
    v_sub_f32 v58, v58, v198
    v_exp_f32 v58, v58
    v_sub_f32 v59, v59, v198
    v_exp_f32 v59, v59
    v_sub_f32 v60, v60, v198
    v_exp_f32 v60, v60
    v_sub_f32 v61, v61, v198
    v_exp_f32 v61, v61
    v_mfma_f32_32x32x4bf16_1k v[16:47], v[178:179], v[160:161], v[16:47]
    v_sub_f32 v62, v62, v198
    v_exp_f32 v62, v62
    v_sub_f32 v63, v63, v198
    v_exp_f32 v63, v63
    v_sub_f32 v64, v64, v199
    v_exp_f32 v64, v64
    v_sub_f32 v65, v65, v199
    v_exp_f32 v65, v65
    v_sub_f32 v66, v66, v199
    v_exp_f32 v66, v66
    v_sub_f32 v67, v67, v199
    v_exp_f32 v67, v67
    v_sub_f32 v68, v68, v199
    v_exp_f32 v68, v68
    v_sub_f32 v69, v69, v199
    v_exp_f32 v69, v69
    v_smfmac_f32_32x32x32_bf16 v[112:127], v[192:195], v[56:63], v2
    v_sub_f32 v70, v70, v199
    v_exp_f32 v70, v70
    v_sub_f32 v71, v71, v199
    v_exp_f32 v71, v71
    v_sub_f32 v72, v72, v199
    v_exp_f32 v72, v72
    v_mfma_f32_32x32x16_bf16 v[48:63], v[168:171], v[152:155], 0
    v_sub_f32 v73, v73, v199
    v_exp_f32 v73, v73
    v_sub_f32 v74, v74, v199
    v_exp_f32 v74, v74
    v_sub_f32 v75, v75, v199
    v_exp_f32 v75, v75
    v_smfmac_f32_32x32x32_bf16 v[128:143], v[188:191], v[64:71], v2
    v_sub_f32 v76, v76, v199
    v_exp_f32 v76, v76
    v_sub_f32 v77, v77, v199
    v_exp_f32 v77, v77
    v_sub_f32 v78, v78, v199
    v_exp_f32 v78, v78
    v_sub_f32 v79, v79, v199
    v_exp_f32 v79, v79
    v_sub_f32 v16, v16, v196
    v_exp_f32 v16, v16
    v_sub_f32 v17, v17, v196
    v_exp_f32 v17, v17
    v_smfmac_f32_32x32x32_bf16 v[128:143], v[192:195], v[72:79], v2
    v_sub_f32 v18, v18, v196
    v_exp_f32 v18, v18
    v_sub_f32 v19, v19, v196
    v_exp_f32 v19, v19
    ds_read_b128 v[172:175], v3 offset:7232
    v_sub_f32 v20, v20, v196
    v_exp_f32 v20, v20
    v_mfma_f32_32x32x16_bf16 v[64:79], v[168:171], v[156:159], 0
    v_sub_f32 v21, v21, v196
    v_exp_f32 v21, v21
    v_sub_f32 v22, v22, v196
    v_exp_f32 v22, v22
    v_sub_f32 v23, v23, v196
    v_exp_f32 v23, v23
    ds_read_b128 v[188:191], v5 offset:8256
    v_sub_f32 v24, v24, v196
    v_exp_f32 v24, v24
    v_sub_f32 v25, v25, v196
    v_exp_f32 v25, v25
    v_smfmac_f32_32x32x32_bf16 v[80:95], v[180:183], v[16:23], v2
    v_sub_f32 v26, v26, v196
    v_exp_f32 v26, v26
    v_sub_f32 v27, v27, v196
    v_exp_f32 v27, v27
    ds_read_b128 v[192:195], v5 offset:8864
    v_sub_f32 v28, v28, v196
    v_exp_f32 v28, v28
    v_sub_f32 v29, v29, v196
    v_exp_f32 v29, v29
    v_mfma_f32_32x32x4bf16_1k v[48:79], v[178:179], v[164:165], v[48:79]
    v_sub_f32 v30, v30, v196
    v_exp_f32 v30, v30
    v_sub_f32 v31, v31, v196
    v_exp_f32 v31, v31
    ds_read2st64_b32 v[176:177], v4 offset0:37 offset1:38
    v_sub_f32 v32, v32, v197
    v_exp_f32 v32, v32
    v_sub_f32 v33, v33, v197
    v_exp_f32 v33, v33
    v_sub_f32 v34, v34, v197
    v_exp_f32 v34, v34
    v_sub_f32 v35, v35, v197
    v_exp_f32 v35, v35
    v_sub_f32 v36, v36, v197
    v_exp_f32 v36, v36
    v_sub_f32 v37, v37, v197
    v_exp_f32 v37, v37
    v_smfmac_f32_32x32x32_bf16 v[80:95], v[184:187], v[24:31], v2
    v_sub_f32 v38, v38, v197
    v_exp_f32 v38, v38
    v_sub_f32 v39, v39, v197
    v_exp_f32 v39, v39
    v_sub_f32 v40, v40, v197
    v_exp_f32 v40, v40
    s_waitcnt lgkmcnt(0)
    v_mfma_f32_32x32x16_bf16 v[16:31], v[172:175], v[144:147], 0
    v_sub_f32 v41, v41, v197
    v_exp_f32 v41, v41
    v_sub_f32 v42, v42, v197
    v_exp_f32 v42, v42
    v_sub_f32 v43, v43, v197
    v_exp_f32 v43, v43
    v_smfmac_f32_32x32x32_bf16 v[96:111], v[180:183], v[32:39], v2
    v_sub_f32 v44, v44, v197
    v_exp_f32 v44, v44
    v_sub_f32 v45, v45, v197
    v_exp_f32 v45, v45
    v_sub_f32 v46, v46, v197
    v_exp_f32 v46, v46
    v_sub_f32 v47, v47, v197
    v_exp_f32 v47, v47
    v_sub_f32 v48, v48, v198
    v_exp_f32 v48, v48
    v_sub_f32 v49, v49, v198
    v_exp_f32 v49, v49
    v_smfmac_f32_32x32x32_bf16 v[96:111], v[184:187], v[40:47], v2
    v_sub_f32 v50, v50, v198
    v_exp_f32 v50, v50
    v_sub_f32 v51, v51, v198
    v_exp_f32 v51, v51
    v_sub_f32 v52, v52, v198
    v_exp_f32 v52, v52
    v_mfma_f32_32x32x16_bf16 v[32:47], v[172:175], v[148:151], 0
    v_sub_f32 v53, v53, v198
    v_exp_f32 v53, v53
    v_sub_f32 v54, v54, v198
    v_exp_f32 v54, v54
    v_sub_f32 v55, v55, v198
    v_exp_f32 v55, v55
    v_sub_f32 v56, v56, v198
    v_exp_f32 v56, v56
    v_sub_f32 v57, v57, v198
    v_exp_f32 v57, v57
    v_smfmac_f32_32x32x32_bf16 v[112:127], v[180:183], v[48:55], v2
    v_sub_f32 v58, v58, v198
    v_exp_f32 v58, v58
    v_sub_f32 v59, v59, v198
    v_exp_f32 v59, v59
    v_sub_f32 v60, v60, v198
    v_exp_f32 v60, v60
    v_sub_f32 v61, v61, v198
    v_exp_f32 v61, v61
    v_mfma_f32_32x32x4bf16_1k v[16:47], v[178:179], v[162:163], v[16:47]
    v_sub_f32 v62, v62, v198
    v_exp_f32 v62, v62
    v_sub_f32 v63, v63, v198
    v_exp_f32 v63, v63
    v_sub_f32 v64, v64, v199
    v_exp_f32 v64, v64
    v_sub_f32 v65, v65, v199
    v_exp_f32 v65, v65
    v_sub_f32 v66, v66, v199
    v_exp_f32 v66, v66
    v_sub_f32 v67, v67, v199
    v_exp_f32 v67, v67
    v_sub_f32 v68, v68, v199
    v_exp_f32 v68, v68
    v_sub_f32 v69, v69, v199
    v_exp_f32 v69, v69
    v_smfmac_f32_32x32x32_bf16 v[112:127], v[184:187], v[56:63], v2
    v_sub_f32 v70, v70, v199
    v_exp_f32 v70, v70
    v_sub_f32 v71, v71, v199
    v_exp_f32 v71, v71
    v_sub_f32 v72, v72, v199
    v_exp_f32 v72, v72
    v_mfma_f32_32x32x16_bf16 v[48:63], v[172:175], v[152:155], 0
    v_sub_f32 v73, v73, v199
    v_exp_f32 v73, v73
    v_sub_f32 v74, v74, v199
    v_exp_f32 v74, v74
    v_sub_f32 v75, v75, v199
    v_exp_f32 v75, v75
    v_smfmac_f32_32x32x32_bf16 v[128:143], v[180:183], v[64:71], v2
    v_sub_f32 v76, v76, v199
    v_exp_f32 v76, v76
    v_sub_f32 v77, v77, v199
    v_exp_f32 v77, v77
    v_sub_f32 v78, v78, v199
    v_exp_f32 v78, v78
    v_sub_f32 v79, v79, v199
    v_exp_f32 v79, v79
    v_sub_f32 v16, v16, v196
    v_exp_f32 v16, v16
    v_sub_f32 v17, v17, v196
    v_exp_f32 v17, v17
    v_smfmac_f32_32x32x32_bf16 v[128:143], v[184:187], v[72:79], v2
    v_sub_f32 v18, v18, v196
    v_exp_f32 v18, v18
    v_sub_f32 v19, v19, v196
    v_exp_f32 v19, v19
    ds_read_b128 v[168:171], v3 offset:9984
    v_sub_f32 v20, v20, v196
    v_exp_f32 v20, v20
    v_mfma_f32_32x32x16_bf16 v[64:79], v[172:175], v[156:159], 0
    v_sub_f32 v21, v21, v196
    v_exp_f32 v21, v21
    v_sub_f32 v22, v22, v196
    v_exp_f32 v22, v22
    v_sub_f32 v23, v23, v196
    v_exp_f32 v23, v23
    ds_read_b128 v[180:183], v5 offset:11008
    v_sub_f32 v24, v24, v196
    v_exp_f32 v24, v24
    v_sub_f32 v25, v25, v196
    v_exp_f32 v25, v25
    v_smfmac_f32_32x32x32_bf16 v[80:95], v[188:191], v[16:23], v2
    v_sub_f32 v26, v26, v196
    v_exp_f32 v26, v26
    v_sub_f32 v27, v27, v196
    v_exp_f32 v27, v27
    ds_read_b128 v[184:187], v5 offset:11616
    v_sub_f32 v28, v28, v196
    v_exp_f32 v28, v28
    v_sub_f32 v29, v29, v196
    v_exp_f32 v29, v29
    v_mfma_f32_32x32x4bf16_1k v[48:79], v[178:179], v[166:167], v[48:79]
    v_sub_f32 v30, v30, v196
    v_exp_f32 v30, v30
    v_sub_f32 v31, v31, v196
    v_exp_f32 v31, v31
    v_sub_f32 v32, v32, v197
    v_exp_f32 v32, v32
    v_sub_f32 v33, v33, v197
    v_exp_f32 v33, v33
    v_sub_f32 v34, v34, v197
    v_exp_f32 v34, v34
    v_sub_f32 v35, v35, v197
    v_exp_f32 v35, v35
    v_sub_f32 v36, v36, v197
    v_exp_f32 v36, v36
    v_sub_f32 v37, v37, v197
    v_exp_f32 v37, v37
    v_smfmac_f32_32x32x32_bf16 v[80:95], v[192:195], v[24:31], v2
    v_sub_f32 v38, v38, v197
    v_exp_f32 v38, v38
    v_sub_f32 v39, v39, v197
    v_exp_f32 v39, v39
    v_sub_f32 v40, v40, v197
    v_exp_f32 v40, v40
    s_waitcnt lgkmcnt(0)
    v_mfma_f32_32x32x16_bf16 v[16:31], v[168:171], v[144:147], 0
    v_sub_f32 v41, v41, v197
    v_exp_f32 v41, v41
    v_sub_f32 v42, v42, v197
    v_exp_f32 v42, v42
    v_sub_f32 v43, v43, v197
    v_exp_f32 v43, v43
    v_smfmac_f32_32x32x32_bf16 v[96:111], v[188:191], v[32:39], v2
    v_sub_f32 v44, v44, v197
    v_exp_f32 v44, v44
    v_sub_f32 v45, v45, v197
    v_exp_f32 v45, v45
    v_sub_f32 v46, v46, v197
    v_exp_f32 v46, v46
    v_sub_f32 v47, v47, v197
    v_exp_f32 v47, v47
    v_sub_f32 v48, v48, v198
    v_exp_f32 v48, v48
    v_sub_f32 v49, v49, v198
    v_exp_f32 v49, v49
    v_smfmac_f32_32x32x32_bf16 v[96:111], v[192:195], v[40:47], v2
    v_sub_f32 v50, v50, v198
    v_exp_f32 v50, v50
    v_sub_f32 v51, v51, v198
    v_exp_f32 v51, v51
    v_sub_f32 v52, v52, v198
    v_exp_f32 v52, v52
    v_mfma_f32_32x32x16_bf16 v[32:47], v[168:171], v[148:151], 0
    v_sub_f32 v53, v53, v198
    v_exp_f32 v53, v53
    v_sub_f32 v54, v54, v198
    v_exp_f32 v54, v54
    v_sub_f32 v55, v55, v198
    v_exp_f32 v55, v55
    v_sub_f32 v56, v56, v198
    v_exp_f32 v56, v56
    v_sub_f32 v57, v57, v198
    v_exp_f32 v57, v57
    v_smfmac_f32_32x32x32_bf16 v[112:127], v[188:191], v[48:55], v2
    v_sub_f32 v58, v58, v198
    v_exp_f32 v58, v58
    v_sub_f32 v59, v59, v198
    v_exp_f32 v59, v59
    v_sub_f32 v60, v60, v198
    v_exp_f32 v60, v60
    v_sub_f32 v61, v61, v198
    v_exp_f32 v61, v61
    v_mfma_f32_32x32x4bf16_1k v[16:47], v[176:177], v[160:161], v[16:47]
    v_sub_f32 v62, v62, v198
    v_exp_f32 v62, v62
    v_sub_f32 v63, v63, v198
    v_exp_f32 v63, v63
    v_sub_f32 v64, v64, v199
    v_exp_f32 v64, v64
    v_sub_f32 v65, v65, v199
    v_exp_f32 v65, v65
    v_sub_f32 v66, v66, v199
    v_exp_f32 v66, v66
    v_sub_f32 v67, v67, v199
    v_exp_f32 v67, v67
    v_sub_f32 v68, v68, v199
    v_exp_f32 v68, v68
    v_sub_f32 v69, v69, v199
    v_exp_f32 v69, v69
    v_smfmac_f32_32x32x32_bf16 v[112:127], v[192:195], v[56:63], v2
    v_sub_f32 v70, v70, v199
    v_exp_f32 v70, v70
    v_sub_f32 v71, v71, v199
    v_exp_f32 v71, v71
    v_sub_f32 v72, v72, v199
    v_exp_f32 v72, v72
    v_mfma_f32_32x32x16_bf16 v[48:63], v[168:171], v[152:155], 0
    v_sub_f32 v73, v73, v199
    v_exp_f32 v73, v73
    v_sub_f32 v74, v74, v199
    v_exp_f32 v74, v74
    v_sub_f32 v75, v75, v199
    v_exp_f32 v75, v75
    v_smfmac_f32_32x32x32_bf16 v[128:143], v[188:191], v[64:71], v2
    v_sub_f32 v76, v76, v199
    v_exp_f32 v76, v76
    v_sub_f32 v77, v77, v199
    v_exp_f32 v77, v77
    v_sub_f32 v78, v78, v199
    v_exp_f32 v78, v78
    v_sub_f32 v79, v79, v199
    v_exp_f32 v79, v79
    v_add_u32 v3, 9472, v3
    v_add_u32 v5, 9472, v5
    v_add_u32 v4, 9472, v4
    v_add_u32 v214, 9472, v214
    s_add_u32 s50, s50, 1
    s_cmp_lt_u32 s50, 8
    s_cbranch_scc1 L_con_attS
    v_smfmac_f32_32x32x32_bf16 v[128:143], v[192:195], v[72:79], v2
    s_barrier
    v_lshrrev_b32 v221, 3, v1
    v_and_b32 v222, 7, v1
    v_bfe_u32 v223, v1, 4, 1
    v_lshlrev_b32 v223, 1, v223
    v_xor_b32 v222, v222, v223
    v_lshlrev_b32 v222, 4, v222
    v_mul_u32_u24 v221, 0x480, v221
    v_add_u32 v217, v221, v222
    v_mad_u32_u24 v218, v221, 18, v222
    v_lshrrev_b32 v221, 2, v1
    v_and_b32 v222, 3, v1
    v_lshlrev_b32 v222, 4, v222
    v_and_b32 v223, 7, v221
    v_mul_u32_u24 v223, 18, v223
    v_lshrrev_b32 v224, 5, v1
    v_add_u32 v223, v223, v224
    v_mul_u32_u24 v223, 0x480, v223
    v_add_u32 v220, v223, v222
    v_mul_u32_u24 v221, 0x480, v221
    v_add_u32 v219, v221, v222
    s_lshr_b32 s38, s35, 1
    s_and_b32 s39, s35, 1
    s_mul_i32 s42, s38, 165888
    s_lshl_b32 s36, s52, 7
    s_add_u32 s43, s42, s36
    s_mul_i32 s36, s39, 9216
    s_add_u32 s36, s36, s43
    s_and_b32 s45, s38, 1
    s_mul_i32 s37, s45, 18432
    s_lshl_b32 s44, s39, 10
    s_add_u32 s37, s37, s44
    s_lshr_b32 s38, s38, 1
    s_mul_i32 s38, s38, 75776
    s_add_u32 s37, s37, s38
    s_mov_b32 m0, s37
    s_nop 0
    buffer_load_dwordx4 v217, s[8:11], s36 offen lds
    s_add_u32 s36, s36, 20736
    s_add_u32 s37, s37, 2048
    s_mov_b32 m0, s37
    s_nop 0
    buffer_load_dwordx4 v217, s[8:11], s36 offen lds
    s_add_u32 s36, s36, 20736
    s_add_u32 s37, s37, 2048
    s_mov_b32 m0, s37
    s_nop 0
    buffer_load_dwordx4 v217, s[8:11], s36 offen lds
    s_add_u32 s36, s36, 20736
    s_add_u32 s37, s37, 2048
    s_mov_b32 m0, s37
    s_nop 0
    buffer_load_dwordx4 v217, s[8:11], s36 offen lds
    s_add_u32 s36, s36, 20736
    s_add_u32 s37, s37, 2048
    s_mov_b32 m0, s37
    s_nop 0
    buffer_load_dwordx4 v217, s[8:11], s36 offen lds
    s_add_u32 s36, s36, 20736
    s_add_u32 s37, s37, 2048
    s_mov_b32 m0, s37
    s_nop 0
    buffer_load_dwordx4 v217, s[8:11], s36 offen lds
    s_add_u32 s36, s36, 20736
    s_add_u32 s37, s37, 2048
    s_mov_b32 m0, s37
    s_nop 0
    buffer_load_dwordx4 v217, s[8:11], s36 offen lds
    s_add_u32 s36, s36, 20736
    s_add_u32 s37, s37, 2048
    s_mov_b32 m0, s37
    s_nop 0
    buffer_load_dwordx4 v217, s[8:11], s36 offen lds
    s_add_u32 s36, s36, 20736
    s_add_u32 s37, s37, 2048
    s_mul_i32 s36, s39, 1152
    s_add_u32 s36, s36, s43
    s_add_u32 s36, s36, 18432
    s_mov_b32 m0, s37
    s_nop 0
    buffer_load_dwordx4 v218, s[8:11], s36 offen lds
    s_lshr_b32 s36, s34, 1
    s_lshl_b32 s36, s36, 6
    s_add_u32 s42, s42, s36
    s_add_u32 s42, s42, 1024
    s_mul_i32 s36, s39, 20736
    s_add_u32 s36, s36, s42
    s_mul_i32 s43, s45, 9216
    s_add_u32 s43, s43, s38
    s_add_u32 s43, s43, 36864
    s_add_u32 s37, s43, s44
    s_mov_b32 m0, s37
    s_nop 0
    buffer_load_dwordx4 v219, s[8:11], s36 offen lds
    s_add_u32 s36, s36, 41472
    s_add_u32 s37, s37, 2048
    s_mov_b32 m0, s37
    s_nop 0
    buffer_load_dwordx4 v219, s[8:11], s36 offen lds
    s_add_u32 s36, s36, 41472
    s_add_u32 s37, s37, 2048
    s_mov_b32 m0, s37
    s_nop 0
    buffer_load_dwordx4 v219, s[8:11], s36 offen lds
    s_add_u32 s36, s36, 41472
    s_add_u32 s37, s37, 2048
    s_mov_b32 m0, s37
    s_nop 0
    buffer_load_dwordx4 v219, s[8:11], s36 offen lds
    s_cmp_eq_u32 s39, 0
    s_cbranch_scc0 L_con_wox2
    s_add_u32 s36, s42, 18432
    s_add_u32 s37, s43, 8192
    s_mov_b32 m0, s37
    s_nop 0
    buffer_load_dwordx4 v220, s[8:11], s36 offen lds
L_con_wox2:
    s_and_b32 s44, s35, 3
    s_mul_i32 s3, s44, 5120
    s_cmp_ge_u32 s35, 4
    s_mov_b32 s45, 55296
    s_cselect_b32 s45, 131072, s45
    s_add_u32 s3, s3, s45
    s_cmp_ge_u32 s35, 4
    s_mov_b32 s45, 151552
    s_cselect_b32 s45, 156672, s45
    s_cmp_eq_u32 s44, 3
    s_cselect_b32 s3, s45, s3
    v_lshl_add_u32 v13, v1, 4, s3
    s_xor_b32 s37, s35, 4
    s_and_b32 s44, s37, 3
    s_mul_i32 s3, s44, 5120
    s_cmp_ge_u32 s37, 4
    s_mov_b32 s45, 55296
    s_cselect_b32 s45, 131072, s45
    s_add_u32 s3, s3, s45
    s_cmp_ge_u32 s37, 4
    s_mov_b32 s45, 151552
    s_cselect_b32 s45, 156672, s45
    s_cmp_eq_u32 s44, 3
    s_cselect_b32 s3, s45, s3
    v_lshl_add_u32 v14, v1, 4, s3
    v_lshl_add_u32 v9, v1, 2, s3
    v_lshlrev_b32 v12, 2, v1
    v_mov_b32 v10, 161792
    v_mov_b32 v11, 0
    ds_write_b32 v10, v11
    s_and_b32 s36, s33, 1
    s_lshl_b32 s36, s36, 1
    s_lshr_b32 s37, s35, 2
    s_add_u32 s36, s36, s37
    s_lshl_b32 s37, s53, 2
    s_add_u32 s36, s36, s37
    s_mul_i32 s36, s36, 36
    s_mul_i32 s37, s34, 9
    s_add_u32 s36, s36, s37
    s_lshl_b32 s36, s36, 10
    s_and_b32 s37, s35, 3
    s_lshl_b32 s61, s37, 8
    s_add_u32 s61, s61, s36
    s_add_u32 s61, s61, 8192
    s_lshl_b32 s37, s37, 11
    s_add_u32 s60, s36, s37
    s_and_b32 s36, s33, 1
    s_lshl_b32 s36, s36, 1
    s_and_b32 s43, s34, 1
    s_lshr_b32 s37, s35, 2
    s_and_b32 s40, s35, 1
    s_xor_b32 s38, s40, s37
    s_xor_b32 s38, s38, s43
    s_xor_b32 s38, s38, 1
    s_add_u32 s38, s38, s36
    s_lshr_b32 s39, s34, 1
    s_xor_b32 s39, s39, s37
    s_xor_b32 s37, s37, s43
    s_lshr_b32 s3, s34, 1
    s_xor_b32 s40, s40, s3
    s_xor_b32 s36, s36, 2
    s_add_u32 s40, s40, s36
    s_bitcmp1_b32 s35, 1
    s_cselect_b32 s38, s40, s38
    s_cselect_b32 s39, s37, s39
    s_and_b32 s3, s35, 6
    s_cmp_eq_u32 s3, 0
    s_cselect_b32 s37, s43, 0
    s_cselect_b32 s51, 1, 0
    s_lshl_b32 s36, s53, 2
    s_add_u32 s36, s36, s38
    s_lshl_b32 s36, s36, 1
    s_add_u32 s36, s36, s39
    s_lshl_b32 s36, s36, 1
    s_xor_b32 s3, s43, 1
    s_and_b32 s3, s3, s51
    s_add_u32 s36, s36, s3
    s_mul_i32 s57, s36, 9216
    s_mul_i32 s36, s39, 75776
    s_mul_i32 s40, s37, 9216
    s_add_u32 s41, s36, 36864
    s_add_u32 s65, s41, s40
    s_sub_u32 s66, s41, s40
    s_add_u32 s66, s66, 9216
    s_lshl_b32 s40, s40, 1
    s_add_u32 s63, s36, s40
    s_sub_u32 s64, s36, s40
    s_add_u32 s64, s64, 18432
    s_lshl_b32 s3, s38, 13
    s_cmp_ge_u32 s38, 2
    s_mov_b32 s36, 55296
    s_cselect_b32 s36, 114688, s36
    s_add_u32 s67, s3, s36
    s_and_b32 s36, s53, 15
    s_lshl_b32 s36, s36, 2
    s_add_u32 s36, s36, s38
    s_mul_i32 s36, s36, 73728
    s_mul_i32 s37, s32, 1152
    s_add_u32 s40, s36, s37
    s_lshr_b32 s36, s34, 1
    s_lshl_b32 s36, s36, 6
    s_add_u32 s41, s40, s36
    s_add_u32 s41, s41, 1024
    s_lshl_b32 s36, s52, 7
    s_add_u32 s40, s40, s36
    s_add_u32 s56, s40, 36864
    s_add_u32 s42, s41, 36864
    s_bitcmp1_b32 s38, 0
    s_mov_b32 s96, 131072
    s_cselect_b32 s96, 55296, s96
    s_mov_b32 s97, 156672
    s_cselect_b32 s97, 151552, s97
    s_lshl_b32 s37, s53, 10
    s_add_u32 s37, s37, 32768
    s_lshl_b32 s36, s52, 7
    s_add_u32 s36, s36, s37
    ds_write_b128 v13, v[80:83] offset:0
    ds_write_b128 v13, v[84:87] offset:1024
    ds_write_b64 v13, v[88:89] offset:4096
    ds_write_b128 v13, v[96:99] offset:2048
    ds_write_b128 v13, v[100:103] offset:3072
    ds_write_b64 v13, v[104:105] offset:4104
    s_waitcnt vmcnt(0) lgkmcnt(0)
    s_barrier
    ds_read_b64 v[24:25], v14 offset:4096
    ds_read_b128 v[16:19], v14 offset:0
    ds_read_b128 v[20:23], v14 offset:1024
    ds_read_b64 v[40:41], v14 offset:4104
    ds_read_b128 v[32:35], v14 offset:2048
    ds_read_b128 v[36:39], v14 offset:3072
    s_waitcnt lgkmcnt(5)
    v_add_f32 v121, v121, v25
    v_add_f32 v120, v120, v24
    v_rcp_f32 v121, v121
    s_waitcnt lgkmcnt(3)
    v_pk_add_f32 v[112:113], v[112:113], v[16:17]
    v_pk_add_f32 v[114:115], v[114:115], v[18:19]
    v_pk_add_f32 v[116:117], v[116:117], v[20:21]
    v_pk_add_f32 v[118:119], v[118:119], v[22:23]
    v_pk_mul_f32 v[112:113], v[112:113], v[120:121] op_sel:[0,1] op_sel_hi:[1,1]
    v_pk_mul_f32 v[114:115], v[114:115], v[120:121] op_sel:[0,1] op_sel_hi:[1,1]
    v_pk_mul_f32 v[116:117], v[116:117], v[120:121] op_sel:[0,1] op_sel_hi:[1,1]
    v_pk_mul_f32 v[118:119], v[118:119], v[120:121] op_sel:[0,1] op_sel_hi:[1,1]
    v_mul_f32 v120, v120, v121
    v_cvt_pk_bf16_f32 v48, v112, v113
    v_cvt_pk_bf16_f32 v49, v114, v115
    v_cvt_pk_bf16_f32 v50, v116, v117
    v_cvt_pk_bf16_f32 v51, v118, v119
    buffer_store_dwordx4 v[48:51], v15, s[20:23], s60 offen offset:0 sc1
    s_waitcnt lgkmcnt(2)
    v_add_f32 v137, v137, v41
    v_add_f32 v136, v136, v40
    v_rcp_f32 v137, v137
    s_waitcnt lgkmcnt(0)
    v_pk_add_f32 v[128:129], v[128:129], v[32:33]
    v_pk_add_f32 v[130:131], v[130:131], v[34:35]
    v_pk_add_f32 v[132:133], v[132:133], v[36:37]
    v_pk_add_f32 v[134:135], v[134:135], v[38:39]
    v_pk_mul_f32 v[128:129], v[128:129], v[136:137] op_sel:[0,1] op_sel_hi:[1,1]
    v_pk_mul_f32 v[130:131], v[130:131], v[136:137] op_sel:[0,1] op_sel_hi:[1,1]
    v_pk_mul_f32 v[132:133], v[132:133], v[136:137] op_sel:[0,1] op_sel_hi:[1,1]
    v_pk_mul_f32 v[134:135], v[134:135], v[136:137] op_sel:[0,1] op_sel_hi:[1,1]
    v_mul_f32 v136, v136, v137
    v_cvt_pk_bf16_f32 v52, v128, v129
    v_cvt_pk_bf16_f32 v53, v130, v131
    v_cvt_pk_bf16_f32 v54, v132, v133
    v_cvt_pk_bf16_f32 v55, v134, v135
    buffer_store_dwordx4 v[52:55], v15, s[20:23], s60 offen offset:1024 sc1
    v_cvt_pk_bf16_f32 v56, v120, v136
    buffer_store_dword v56, v12, s[20:23], s61 offen sc1
    s_setprio 0
    ds_write_b128 v14, v[48:51]
    ds_write_b128 v14, v[52:55] offset:1024
    ds_write_b32 v9, v56 offset:2048
    s_branch L_con_fin
L_con_end_concat_heads__grouped_kv_mqa__grouped_kv_mqa__prompt_kernel:
    s_endpgm
L_con_code_end:
.section .rodata,"a"
.p2align 6
.amdhsa_kernel concat_heads__grouped_kv_mqa__grouped_kv_mqa__prompt_kernel
  .amdhsa_next_free_vgpr 256
  .amdhsa_next_free_sgpr 100
  .amdhsa_accum_offset 256
  .amdhsa_group_segment_fixed_size 0
  .amdhsa_kernarg_size 104
  .amdhsa_user_sgpr_count 2
  .amdhsa_user_sgpr_kernarg_segment_ptr 1
  .amdhsa_system_sgpr_workgroup_id_x 1
  .amdhsa_float_denorm_mode_32 3
.end_amdhsa_kernel
```
